```python
import torch

def _softmax(x, axis=-1):
    return torch.softmax(x, dim=axis)
def _gelu(x):
    return torch.nn.functional.gelu(x, approximate="tanh")
def _silu(x):
    return torch.nn.functional.silu(x)
def _sigmoid(x):
    return torch.sigmoid(x)
def _layernorm(x, axis=-1, eps=1e-5):
    m = x.mean(dim=axis, keepdim=True)
    v = x.var(dim=axis, keepdim=True, unbiased=False)
    return (x - m) / torch.sqrt(v + eps)
def _scatter_add(tgt, idx, src, axis=0):
    return tgt.clone().index_add_(axis, idx, src)
def _segment_sum(src, seg, n):
    out = torch.zeros((n,) + src.shape[1:], dtype=src.dtype)
    return out.index_add_(0, seg, src)
def _pad(x, pw):
    flat = tuple(v for pair in reversed(pw) for v in pair)
    return torch.nn.functional.pad(x, flat)

kernel_name = 'parallel_sum__softmax_full_mha__mixer_s_mlp__prompt'

def setup_inputs():

    _w = (lambda a: (lambda t: t.to(torch.bfloat16) if t.is_floating_point() else t)(torch.as_tensor(a)))
    def _A_setup():
        B, S, D = 1, 2048, 448
        return {
            "x": _w((lambda *s: torch.randn(*s, dtype=torch.bfloat16) * 0.05)(B, S, D)),
            "wqkv": _w((lambda *s: torch.randn(*s, dtype=torch.bfloat16) * 0.1)(D, 3 * D)),
            "wo": _w((lambda *s: torch.randn(*s, dtype=torch.bfloat16) * 0.05)(D, D)),
        }
    _A_in = _A_setup()

    def _B_setup():
        B, S, D, F = 1, 2048, 448, 1792
        return {
            "x":  _w((lambda *s: torch.randn(*s, dtype=torch.bfloat16) * 0.05)(B, S, D)),
            "w1": _w((lambda *s: torch.randn(*s, dtype=torch.bfloat16) * 1.6)(D, D) * (D ** -0.5)),
            "w2": _w((lambda *s: torch.randn(*s, dtype=torch.bfloat16) * 1.6)(D, D) * (D ** -0.5)),
            "w3": _w((lambda *s: torch.randn(*s, dtype=torch.bfloat16) * 1.6)(D, F) * (D ** -0.5)),
            "w4": _w((lambda *s: torch.randn(*s, dtype=torch.bfloat16) * 1.6)(F, D) * (F ** -0.5)),
        }
    _B_in = _B_setup()

    return {
        "A_x": _A_in["x"],
        "A_wqkv": _A_in["wqkv"],
        "A_wo": _A_in["wo"],
        "B_x": _B_in["x"],
        "B_w1": _B_in["w1"],
        "B_w2": _B_in["w2"],
        "B_w3": _B_in["w3"],
        "B_w4": _B_in["w4"],
    }

def reference(A_x, A_wqkv, A_wo, B_x, B_w1, B_w2, B_w3, B_w4):
    def _A_ref(x, wqkv, wo):
        B, S, D = x.shape
        H = 16; Dh = D // H
        qkv = (lambda x, *d: x.permute(*d))((x @ wqkv).reshape(B, S, 3, H, Dh), 2, 0, 3, 1, 4)
        q, k, v = qkv[0], qkv[1], qkv[2]
        scale = Dh ** -0.5
        scores = torch.einsum("bhqd,bhkd->bhqk", q, k) * scale
        p = _softmax(scores, axis=-1)
        o = torch.einsum("bhqk,bhkd->bhqd", p, v)
        return (lambda x, *d: x.permute(*d))(o, 0, 2, 1, 3).reshape(B, S, D) @ wo

    def _B_ref(x, w1, w2, w3, w4):
        B, S, D = x.shape
        h = _gelu(_layernorm(x, axis=-1) @ w1)
        c = D // 4
        g0 = _pad(h[:, :, 0*c:1*c], ((0, 0), (1, 0), (0, 0)))[:, :S, :]
        g1 = _pad(h[:, :, 1*c:2*c], ((0, 0), (0, 1), (0, 0)))[:, 1:, :]
        g2 = _pad(h[:, :, 2*c:3*c], ((0, 0), (2, 0), (0, 0)))[:, :S, :]
        g3 = _pad(h[:, :, 3*c:   ], ((0, 0), (0, 2), (0, 0)))[:, 2:, :]
        hs = torch.concatenate([g0, g1, g2, g3], axis=-1) @ w2
        x1 = x + hs
        h2 = _gelu(_layernorm(x1, axis=-1) @ w3) @ w4
        return x1 + h2

    x = A_x
    xn = _layernorm(x, axis=-1)
    return x + _A_ref(xn, A_wqkv, A_wo) + _B_ref(xn, B_w1, B_w2, B_w3, B_w4)
```

```asm
; @launch grid=(256,1,1) block=(512,1,1) lds=163840
.amdgcn_target "amdgcn-amd-amdhsa--gfx950"
.text
.globl parallel_sum__softmax_full_mha__mixer_s_mlp__prompt_kernel
.p2align 8
.type parallel_sum__softmax_full_mha__mixer_s_mlp__prompt_kernel,@function
parallel_sum__softmax_full_mha__mixer_s_mlp__prompt_kernel:
SC1on_6:
  s_cmp_ge_u32 s2, 256
  s_cbranch_scc1 K1end_5
  s_load_dwordx2 s[8:9], s[0:1], 0
  s_load_dwordx2 s[16:17], s[0:1], 8
  s_load_dwordx2 s[12:13], s[0:1], 32
  s_load_dwordx2 s[20:21], s[0:1], 80
  v_lshrrev_b32 v1, 6, v0
  v_and_b32 v0, 63, v0
  v_readfirstlane_b32 s3, v1
  s_mov_b32 s10, 0x1c0000
  s_mov_b32 s11, 0x00020000
  s_mov_b32 s18, 0x126000
  s_mov_b32 s19, 0x00020000
  s_mov_b32 s22, 0x10000000
  s_mov_b32 s23, 0x00020000
  s_cmp_ge_u32 s3, 4
  s_cbranch_scc1 KMB_1
  s_cmp_ge_u32 s2, 224
  s_cbranch_scc1 K1spare_4
  s_lshr_b32 s4, s3, 1
  s_and_b32 s5, s3, 1
  s_and_b32 s24, s2, 7
  s_lshr_b32 s25, s2, 3
  s_lshr_b32 s6, s24, 1
  s_lshl_b32 s6, s6, 2
  s_and_b32 s26, s25, 3
  s_add_u32 s6, s6, s26
  s_lshr_b32 s24, s24, 0
  s_and_b32 s25, s2, 1
  s_lshr_b32 s24, s2, 5
  s_waitcnt lgkmcnt(0)
  s_cmp_eq_u32 s25, 1
  s_cselect_b32 s12, s16, s12
  s_cselect_b32 s13, s17, s13
  s_mov_b32 s14, 0x62000
  s_cselect_b32 s14, 0x126000, s14
  s_mov_b32 s15, 0x00020000
  s_movk_i32 s26, 896
  s_cselect_b32 s26, 2688, s26
  s_cselect_b32 s27, 896, 0
  s_cselect_b32 s28, 1792, 0
  s_lshl_b32 s29, s24, 7
  s_add_u32 s27, s27, s29
  s_add_u32 s28, s28, s29
  v_lshrrev_b32 v2, 3, v0
  v_lshrrev_b32 v3, 2, v2
  v_lshlrev_b32 v3, 4, v3
  v_and_b32 v4, 3, v2
  v_add_u32 v3, v3, v4
  s_lshl_b32 s29, s6, 7
  s_lshl_b32 s30, s3, 5
  s_add_u32 s29, s29, s30
  v_add_u32 v3, s29, v3
  v_mul_u32_u24 v3, 896, v3
  v_lshrrev_b32 v4, 1, v2
  v_and_b32 v5, 7, v0
  v_xor_b32 v4, v4, v5
  v_lshl_add_u32 v8, v4, 4, v3
  v_xor_b32 v9, 64, v8
  v_lshrrev_b32 v2, 5, v0
  v_bfe_u32 v3, v0, 2, 2
  v_lshl_add_u32 v2, v2, 2, v3
  v_mul_lo_u32 v10, v2, s26
  v_bfe_u32 v2, v0, 4, 1
  v_lshl_add_u32 v10, v2, 6, v10
  v_and_b32 v2, 3, v0
  v_lshl_add_u32 v10, v2, 4, v10
  v_add_u32 v10, s27, v10
  s_movk_i32 s30, 2688
  v_lshrrev_b32 v2, 5, v0
  v_bfe_u32 v3, v0, 2, 2
  v_lshl_add_u32 v2, v2, 2, v3
  v_mul_lo_u32 v11, v2, s30
  v_bfe_u32 v2, v0, 4, 1
  v_lshl_add_u32 v11, v2, 6, v11
  v_and_b32 v2, 3, v0
  v_lshl_add_u32 v11, v2, 4, v11
  v_add_u32 v11, s28, v11
  s_mov_b32 s32, 0
  s_lshl_b32 s29, s3, 4
  s_mul_i32 s33, s29, s26
  s_mul_i32 s34, s29, 2688
  s_lshl_b32 s35, s26, 3
  s_lshl_b32 s36, s26, 6
  s_lshl_b32 s37, s3, 12
  s_lshl_b32 s38, s3, 11
  s_add_u32 s38, s38, 16384
  s_mov_b32 s40, 0
K1pro_7:
  s_add_u32 m0, s40, s37
  s_nop 0
  buffer_load_dwordx4 v8, s[8:11], s32 offen lds
  s_add_u32 m0, m0, 1024
  s_add_u32 s39, s32, 3584
  buffer_load_dwordx4 v9, s[8:11], s39 offen lds
  s_add_u32 m0, m0, 1024
  s_add_u32 s39, s32, 7168
  buffer_load_dwordx4 v8, s[8:11], s39 offen lds
  s_add_u32 m0, m0, 1024
  s_add_u32 s39, s32, 10752
  buffer_load_dwordx4 v9, s[8:11], s39 offen lds
  s_add_u32 m0, s40, s38
  s_nop 0
  buffer_load_dwordx4 v10, s[12:15], s33 offen lds
  s_add_u32 m0, m0, 1024
  s_add_u32 s39, s33, s35
  buffer_load_dwordx4 v10, s[12:15], s39 offen lds
  s_add_u32 m0, m0, 7168
  s_nop 0
  buffer_load_dwordx4 v11, s[16:19], s34 offen lds
  s_add_u32 m0, m0, 1024
  s_add_u32 s39, s34, 21504
  buffer_load_dwordx4 v11, s[16:19], s39 offen lds
  s_add_u32 s32, s32, 128
  s_add_u32 s33, s33, s36
  s_add_u32 s34, s34, 172032
  s_add_u32 s40, s40, 32768
  s_cmp_lt_u32 s40, 98304
  s_nop 0
  s_cbranch_scc1 K1pro_7
  v_and_b32 v2, 31, v0
  v_lshrrev_b32 v3, 5, v0
  v_bfe_u32 v4, v0, 1, 3
  v_xor_b32 v4, v4, v3
  v_lshlrev_b32 v5, 7, v2
  v_lshl_add_u32 v5, v4, 4, v5
  s_lshl_b32 s29, s4, 1
  s_add_u32 s41, s29, s5
  s_xor_b32 s42, s41, 1
  s_lshl_b32 s29, s41, 12
  v_add_u32 v12, s29, v5
  s_lshl_b32 s29, s42, 12
  v_add_u32 v16, s29, v5
  v_xor_b32 v13, 32, v12
  v_xor_b32 v17, 32, v16
  v_xor_b32 v14, 64, v12
  v_xor_b32 v18, 64, v16
  v_xor_b32 v15, 96, v12
  v_xor_b32 v19, 96, v16
  v_lshrrev_b32 v2, 5, v0
  v_lshlrev_b32 v20, 10, v2
  v_bfe_u32 v2, v0, 2, 2
  v_lshl_add_u32 v20, v2, 6, v20
  v_and_b32 v2, 1, v0
  v_lshl_add_u32 v20, v2, 5, v20
  v_bfe_u32 v2, v0, 4, 1
  v_lshl_add_u32 v20, v2, 4, v20
  v_bfe_u32 v2, v0, 1, 1
  v_lshl_add_u32 v20, v2, 3, v20
  s_lshl_b32 s29, s5, 8
  s_add_u32 s29, s29, 16384
  v_add_u32 v20, s29, v20
  v_mov_b32 v64, 0
  v_mov_b32 v65, 0
  v_mov_b32 v66, 0
  v_mov_b32 v67, 0
  v_mov_b32 v68, 0
  v_mov_b32 v69, 0
  v_mov_b32 v70, 0
  v_mov_b32 v71, 0
  v_mov_b32 v72, 0
  v_mov_b32 v73, 0
  v_mov_b32 v74, 0
  v_mov_b32 v75, 0
  v_mov_b32 v76, 0
  v_mov_b32 v77, 0
  v_mov_b32 v78, 0
  v_mov_b32 v79, 0
  v_mov_b32 v80, 0
  v_mov_b32 v81, 0
  v_mov_b32 v82, 0
  v_mov_b32 v83, 0
  v_mov_b32 v84, 0
  v_mov_b32 v85, 0
  v_mov_b32 v86, 0
  v_mov_b32 v87, 0
  v_mov_b32 v88, 0
  v_mov_b32 v89, 0
  v_mov_b32 v90, 0
  v_mov_b32 v91, 0
  v_mov_b32 v92, 0
  v_mov_b32 v93, 0
  v_mov_b32 v94, 0
  v_mov_b32 v95, 0
  v_mov_b32 v96, 0
  v_mov_b32 v97, 0
  v_mov_b32 v98, 0
  v_mov_b32 v99, 0
  v_mov_b32 v100, 0
  v_mov_b32 v101, 0
  v_mov_b32 v102, 0
  v_mov_b32 v103, 0
  v_mov_b32 v104, 0
  v_mov_b32 v105, 0
  v_mov_b32 v106, 0
  v_mov_b32 v107, 0
  v_mov_b32 v108, 0
  v_mov_b32 v109, 0
  v_mov_b32 v110, 0
  v_mov_b32 v111, 0
  v_mov_b32 v112, 0
  v_mov_b32 v113, 0
  v_mov_b32 v114, 0
  v_mov_b32 v115, 0
  v_mov_b32 v116, 0
  v_mov_b32 v117, 0
  v_mov_b32 v118, 0
  v_mov_b32 v119, 0
  v_mov_b32 v120, 0
  v_mov_b32 v121, 0
  v_mov_b32 v122, 0
  v_mov_b32 v123, 0
  v_mov_b32 v124, 0
  v_mov_b32 v125, 0
  v_mov_b32 v126, 0
  v_mov_b32 v127, 0
  v_mov_b32 v24, 0
  v_mov_b32 v25, 0
  v_mov_b32 v26, 0
  v_mov_b32 v27, 0
  s_mov_b32 s43, 0x3f803f80
  v_and_b32 v2, 15, v0
  v_bfe_u32 v3, v0, 4, 1
  v_cmp_eq_u32 vcc, v2, v3
  v_mov_b32 v2, 0x3f803f80
  s_nop 0
  v_cndmask_b32 v28, 0, v2, vcc
  v_cndmask_b32 v29, 0, v2, vcc
  v_cndmask_b32 v30, 0, v2, vcc
  v_cndmask_b32 v31, 0, v2, vcc
  s_setprio 1
  s_cmp_eq_u32 s25, 1
  s_cbranch_scc1 K1kv_9
  s_cmp_eq_u32 s4, 1
  s_cbranch_scc1 K1wm1_10
  s_waitcnt vmcnt(16)
  s_barrier
  ds_read_b128 v[32:35], v12
  ds_read_b64_tr_b16 v[40:41], v20 offset:0
  ds_read_b64_tr_b16 v[42:43], v20 offset:512
  ds_read_b128 v[36:39], v16
  ds_read_b64_tr_b16 v[44:45], v20 offset:8192
  ds_read_b64_tr_b16 v[46:47], v20 offset:8704
  s_mov_b32 s44, 0
K1loopA_11:
  s_waitcnt lgkmcnt(0)
  v_mfma_f32_32x32x16_bf16 v[64:79], v[40:43], v[32:35], v[64:79]
  ds_read_b128 v[48:51], v13
  ds_read_b64_tr_b16 v[56:57], v20 offset:2048
  v_mfma_f32_32x32x16_bf16 v[80:95], v[40:43], v[36:39], v[80:95]
  ds_read_b64_tr_b16 v[58:59], v20 offset:2560
  ds_read_b128 v[52:55], v17
  s_add_u32 m0, s40, s37
  s_nop 0
  buffer_load_dwordx4 v8, s[8:11], s32 offen lds
  v_mfma_f32_32x32x16_bf16 v[96:111], v[44:47], v[32:35], v[96:111]
  ds_read_b64_tr_b16 v[60:61], v20 offset:10240
  ds_read_b64_tr_b16 v[62:63], v20 offset:10752
  v_mfma_f32_32x32x16_bf16 v[112:127], v[44:47], v[36:39], v[112:127]
  s_add_u32 m0, m0, 1024
  s_add_u32 s39, s32, 3584
  buffer_load_dwordx4 v9, s[8:11], s39 offen lds
  v_mfma_f32_16x16x32_bf16 v[24:27], v[28:31], v[40:43], v[24:27]
  s_waitcnt lgkmcnt(0)
  v_mfma_f32_32x32x16_bf16 v[64:79], v[56:59], v[48:51], v[64:79]
  ds_read_b128 v[32:35], v14
  ds_read_b64_tr_b16 v[40:41], v20 offset:4096
  v_mfma_f32_32x32x16_bf16 v[80:95], v[56:59], v[52:55], v[80:95]
  ds_read_b64_tr_b16 v[42:43], v20 offset:4608
  ds_read_b128 v[36:39], v18
  s_add_u32 m0, m0, 1024
  s_add_u32 s39, s32, 7168
  buffer_load_dwordx4 v8, s[8:11], s39 offen lds
  v_mfma_f32_32x32x16_bf16 v[96:111], v[60:63], v[48:51], v[96:111]
  ds_read_b64_tr_b16 v[44:45], v20 offset:12288
  ds_read_b64_tr_b16 v[46:47], v20 offset:12800
  v_mfma_f32_32x32x16_bf16 v[112:127], v[60:63], v[52:55], v[112:127]
  s_add_u32 m0, m0, 1024
  s_add_u32 s39, s32, 10752
  buffer_load_dwordx4 v9, s[8:11], s39 offen lds
  v_mfma_f32_16x16x32_bf16 v[24:27], v[28:31], v[56:59], v[24:27]
  s_waitcnt lgkmcnt(0)
  v_mfma_f32_32x32x16_bf16 v[64:79], v[40:43], v[32:35], v[64:79]
  ds_read_b128 v[48:51], v15
  ds_read_b64_tr_b16 v[56:57], v20 offset:6144
  v_mfma_f32_32x32x16_bf16 v[80:95], v[40:43], v[36:39], v[80:95]
  ds_read_b64_tr_b16 v[58:59], v20 offset:6656
  ds_read_b128 v[52:55], v19
  s_add_u32 m0, s40, s38
  s_nop 0
  buffer_load_dwordx4 v10, s[12:15], s33 offen lds
  v_mfma_f32_32x32x16_bf16 v[96:111], v[44:47], v[32:35], v[96:111]
  ds_read_b64_tr_b16 v[60:61], v20 offset:14336
  ds_read_b64_tr_b16 v[62:63], v20 offset:14848
  v_mfma_f32_32x32x16_bf16 v[112:127], v[44:47], v[36:39], v[112:127]
  s_add_u32 m0, m0, 1024
  s_add_u32 s39, s33, s35
  buffer_load_dwordx4 v10, s[12:15], s39 offen lds
  v_mfma_f32_16x16x32_bf16 v[24:27], v[28:31], v[40:43], v[24:27]
  s_waitcnt vmcnt(14)
  s_barrier
  v_add_u32 v12, 32768, v12
  v_add_u32 v13, 32768, v13
  v_add_u32 v14, 32768, v14
  v_add_u32 v15, 32768, v15
  v_add_u32 v16, 32768, v16
  v_add_u32 v17, 32768, v17
  v_add_u32 v18, 32768, v18
  v_add_u32 v19, 32768, v19
  v_add_u32 v20, 32768, v20
  s_waitcnt lgkmcnt(0)
  v_mfma_f32_32x32x16_bf16 v[64:79], v[56:59], v[48:51], v[64:79]
  ds_read_b128 v[32:35], v12
  ds_read_b64_tr_b16 v[40:41], v20 offset:0
  v_mfma_f32_32x32x16_bf16 v[80:95], v[56:59], v[52:55], v[80:95]
  ds_read_b64_tr_b16 v[42:43], v20 offset:512
  ds_read_b128 v[36:39], v16
  s_add_u32 m0, m0, 7168
  s_nop 0
  buffer_load_dwordx4 v11, s[16:19], s34 offen lds
  v_mfma_f32_32x32x16_bf16 v[96:111], v[60:63], v[48:51], v[96:111]
  ds_read_b64_tr_b16 v[44:45], v20 offset:8192
  ds_read_b64_tr_b16 v[46:47], v20 offset:8704
  v_mfma_f32_32x32x16_bf16 v[112:127], v[60:63], v[52:55], v[112:127]
  s_add_u32 m0, m0, 1024
  s_add_u32 s39, s34, 21504
  buffer_load_dwordx4 v11, s[16:19], s39 offen lds
  s_add_u32 s32, s32, 128
  s_add_u32 s33, s33, s36
  s_add_u32 s34, s34, 172032
  v_mfma_f32_16x16x32_bf16 v[24:27], v[28:31], v[56:59], v[24:27]
  s_add_u32 s40, s40, 32768
  s_cmp_eq_u32 s40, 163840
  s_cselect_b32 s40, 0, s40
  s_add_u32 s44, s44, 1
  s_cmp_lt_u32 s44, 4
  s_cbranch_scc1 K1loopA_11
K1loopB_12:
  s_waitcnt lgkmcnt(0)
  v_mfma_f32_32x32x16_bf16 v[64:79], v[40:43], v[32:35], v[64:79]
  ds_read_b128 v[48:51], v13
  ds_read_b64_tr_b16 v[56:57], v20 offset:2048
  v_mfma_f32_32x32x16_bf16 v[80:95], v[40:43], v[36:39], v[80:95]
  ds_read_b64_tr_b16 v[58:59], v20 offset:2560
  ds_read_b128 v[52:55], v17
  v_mfma_f32_32x32x16_bf16 v[96:111], v[44:47], v[32:35], v[96:111]
  ds_read_b64_tr_b16 v[60:61], v20 offset:10240
  ds_read_b64_tr_b16 v[62:63], v20 offset:10752
  v_mfma_f32_32x32x16_bf16 v[112:127], v[44:47], v[36:39], v[112:127]
  v_mfma_f32_16x16x32_bf16 v[24:27], v[28:31], v[40:43], v[24:27]
  s_waitcnt lgkmcnt(0)
  v_mfma_f32_32x32x16_bf16 v[64:79], v[56:59], v[48:51], v[64:79]
  ds_read_b128 v[32:35], v14
  ds_read_b64_tr_b16 v[40:41], v20 offset:4096
  v_mfma_f32_32x32x16_bf16 v[80:95], v[56:59], v[52:55], v[80:95]
  ds_read_b64_tr_b16 v[42:43], v20 offset:4608
  ds_read_b128 v[36:39], v18
  v_mfma_f32_32x32x16_bf16 v[96:111], v[60:63], v[48:51], v[96:111]
  ds_read_b64_tr_b16 v[44:45], v20 offset:12288
  ds_read_b64_tr_b16 v[46:47], v20 offset:12800
  v_mfma_f32_32x32x16_bf16 v[112:127], v[60:63], v[52:55], v[112:127]
  v_mfma_f32_16x16x32_bf16 v[24:27], v[28:31], v[56:59], v[24:27]
  s_waitcnt lgkmcnt(0)
  v_mfma_f32_32x32x16_bf16 v[64:79], v[40:43], v[32:35], v[64:79]
  ds_read_b128 v[48:51], v15
  ds_read_b64_tr_b16 v[56:57], v20 offset:6144
  v_mfma_f32_32x32x16_bf16 v[80:95], v[40:43], v[36:39], v[80:95]
  ds_read_b64_tr_b16 v[58:59], v20 offset:6656
  ds_read_b128 v[52:55], v19
  v_mfma_f32_32x32x16_bf16 v[96:111], v[44:47], v[32:35], v[96:111]
  ds_read_b64_tr_b16 v[60:61], v20 offset:14336
  ds_read_b64_tr_b16 v[62:63], v20 offset:14848
  v_mfma_f32_32x32x16_bf16 v[112:127], v[44:47], v[36:39], v[112:127]
  v_mfma_f32_16x16x32_bf16 v[24:27], v[28:31], v[40:43], v[24:27]
  s_cmp_eq_u32 s44, 6
  s_cbranch_scc1 wlast_13
  s_cmp_eq_u32 s44, 5
  s_cbranch_scc1 w0_14
  s_waitcnt vmcnt(8)
  s_branch go_15
w0_14:
  s_waitcnt vmcnt(0)
go_15:
  s_barrier
  s_cmp_eq_u32 s44, 4
  s_mov_b32 s29, 32768
  s_cselect_b32 s29, 0xfffe0000, s29
  v_add_u32 v12, s29, v12
  v_add_u32 v13, s29, v13
  v_add_u32 v14, s29, v14
  v_add_u32 v15, s29, v15
  v_add_u32 v16, s29, v16
  v_add_u32 v17, s29, v17
  v_add_u32 v18, s29, v18
  v_add_u32 v19, s29, v19
  v_add_u32 v20, s29, v20
  s_waitcnt lgkmcnt(0)
  v_mfma_f32_32x32x16_bf16 v[64:79], v[56:59], v[48:51], v[64:79]
  ds_read_b128 v[32:35], v12
  ds_read_b64_tr_b16 v[40:41], v20 offset:0
  v_mfma_f32_32x32x16_bf16 v[80:95], v[56:59], v[52:55], v[80:95]
  ds_read_b64_tr_b16 v[42:43], v20 offset:512
  ds_read_b128 v[36:39], v16
  v_mfma_f32_32x32x16_bf16 v[96:111], v[60:63], v[48:51], v[96:111]
  ds_read_b64_tr_b16 v[44:45], v20 offset:8192
  ds_read_b64_tr_b16 v[46:47], v20 offset:8704
  v_mfma_f32_32x32x16_bf16 v[112:127], v[60:63], v[52:55], v[112:127]
  v_mfma_f32_16x16x32_bf16 v[24:27], v[28:31], v[56:59], v[24:27]
  s_add_u32 s44, s44, 1
  s_branch K1loopB_12
wlast_13:
  s_waitcnt lgkmcnt(0)
  v_mfma_f32_32x32x16_bf16 v[64:79], v[56:59], v[48:51], v[64:79]
  v_mfma_f32_32x32x16_bf16 v[80:95], v[56:59], v[52:55], v[80:95]
  v_mfma_f32_32x32x16_bf16 v[96:111], v[60:63], v[48:51], v[96:111]
  v_mfma_f32_32x32x16_bf16 v[112:127], v[60:63], v[52:55], v[112:127]
  v_mfma_f32_16x16x32_bf16 v[24:27], v[28:31], v[56:59], v[24:27]
  s_nop 0
  s_branch K1epi_8
K1wm1_10:
  s_waitcnt vmcnt(16)
  s_barrier
  ds_read_b128 v[32:35], v12
  ds_read_b64_tr_b16 v[40:41], v20 offset:0
  ds_read_b64_tr_b16 v[42:43], v20 offset:512
  ds_read_b128 v[36:39], v16
  ds_read_b64_tr_b16 v[44:45], v20 offset:8192
  ds_read_b64_tr_b16 v[46:47], v20 offset:8704
  s_mov_b32 s44, 0
K1loopA_16:
  s_waitcnt lgkmcnt(0)
  v_mfma_f32_32x32x16_bf16 v[64:79], v[40:43], v[32:35], v[64:79]
  ds_read_b128 v[48:51], v13
  ds_read_b64_tr_b16 v[56:57], v20 offset:2048
  v_mfma_f32_32x32x16_bf16 v[80:95], v[40:43], v[36:39], v[80:95]
  ds_read_b64_tr_b16 v[58:59], v20 offset:2560
  ds_read_b128 v[52:55], v17
  s_add_u32 m0, s40, s37
  s_nop 0
  buffer_load_dwordx4 v8, s[8:11], s32 offen lds
  v_mfma_f32_32x32x16_bf16 v[96:111], v[44:47], v[32:35], v[96:111]
  ds_read_b64_tr_b16 v[60:61], v20 offset:10240
  ds_read_b64_tr_b16 v[62:63], v20 offset:10752
  v_mfma_f32_32x32x16_bf16 v[112:127], v[44:47], v[36:39], v[112:127]
  s_add_u32 m0, m0, 1024
  s_add_u32 s39, s32, 3584
  buffer_load_dwordx4 v9, s[8:11], s39 offen lds
  v_mfma_f32_16x16x32_bf16 v[24:27], v[28:31], v[44:47], v[24:27]
  s_waitcnt lgkmcnt(0)
  v_mfma_f32_32x32x16_bf16 v[64:79], v[56:59], v[48:51], v[64:79]
  ds_read_b128 v[32:35], v14
  ds_read_b64_tr_b16 v[40:41], v20 offset:4096
  v_mfma_f32_32x32x16_bf16 v[80:95], v[56:59], v[52:55], v[80:95]
  ds_read_b64_tr_b16 v[42:43], v20 offset:4608
  ds_read_b128 v[36:39], v18
  s_add_u32 m0, m0, 1024
  s_add_u32 s39, s32, 7168
  buffer_load_dwordx4 v8, s[8:11], s39 offen lds
  v_mfma_f32_32x32x16_bf16 v[96:111], v[60:63], v[48:51], v[96:111]
  ds_read_b64_tr_b16 v[44:45], v20 offset:12288
  ds_read_b64_tr_b16 v[46:47], v20 offset:12800
  v_mfma_f32_32x32x16_bf16 v[112:127], v[60:63], v[52:55], v[112:127]
  s_add_u32 m0, m0, 1024
  s_add_u32 s39, s32, 10752
  buffer_load_dwordx4 v9, s[8:11], s39 offen lds
  v_mfma_f32_16x16x32_bf16 v[24:27], v[28:31], v[60:63], v[24:27]
  s_waitcnt lgkmcnt(0)
  v_mfma_f32_32x32x16_bf16 v[64:79], v[40:43], v[32:35], v[64:79]
  ds_read_b128 v[48:51], v15
  ds_read_b64_tr_b16 v[56:57], v20 offset:6144
  v_mfma_f32_32x32x16_bf16 v[80:95], v[40:43], v[36:39], v[80:95]
  ds_read_b64_tr_b16 v[58:59], v20 offset:6656
  ds_read_b128 v[52:55], v19
  s_add_u32 m0, s40, s38
  s_nop 0
  buffer_load_dwordx4 v10, s[12:15], s33 offen lds
  v_mfma_f32_32x32x16_bf16 v[96:111], v[44:47], v[32:35], v[96:111]
  ds_read_b64_tr_b16 v[60:61], v20 offset:14336
  ds_read_b64_tr_b16 v[62:63], v20 offset:14848
  v_mfma_f32_32x32x16_bf16 v[112:127], v[44:47], v[36:39], v[112:127]
  s_add_u32 m0, m0, 1024
  s_add_u32 s39, s33, s35
  buffer_load_dwordx4 v10, s[12:15], s39 offen lds
  v_mfma_f32_16x16x32_bf16 v[24:27], v[28:31], v[44:47], v[24:27]
  s_waitcnt vmcnt(14)
  s_barrier
  v_add_u32 v12, 32768, v12
  v_add_u32 v13, 32768, v13
  v_add_u32 v14, 32768, v14
  v_add_u32 v15, 32768, v15
  v_add_u32 v16, 32768, v16
  v_add_u32 v17, 32768, v17
  v_add_u32 v18, 32768, v18
  v_add_u32 v19, 32768, v19
  v_add_u32 v20, 32768, v20
  s_waitcnt lgkmcnt(0)
  v_mfma_f32_32x32x16_bf16 v[64:79], v[56:59], v[48:51], v[64:79]
  ds_read_b128 v[32:35], v12
  ds_read_b64_tr_b16 v[40:41], v20 offset:0
  v_mfma_f32_32x32x16_bf16 v[80:95], v[56:59], v[52:55], v[80:95]
  ds_read_b64_tr_b16 v[42:43], v20 offset:512
  ds_read_b128 v[36:39], v16
  s_add_u32 m0, m0, 7168
  s_nop 0
  buffer_load_dwordx4 v11, s[16:19], s34 offen lds
  v_mfma_f32_32x32x16_bf16 v[96:111], v[60:63], v[48:51], v[96:111]
  ds_read_b64_tr_b16 v[44:45], v20 offset:8192
  ds_read_b64_tr_b16 v[46:47], v20 offset:8704
  v_mfma_f32_32x32x16_bf16 v[112:127], v[60:63], v[52:55], v[112:127]
  s_add_u32 m0, m0, 1024
  s_add_u32 s39, s34, 21504
  buffer_load_dwordx4 v11, s[16:19], s39 offen lds
  s_add_u32 s32, s32, 128
  s_add_u32 s33, s33, s36
  s_add_u32 s34, s34, 172032
  v_mfma_f32_16x16x32_bf16 v[24:27], v[28:31], v[60:63], v[24:27]
  s_add_u32 s40, s40, 32768
  s_cmp_eq_u32 s40, 163840
  s_cselect_b32 s40, 0, s40
  s_add_u32 s44, s44, 1
  s_cmp_lt_u32 s44, 4
  s_cbranch_scc1 K1loopA_16
K1loopB_17:
  s_waitcnt lgkmcnt(0)
  v_mfma_f32_32x32x16_bf16 v[64:79], v[40:43], v[32:35], v[64:79]
  ds_read_b128 v[48:51], v13
  ds_read_b64_tr_b16 v[56:57], v20 offset:2048
  v_mfma_f32_32x32x16_bf16 v[80:95], v[40:43], v[36:39], v[80:95]
  ds_read_b64_tr_b16 v[58:59], v20 offset:2560
  ds_read_b128 v[52:55], v17
  v_mfma_f32_32x32x16_bf16 v[96:111], v[44:47], v[32:35], v[96:111]
  ds_read_b64_tr_b16 v[60:61], v20 offset:10240
  ds_read_b64_tr_b16 v[62:63], v20 offset:10752
  v_mfma_f32_32x32x16_bf16 v[112:127], v[44:47], v[36:39], v[112:127]
  v_mfma_f32_16x16x32_bf16 v[24:27], v[28:31], v[44:47], v[24:27]
  s_waitcnt lgkmcnt(0)
  v_mfma_f32_32x32x16_bf16 v[64:79], v[56:59], v[48:51], v[64:79]
  ds_read_b128 v[32:35], v14
  ds_read_b64_tr_b16 v[40:41], v20 offset:4096
  v_mfma_f32_32x32x16_bf16 v[80:95], v[56:59], v[52:55], v[80:95]
  ds_read_b64_tr_b16 v[42:43], v20 offset:4608
  ds_read_b128 v[36:39], v18
  v_mfma_f32_32x32x16_bf16 v[96:111], v[60:63], v[48:51], v[96:111]
  ds_read_b64_tr_b16 v[44:45], v20 offset:12288
  ds_read_b64_tr_b16 v[46:47], v20 offset:12800
  v_mfma_f32_32x32x16_bf16 v[112:127], v[60:63], v[52:55], v[112:127]
  v_mfma_f32_16x16x32_bf16 v[24:27], v[28:31], v[60:63], v[24:27]
  s_waitcnt lgkmcnt(0)
  v_mfma_f32_32x32x16_bf16 v[64:79], v[40:43], v[32:35], v[64:79]
  ds_read_b128 v[48:51], v15
  ds_read_b64_tr_b16 v[56:57], v20 offset:6144
  v_mfma_f32_32x32x16_bf16 v[80:95], v[40:43], v[36:39], v[80:95]
  ds_read_b64_tr_b16 v[58:59], v20 offset:6656
  ds_read_b128 v[52:55], v19
  v_mfma_f32_32x32x16_bf16 v[96:111], v[44:47], v[32:35], v[96:111]
  ds_read_b64_tr_b16 v[60:61], v20 offset:14336
  ds_read_b64_tr_b16 v[62:63], v20 offset:14848
  v_mfma_f32_32x32x16_bf16 v[112:127], v[44:47], v[36:39], v[112:127]
  v_mfma_f32_16x16x32_bf16 v[24:27], v[28:31], v[44:47], v[24:27]
  s_cmp_eq_u32 s44, 6
  s_cbranch_scc1 wlast_18
  s_cmp_eq_u32 s44, 5
  s_cbranch_scc1 w0_19
  s_waitcnt vmcnt(8)
  s_branch go_20
w0_19:
  s_waitcnt vmcnt(0)
go_20:
  s_barrier
  s_cmp_eq_u32 s44, 4
  s_mov_b32 s29, 32768
  s_cselect_b32 s29, 0xfffe0000, s29
  v_add_u32 v12, s29, v12
  v_add_u32 v13, s29, v13
  v_add_u32 v14, s29, v14
  v_add_u32 v15, s29, v15
  v_add_u32 v16, s29, v16
  v_add_u32 v17, s29, v17
  v_add_u32 v18, s29, v18
  v_add_u32 v19, s29, v19
  v_add_u32 v20, s29, v20
  s_waitcnt lgkmcnt(0)
  v_mfma_f32_32x32x16_bf16 v[64:79], v[56:59], v[48:51], v[64:79]
  ds_read_b128 v[32:35], v12
  ds_read_b64_tr_b16 v[40:41], v20 offset:0
  v_mfma_f32_32x32x16_bf16 v[80:95], v[56:59], v[52:55], v[80:95]
  ds_read_b64_tr_b16 v[42:43], v20 offset:512
  ds_read_b128 v[36:39], v16
  v_mfma_f32_32x32x16_bf16 v[96:111], v[60:63], v[48:51], v[96:111]
  ds_read_b64_tr_b16 v[44:45], v20 offset:8192
  ds_read_b64_tr_b16 v[46:47], v20 offset:8704
  v_mfma_f32_32x32x16_bf16 v[112:127], v[60:63], v[52:55], v[112:127]
  v_mfma_f32_16x16x32_bf16 v[24:27], v[28:31], v[60:63], v[24:27]
  s_add_u32 s44, s44, 1
  s_branch K1loopB_17
wlast_18:
  s_waitcnt lgkmcnt(0)
  v_mfma_f32_32x32x16_bf16 v[64:79], v[56:59], v[48:51], v[64:79]
  v_mfma_f32_32x32x16_bf16 v[80:95], v[56:59], v[52:55], v[80:95]
  v_mfma_f32_32x32x16_bf16 v[96:111], v[60:63], v[48:51], v[96:111]
  v_mfma_f32_32x32x16_bf16 v[112:127], v[60:63], v[52:55], v[112:127]
  v_mfma_f32_16x16x32_bf16 v[24:27], v[28:31], v[60:63], v[24:27]
  s_nop 0
  s_branch K1epi_8
K1kv_9:
  s_cmp_eq_u32 s4, 1
  s_cbranch_scc1 K1wm1_21
  s_waitcnt vmcnt(16)
  s_barrier
  ds_read_b128 v[32:35], v12
  ds_read_b64_tr_b16 v[40:41], v20 offset:0
  ds_read_b64_tr_b16 v[42:43], v20 offset:512
  ds_read_b128 v[36:39], v16
  ds_read_b64_tr_b16 v[44:45], v20 offset:8192
  ds_read_b64_tr_b16 v[46:47], v20 offset:8704
  s_mov_b32 s44, 0
K1loopA_22:
  s_waitcnt lgkmcnt(0)
  v_mfma_f32_32x32x16_bf16 v[64:79], v[40:43], v[32:35], v[64:79]
  ds_read_b128 v[48:51], v13
  ds_read_b64_tr_b16 v[56:57], v20 offset:2048
  v_mfma_f32_32x32x16_bf16 v[80:95], v[40:43], v[36:39], v[80:95]
  ds_read_b64_tr_b16 v[58:59], v20 offset:2560
  ds_read_b128 v[52:55], v17
  s_add_u32 m0, s40, s37
  s_nop 0
  buffer_load_dwordx4 v8, s[8:11], s32 offen lds
  v_mfma_f32_32x32x16_bf16 v[96:111], v[32:35], v[44:47], v[96:111]
  ds_read_b64_tr_b16 v[60:61], v20 offset:10240
  ds_read_b64_tr_b16 v[62:63], v20 offset:10752
  v_mfma_f32_32x32x16_bf16 v[112:127], v[36:39], v[44:47], v[112:127]
  s_add_u32 m0, m0, 1024
  s_add_u32 s39, s32, 3584
  buffer_load_dwordx4 v9, s[8:11], s39 offen lds
  v_mfma_f32_16x16x32_bf16 v[24:27], v[28:31], v[40:43], v[24:27]
  s_waitcnt lgkmcnt(0)
  v_mfma_f32_32x32x16_bf16 v[64:79], v[56:59], v[48:51], v[64:79]
  ds_read_b128 v[32:35], v14
  ds_read_b64_tr_b16 v[40:41], v20 offset:4096
  v_mfma_f32_32x32x16_bf16 v[80:95], v[56:59], v[52:55], v[80:95]
  ds_read_b64_tr_b16 v[42:43], v20 offset:4608
  ds_read_b128 v[36:39], v18
  s_add_u32 m0, m0, 1024
  s_add_u32 s39, s32, 7168
  buffer_load_dwordx4 v8, s[8:11], s39 offen lds
  v_mfma_f32_32x32x16_bf16 v[96:111], v[48:51], v[60:63], v[96:111]
  ds_read_b64_tr_b16 v[44:45], v20 offset:12288
  ds_read_b64_tr_b16 v[46:47], v20 offset:12800
  v_mfma_f32_32x32x16_bf16 v[112:127], v[52:55], v[60:63], v[112:127]
  s_add_u32 m0, m0, 1024
  s_add_u32 s39, s32, 10752
  buffer_load_dwordx4 v9, s[8:11], s39 offen lds
  v_mfma_f32_16x16x32_bf16 v[24:27], v[28:31], v[56:59], v[24:27]
  s_waitcnt lgkmcnt(0)
  v_mfma_f32_32x32x16_bf16 v[64:79], v[40:43], v[32:35], v[64:79]
  ds_read_b128 v[48:51], v15
  ds_read_b64_tr_b16 v[56:57], v20 offset:6144
  v_mfma_f32_32x32x16_bf16 v[80:95], v[40:43], v[36:39], v[80:95]
  ds_read_b64_tr_b16 v[58:59], v20 offset:6656
  ds_read_b128 v[52:55], v19
  s_add_u32 m0, s40, s38
  s_nop 0
  buffer_load_dwordx4 v10, s[12:15], s33 offen lds
  v_mfma_f32_32x32x16_bf16 v[96:111], v[32:35], v[44:47], v[96:111]
  ds_read_b64_tr_b16 v[60:61], v20 offset:14336
  ds_read_b64_tr_b16 v[62:63], v20 offset:14848
  v_mfma_f32_32x32x16_bf16 v[112:127], v[36:39], v[44:47], v[112:127]
  s_add_u32 m0, m0, 1024
  s_add_u32 s39, s33, s35
  buffer_load_dwordx4 v10, s[12:15], s39 offen lds
  v_mfma_f32_16x16x32_bf16 v[24:27], v[28:31], v[40:43], v[24:27]
  s_waitcnt vmcnt(14)
  s_barrier
  v_add_u32 v12, 32768, v12
  v_add_u32 v13, 32768, v13
  v_add_u32 v14, 32768, v14
  v_add_u32 v15, 32768, v15
  v_add_u32 v16, 32768, v16
  v_add_u32 v17, 32768, v17
  v_add_u32 v18, 32768, v18
  v_add_u32 v19, 32768, v19
  v_add_u32 v20, 32768, v20
  s_waitcnt lgkmcnt(0)
  v_mfma_f32_32x32x16_bf16 v[64:79], v[56:59], v[48:51], v[64:79]
  ds_read_b128 v[32:35], v12
  ds_read_b64_tr_b16 v[40:41], v20 offset:0
  v_mfma_f32_32x32x16_bf16 v[80:95], v[56:59], v[52:55], v[80:95]
  ds_read_b64_tr_b16 v[42:43], v20 offset:512
  ds_read_b128 v[36:39], v16
  s_add_u32 m0, m0, 7168
  s_nop 0
  buffer_load_dwordx4 v11, s[16:19], s34 offen lds
  v_mfma_f32_32x32x16_bf16 v[96:111], v[48:51], v[60:63], v[96:111]
  ds_read_b64_tr_b16 v[44:45], v20 offset:8192
  ds_read_b64_tr_b16 v[46:47], v20 offset:8704
  v_mfma_f32_32x32x16_bf16 v[112:127], v[52:55], v[60:63], v[112:127]
  s_add_u32 m0, m0, 1024
  s_add_u32 s39, s34, 21504
  buffer_load_dwordx4 v11, s[16:19], s39 offen lds
  s_add_u32 s32, s32, 128
  s_add_u32 s33, s33, s36
  s_add_u32 s34, s34, 172032
  v_mfma_f32_16x16x32_bf16 v[24:27], v[28:31], v[56:59], v[24:27]
  s_add_u32 s40, s40, 32768
  s_cmp_eq_u32 s40, 163840
  s_cselect_b32 s40, 0, s40
  s_add_u32 s44, s44, 1
  s_cmp_lt_u32 s44, 4
  s_cbranch_scc1 K1loopA_22
K1loopB_23:
  s_waitcnt lgkmcnt(0)
  v_mfma_f32_32x32x16_bf16 v[64:79], v[40:43], v[32:35], v[64:79]
  ds_read_b128 v[48:51], v13
  ds_read_b64_tr_b16 v[56:57], v20 offset:2048
  v_mfma_f32_32x32x16_bf16 v[80:95], v[40:43], v[36:39], v[80:95]
  ds_read_b64_tr_b16 v[58:59], v20 offset:2560
  ds_read_b128 v[52:55], v17
  v_mfma_f32_32x32x16_bf16 v[96:111], v[32:35], v[44:47], v[96:111]
  ds_read_b64_tr_b16 v[60:61], v20 offset:10240
  ds_read_b64_tr_b16 v[62:63], v20 offset:10752
  v_mfma_f32_32x32x16_bf16 v[112:127], v[36:39], v[44:47], v[112:127]
  v_mfma_f32_16x16x32_bf16 v[24:27], v[28:31], v[40:43], v[24:27]
  s_waitcnt lgkmcnt(0)
  v_mfma_f32_32x32x16_bf16 v[64:79], v[56:59], v[48:51], v[64:79]
  ds_read_b128 v[32:35], v14
  ds_read_b64_tr_b16 v[40:41], v20 offset:4096
  v_mfma_f32_32x32x16_bf16 v[80:95], v[56:59], v[52:55], v[80:95]
  ds_read_b64_tr_b16 v[42:43], v20 offset:4608
  ds_read_b128 v[36:39], v18
  v_mfma_f32_32x32x16_bf16 v[96:111], v[48:51], v[60:63], v[96:111]
  ds_read_b64_tr_b16 v[44:45], v20 offset:12288
  ds_read_b64_tr_b16 v[46:47], v20 offset:12800
  v_mfma_f32_32x32x16_bf16 v[112:127], v[52:55], v[60:63], v[112:127]
  v_mfma_f32_16x16x32_bf16 v[24:27], v[28:31], v[56:59], v[24:27]
  s_waitcnt lgkmcnt(0)
  v_mfma_f32_32x32x16_bf16 v[64:79], v[40:43], v[32:35], v[64:79]
  ds_read_b128 v[48:51], v15
  ds_read_b64_tr_b16 v[56:57], v20 offset:6144
  v_mfma_f32_32x32x16_bf16 v[80:95], v[40:43], v[36:39], v[80:95]
  ds_read_b64_tr_b16 v[58:59], v20 offset:6656
  ds_read_b128 v[52:55], v19
  v_mfma_f32_32x32x16_bf16 v[96:111], v[32:35], v[44:47], v[96:111]
  ds_read_b64_tr_b16 v[60:61], v20 offset:14336
  ds_read_b64_tr_b16 v[62:63], v20 offset:14848
  v_mfma_f32_32x32x16_bf16 v[112:127], v[36:39], v[44:47], v[112:127]
  v_mfma_f32_16x16x32_bf16 v[24:27], v[28:31], v[40:43], v[24:27]
  s_cmp_eq_u32 s44, 6
  s_cbranch_scc1 wlast_24
  s_cmp_eq_u32 s44, 5
  s_cbranch_scc1 w0_25
  s_waitcnt vmcnt(8)
  s_branch go_26
w0_25:
  s_waitcnt vmcnt(0)
go_26:
  s_barrier
  s_cmp_eq_u32 s44, 4
  s_mov_b32 s29, 32768
  s_cselect_b32 s29, 0xfffe0000, s29
  v_add_u32 v12, s29, v12
  v_add_u32 v13, s29, v13
  v_add_u32 v14, s29, v14
  v_add_u32 v15, s29, v15
  v_add_u32 v16, s29, v16
  v_add_u32 v17, s29, v17
  v_add_u32 v18, s29, v18
  v_add_u32 v19, s29, v19
  v_add_u32 v20, s29, v20
  s_waitcnt lgkmcnt(0)
  v_mfma_f32_32x32x16_bf16 v[64:79], v[56:59], v[48:51], v[64:79]
  ds_read_b128 v[32:35], v12
  ds_read_b64_tr_b16 v[40:41], v20 offset:0
  v_mfma_f32_32x32x16_bf16 v[80:95], v[56:59], v[52:55], v[80:95]
  ds_read_b64_tr_b16 v[42:43], v20 offset:512
  ds_read_b128 v[36:39], v16
  v_mfma_f32_32x32x16_bf16 v[96:111], v[48:51], v[60:63], v[96:111]
  ds_read_b64_tr_b16 v[44:45], v20 offset:8192
  ds_read_b64_tr_b16 v[46:47], v20 offset:8704
  v_mfma_f32_32x32x16_bf16 v[112:127], v[52:55], v[60:63], v[112:127]
  v_mfma_f32_16x16x32_bf16 v[24:27], v[28:31], v[56:59], v[24:27]
  s_add_u32 s44, s44, 1
  s_branch K1loopB_23
wlast_24:
  s_waitcnt lgkmcnt(0)
  v_mfma_f32_32x32x16_bf16 v[64:79], v[56:59], v[48:51], v[64:79]
  v_mfma_f32_32x32x16_bf16 v[80:95], v[56:59], v[52:55], v[80:95]
  v_mfma_f32_32x32x16_bf16 v[96:111], v[48:51], v[60:63], v[96:111]
  v_mfma_f32_32x32x16_bf16 v[112:127], v[52:55], v[60:63], v[112:127]
  v_mfma_f32_16x16x32_bf16 v[24:27], v[28:31], v[56:59], v[24:27]
  s_nop 0
  s_branch K1epi_8
K1wm1_21:
  s_waitcnt vmcnt(16)
  s_barrier
  ds_read_b128 v[32:35], v12
  ds_read_b64_tr_b16 v[40:41], v20 offset:0
  ds_read_b64_tr_b16 v[42:43], v20 offset:512
  ds_read_b128 v[36:39], v16
  ds_read_b64_tr_b16 v[44:45], v20 offset:8192
  ds_read_b64_tr_b16 v[46:47], v20 offset:8704
  s_mov_b32 s44, 0
K1loopA_27:
  s_waitcnt lgkmcnt(0)
  v_mfma_f32_32x32x16_bf16 v[64:79], v[40:43], v[32:35], v[64:79]
  ds_read_b128 v[48:51], v13
  ds_read_b64_tr_b16 v[56:57], v20 offset:2048
  v_mfma_f32_32x32x16_bf16 v[80:95], v[40:43], v[36:39], v[80:95]
  ds_read_b64_tr_b16 v[58:59], v20 offset:2560
  ds_read_b128 v[52:55], v17
  s_add_u32 m0, s40, s37
  s_nop 0
  buffer_load_dwordx4 v8, s[8:11], s32 offen lds
  v_mfma_f32_32x32x16_bf16 v[96:111], v[32:35], v[44:47], v[96:111]
  ds_read_b64_tr_b16 v[60:61], v20 offset:10240
  ds_read_b64_tr_b16 v[62:63], v20 offset:10752
  v_mfma_f32_32x32x16_bf16 v[112:127], v[36:39], v[44:47], v[112:127]
  s_add_u32 m0, m0, 1024
  s_add_u32 s39, s32, 3584
  buffer_load_dwordx4 v9, s[8:11], s39 offen lds
  v_mfma_f32_16x16x32_bf16 v[24:27], v[28:31], v[44:47], v[24:27]
  s_waitcnt lgkmcnt(0)
  v_mfma_f32_32x32x16_bf16 v[64:79], v[56:59], v[48:51], v[64:79]
  ds_read_b128 v[32:35], v14
  ds_read_b64_tr_b16 v[40:41], v20 offset:4096
  v_mfma_f32_32x32x16_bf16 v[80:95], v[56:59], v[52:55], v[80:95]
  ds_read_b64_tr_b16 v[42:43], v20 offset:4608
  ds_read_b128 v[36:39], v18
  s_add_u32 m0, m0, 1024
  s_add_u32 s39, s32, 7168
  buffer_load_dwordx4 v8, s[8:11], s39 offen lds
  v_mfma_f32_32x32x16_bf16 v[96:111], v[48:51], v[60:63], v[96:111]
  ds_read_b64_tr_b16 v[44:45], v20 offset:12288
  ds_read_b64_tr_b16 v[46:47], v20 offset:12800
  v_mfma_f32_32x32x16_bf16 v[112:127], v[52:55], v[60:63], v[112:127]
  s_add_u32 m0, m0, 1024
  s_add_u32 s39, s32, 10752
  buffer_load_dwordx4 v9, s[8:11], s39 offen lds
  v_mfma_f32_16x16x32_bf16 v[24:27], v[28:31], v[60:63], v[24:27]
  s_waitcnt lgkmcnt(0)
  v_mfma_f32_32x32x16_bf16 v[64:79], v[40:43], v[32:35], v[64:79]
  ds_read_b128 v[48:51], v15
  ds_read_b64_tr_b16 v[56:57], v20 offset:6144
  v_mfma_f32_32x32x16_bf16 v[80:95], v[40:43], v[36:39], v[80:95]
  ds_read_b64_tr_b16 v[58:59], v20 offset:6656
  ds_read_b128 v[52:55], v19
  s_add_u32 m0, s40, s38
  s_nop 0
  buffer_load_dwordx4 v10, s[12:15], s33 offen lds
  v_mfma_f32_32x32x16_bf16 v[96:111], v[32:35], v[44:47], v[96:111]
  ds_read_b64_tr_b16 v[60:61], v20 offset:14336
  ds_read_b64_tr_b16 v[62:63], v20 offset:14848
  v_mfma_f32_32x32x16_bf16 v[112:127], v[36:39], v[44:47], v[112:127]
  s_add_u32 m0, m0, 1024
  s_add_u32 s39, s33, s35
  buffer_load_dwordx4 v10, s[12:15], s39 offen lds
  v_mfma_f32_16x16x32_bf16 v[24:27], v[28:31], v[44:47], v[24:27]
  s_waitcnt vmcnt(14)
  s_barrier
  v_add_u32 v12, 32768, v12
  v_add_u32 v13, 32768, v13
  v_add_u32 v14, 32768, v14
  v_add_u32 v15, 32768, v15
  v_add_u32 v16, 32768, v16
  v_add_u32 v17, 32768, v17
  v_add_u32 v18, 32768, v18
  v_add_u32 v19, 32768, v19
  v_add_u32 v20, 32768, v20
  s_waitcnt lgkmcnt(0)
  v_mfma_f32_32x32x16_bf16 v[64:79], v[56:59], v[48:51], v[64:79]
  ds_read_b128 v[32:35], v12
  ds_read_b64_tr_b16 v[40:41], v20 offset:0
  v_mfma_f32_32x32x16_bf16 v[80:95], v[56:59], v[52:55], v[80:95]
  ds_read_b64_tr_b16 v[42:43], v20 offset:512
  ds_read_b128 v[36:39], v16
  s_add_u32 m0, m0, 7168
  s_nop 0
  buffer_load_dwordx4 v11, s[16:19], s34 offen lds
  v_mfma_f32_32x32x16_bf16 v[96:111], v[48:51], v[60:63], v[96:111]
  ds_read_b64_tr_b16 v[44:45], v20 offset:8192
  ds_read_b64_tr_b16 v[46:47], v20 offset:8704
  v_mfma_f32_32x32x16_bf16 v[112:127], v[52:55], v[60:63], v[112:127]
  s_add_u32 m0, m0, 1024
  s_add_u32 s39, s34, 21504
  buffer_load_dwordx4 v11, s[16:19], s39 offen lds
  s_add_u32 s32, s32, 128
  s_add_u32 s33, s33, s36
  s_add_u32 s34, s34, 172032
  v_mfma_f32_16x16x32_bf16 v[24:27], v[28:31], v[60:63], v[24:27]
  s_add_u32 s40, s40, 32768
  s_cmp_eq_u32 s40, 163840
  s_cselect_b32 s40, 0, s40
  s_add_u32 s44, s44, 1
  s_cmp_lt_u32 s44, 4
  s_cbranch_scc1 K1loopA_27
K1loopB_28:
  s_waitcnt lgkmcnt(0)
  v_mfma_f32_32x32x16_bf16 v[64:79], v[40:43], v[32:35], v[64:79]
  ds_read_b128 v[48:51], v13
  ds_read_b64_tr_b16 v[56:57], v20 offset:2048
  v_mfma_f32_32x32x16_bf16 v[80:95], v[40:43], v[36:39], v[80:95]
  ds_read_b64_tr_b16 v[58:59], v20 offset:2560
  ds_read_b128 v[52:55], v17
  v_mfma_f32_32x32x16_bf16 v[96:111], v[32:35], v[44:47], v[96:111]
  ds_read_b64_tr_b16 v[60:61], v20 offset:10240
  ds_read_b64_tr_b16 v[62:63], v20 offset:10752
  v_mfma_f32_32x32x16_bf16 v[112:127], v[36:39], v[44:47], v[112:127]
  v_mfma_f32_16x16x32_bf16 v[24:27], v[28:31], v[44:47], v[24:27]
  s_waitcnt lgkmcnt(0)
  v_mfma_f32_32x32x16_bf16 v[64:79], v[56:59], v[48:51], v[64:79]
  ds_read_b128 v[32:35], v14
  ds_read_b64_tr_b16 v[40:41], v20 offset:4096
  v_mfma_f32_32x32x16_bf16 v[80:95], v[56:59], v[52:55], v[80:95]
  ds_read_b64_tr_b16 v[42:43], v20 offset:4608
  ds_read_b128 v[36:39], v18
  v_mfma_f32_32x32x16_bf16 v[96:111], v[48:51], v[60:63], v[96:111]
  ds_read_b64_tr_b16 v[44:45], v20 offset:12288
  ds_read_b64_tr_b16 v[46:47], v20 offset:12800
  v_mfma_f32_32x32x16_bf16 v[112:127], v[52:55], v[60:63], v[112:127]
  v_mfma_f32_16x16x32_bf16 v[24:27], v[28:31], v[60:63], v[24:27]
  s_waitcnt lgkmcnt(0)
  v_mfma_f32_32x32x16_bf16 v[64:79], v[40:43], v[32:35], v[64:79]
  ds_read_b128 v[48:51], v15
  ds_read_b64_tr_b16 v[56:57], v20 offset:6144
  v_mfma_f32_32x32x16_bf16 v[80:95], v[40:43], v[36:39], v[80:95]
  ds_read_b64_tr_b16 v[58:59], v20 offset:6656
  ds_read_b128 v[52:55], v19
  v_mfma_f32_32x32x16_bf16 v[96:111], v[32:35], v[44:47], v[96:111]
  ds_read_b64_tr_b16 v[60:61], v20 offset:14336
  ds_read_b64_tr_b16 v[62:63], v20 offset:14848
  v_mfma_f32_32x32x16_bf16 v[112:127], v[36:39], v[44:47], v[112:127]
  v_mfma_f32_16x16x32_bf16 v[24:27], v[28:31], v[44:47], v[24:27]
  s_cmp_eq_u32 s44, 6
  s_cbranch_scc1 wlast_29
  s_cmp_eq_u32 s44, 5
  s_cbranch_scc1 w0_30
  s_waitcnt vmcnt(8)
  s_branch go_31
w0_30:
  s_waitcnt vmcnt(0)
go_31:
  s_barrier
  s_cmp_eq_u32 s44, 4
  s_mov_b32 s29, 32768
  s_cselect_b32 s29, 0xfffe0000, s29
  v_add_u32 v12, s29, v12
  v_add_u32 v13, s29, v13
  v_add_u32 v14, s29, v14
  v_add_u32 v15, s29, v15
  v_add_u32 v16, s29, v16
  v_add_u32 v17, s29, v17
  v_add_u32 v18, s29, v18
  v_add_u32 v19, s29, v19
  v_add_u32 v20, s29, v20
  s_waitcnt lgkmcnt(0)
  v_mfma_f32_32x32x16_bf16 v[64:79], v[56:59], v[48:51], v[64:79]
  ds_read_b128 v[32:35], v12
  ds_read_b64_tr_b16 v[40:41], v20 offset:0
  v_mfma_f32_32x32x16_bf16 v[80:95], v[56:59], v[52:55], v[80:95]
  ds_read_b64_tr_b16 v[42:43], v20 offset:512
  ds_read_b128 v[36:39], v16
  v_mfma_f32_32x32x16_bf16 v[96:111], v[48:51], v[60:63], v[96:111]
  ds_read_b64_tr_b16 v[44:45], v20 offset:8192
  ds_read_b64_tr_b16 v[46:47], v20 offset:8704
  v_mfma_f32_32x32x16_bf16 v[112:127], v[52:55], v[60:63], v[112:127]
  v_mfma_f32_16x16x32_bf16 v[24:27], v[28:31], v[60:63], v[24:27]
  s_add_u32 s44, s44, 1
  s_branch K1loopB_28
wlast_29:
  s_waitcnt lgkmcnt(0)
  v_mfma_f32_32x32x16_bf16 v[64:79], v[56:59], v[48:51], v[64:79]
  v_mfma_f32_32x32x16_bf16 v[80:95], v[56:59], v[52:55], v[80:95]
  v_mfma_f32_32x32x16_bf16 v[96:111], v[48:51], v[60:63], v[96:111]
  v_mfma_f32_32x32x16_bf16 v[112:127], v[52:55], v[60:63], v[112:127]
  v_mfma_f32_16x16x32_bf16 v[24:27], v[28:31], v[60:63], v[24:27]
  s_nop 0
  s_branch K1epi_8
K1epi_8:
  s_lshl_b32 s29, s5, 7
  s_lshl_b32 s30, s4, 8
  s_add_u32 s29, s29, s30
  s_add_u32 s29, s29, 67072
  v_lshl_add_u32 v4, v0, 2, s29
  s_mov_b64 exec, 0xffff
  ds_write_b32 v4, v24
  ds_write_b32 v4, v25 offset:64
  s_mov_b64 exec, -1
  v_and_b32 v2, 31, v0
  v_and_b32 v6, 3, v2
  v_lshrrev_b32 v3, 3, v2
  v_lshl_add_u32 v6, v3, 2, v6
  v_bfe_u32 v3, v2, 2, 1
  v_lshl_add_u32 v6, v3, 4, v6
  v_lshrrev_b32 v7, 5, v0
  s_waitcnt lgkmcnt(0)
  s_barrier
  v_and_b32 v2, 31, v0
  s_lshl_b32 s29, s41, 7
  s_add_u32 s29, s29, 65536
  v_lshl_add_u32 v3, v2, 2, s29
  s_lshl_b32 s29, s42, 7
  s_add_u32 s29, s29, 65536
  v_lshl_add_u32 v4, v2, 2, s29
  ds_read_b32 v32, v3
  ds_read_b32 v33, v3 offset:512
  ds_read_b32 v34, v3 offset:1024
  ds_read_b32 v35, v4
  ds_read_b32 v36, v4 offset:512
  ds_read_b32 v37, v4 offset:1024
  s_lshl_b32 s29, s5, 7
  s_add_u32 s29, s29, 67072
  v_lshl_add_u32 v5, v7, 4, s29
  ds_read_b128 v[40:43], v5 offset:0
  ds_read_b128 v[44:47], v5 offset:32
  ds_read_b128 v[48:51], v5 offset:64
  ds_read_b128 v[52:55], v5 offset:96
  s_cmp_eq_u32 s25, 1
  s_cbranch_scc1 ekv_32
  ds_read_b128 v[8:11], v5 offset:256
  ds_read_b128 v[12:15], v5 offset:288
  ds_read_b128 v[16:19], v5 offset:320
  ds_read_b128 v[20:23], v5 offset:352
  s_waitcnt lgkmcnt(0)
  s_or_b32 s29, s24, s25
  s_cmp_lg_u32 s29, 0
  s_cbranch_scc1 nost_34
  s_lshl_b32 s29, s6, 7
  s_lshl_b32 s30, s41, 5
  s_add_u32 s29, s29, s30
  s_lshl_b32 s29, s29, 3
  s_add_u32 s29, s29, 8323072
  v_lshlrev_b32 v3, 3, v6
  buffer_store_dwordx2 v[32:33], v3, s[20:23], s29 offen sc1
nost_34:
  v_mul_f32 v38, v32, v34
  v_mul_f32 v39, v33, v34
  v_mul_f32 v56, v35, v37
  v_mul_f32 v57, v36, v37
  v_mul_f32 v64, v64, v38
  v_fma_f32 v64, v39, v40, v64
  v_mul_f32 v65, v65, v38
  v_fma_f32 v65, v39, v41, v65
  v_mul_f32 v66, v66, v38
  v_fma_f32 v66, v39, v42, v66
  v_mul_f32 v67, v67, v38
  v_fma_f32 v67, v39, v43, v67
  v_mul_f32 v68, v68, v38
  v_fma_f32 v68, v39, v44, v68
  v_mul_f32 v69, v69, v38
  v_fma_f32 v69, v39, v45, v69
  v_mul_f32 v70, v70, v38
  v_fma_f32 v70, v39, v46, v70
  v_mul_f32 v71, v71, v38
  v_fma_f32 v71, v39, v47, v71
  v_mul_f32 v72, v72, v38
  v_fma_f32 v72, v39, v48, v72
  v_mul_f32 v73, v73, v38
  v_fma_f32 v73, v39, v49, v73
  v_mul_f32 v74, v74, v38
  v_fma_f32 v74, v39, v50, v74
  v_mul_f32 v75, v75, v38
  v_fma_f32 v75, v39, v51, v75
  v_mul_f32 v76, v76, v38
  v_fma_f32 v76, v39, v52, v76
  v_mul_f32 v77, v77, v38
  v_fma_f32 v77, v39, v53, v77
  v_mul_f32 v78, v78, v38
  v_fma_f32 v78, v39, v54, v78
  v_mul_f32 v79, v79, v38
  v_fma_f32 v79, v39, v55, v79
  v_mul_f32 v80, v80, v56
  v_fma_f32 v80, v57, v40, v80
  v_mul_f32 v81, v81, v56
  v_fma_f32 v81, v57, v41, v81
  v_mul_f32 v82, v82, v56
  v_fma_f32 v82, v57, v42, v82
  v_mul_f32 v83, v83, v56
  v_fma_f32 v83, v57, v43, v83
  v_mul_f32 v84, v84, v56
  v_fma_f32 v84, v57, v44, v84
  v_mul_f32 v85, v85, v56
  v_fma_f32 v85, v57, v45, v85
  v_mul_f32 v86, v86, v56
  v_fma_f32 v86, v57, v46, v86
  v_mul_f32 v87, v87, v56
  v_fma_f32 v87, v57, v47, v87
  v_mul_f32 v88, v88, v56
  v_fma_f32 v88, v57, v48, v88
  v_mul_f32 v89, v89, v56
  v_fma_f32 v89, v57, v49, v89
  v_mul_f32 v90, v90, v56
  v_fma_f32 v90, v57, v50, v90
  v_mul_f32 v91, v91, v56
  v_fma_f32 v91, v57, v51, v91
  v_mul_f32 v92, v92, v56
  v_fma_f32 v92, v57, v52, v92
  v_mul_f32 v93, v93, v56
  v_fma_f32 v93, v57, v53, v93
  v_mul_f32 v94, v94, v56
  v_fma_f32 v94, v57, v54, v94
  v_mul_f32 v95, v95, v56
  v_fma_f32 v95, v57, v55, v95
  v_mov_b32 v58, 0xc0135761
  v_mov_b32 v59, 0xc0135761
  v_mov_b32 v60, 0xbdd2d3e8
  v_mov_b32 v61, 0xbdd2d3e8
  v_pk_mul_f32 v[40:41], v[64:65], v[64:65]
  v_pk_mul_f32 v[42:43], v[66:67], v[66:67]
  v_pk_mul_f32 v[44:45], v[68:69], v[68:69]
  v_pk_mul_f32 v[46:47], v[70:71], v[70:71]
  v_pk_mul_f32 v[48:49], v[72:73], v[72:73]
  v_pk_mul_f32 v[50:51], v[74:75], v[74:75]
  v_pk_mul_f32 v[52:53], v[76:77], v[76:77]
  v_pk_mul_f32 v[54:55], v[78:79], v[78:79]
  v_pk_fma_f32 v[40:41], v[40:41], v[60:61], v[58:59]
  v_pk_fma_f32 v[42:43], v[42:43], v[60:61], v[58:59]
  v_pk_fma_f32 v[44:45], v[44:45], v[60:61], v[58:59]
  v_pk_fma_f32 v[46:47], v[46:47], v[60:61], v[58:59]
  v_pk_fma_f32 v[48:49], v[48:49], v[60:61], v[58:59]
  v_pk_fma_f32 v[50:51], v[50:51], v[60:61], v[58:59]
  v_pk_fma_f32 v[52:53], v[52:53], v[60:61], v[58:59]
  v_pk_fma_f32 v[54:55], v[54:55], v[60:61], v[58:59]
  v_pk_mul_f32 v[40:41], v[40:41], v[64:65]
  v_pk_mul_f32 v[42:43], v[42:43], v[66:67]
  v_pk_mul_f32 v[44:45], v[44:45], v[68:69]
  v_pk_mul_f32 v[46:47], v[46:47], v[70:71]
  v_pk_mul_f32 v[48:49], v[48:49], v[72:73]
  v_pk_mul_f32 v[50:51], v[50:51], v[74:75]
  v_pk_mul_f32 v[52:53], v[52:53], v[76:77]
  v_pk_mul_f32 v[54:55], v[54:55], v[78:79]
  v_exp_f32 v40, v40
  v_exp_f32 v41, v41
  v_exp_f32 v42, v42
  v_exp_f32 v43, v43
  v_exp_f32 v44, v44
  v_exp_f32 v45, v45
  v_exp_f32 v46, v46
  v_exp_f32 v47, v47
  v_exp_f32 v48, v48
  v_exp_f32 v49, v49
  v_exp_f32 v50, v50
  v_exp_f32 v51, v51
  v_exp_f32 v52, v52
  v_exp_f32 v53, v53
  v_exp_f32 v54, v54
  v_exp_f32 v55, v55
  v_pk_add_f32 v[40:41], v[40:41], 1.0 op_sel_hi:[1,0]
  v_pk_add_f32 v[42:43], v[42:43], 1.0 op_sel_hi:[1,0]
  v_pk_add_f32 v[44:45], v[44:45], 1.0 op_sel_hi:[1,0]
  v_pk_add_f32 v[46:47], v[46:47], 1.0 op_sel_hi:[1,0]
  v_pk_add_f32 v[48:49], v[48:49], 1.0 op_sel_hi:[1,0]
  v_pk_add_f32 v[50:51], v[50:51], 1.0 op_sel_hi:[1,0]
  v_pk_add_f32 v[52:53], v[52:53], 1.0 op_sel_hi:[1,0]
  v_pk_add_f32 v[54:55], v[54:55], 1.0 op_sel_hi:[1,0]
  v_rcp_f32 v40, v40
  v_rcp_f32 v41, v41
  v_rcp_f32 v42, v42
  v_rcp_f32 v43, v43
  v_rcp_f32 v44, v44
  v_rcp_f32 v45, v45
  v_rcp_f32 v46, v46
  v_rcp_f32 v47, v47
  v_rcp_f32 v48, v48
  v_rcp_f32 v49, v49
  v_rcp_f32 v50, v50
  v_rcp_f32 v51, v51
  v_rcp_f32 v52, v52
  v_rcp_f32 v53, v53
  v_rcp_f32 v54, v54
  v_rcp_f32 v55, v55
  v_pk_mul_f32 v[64:65], v[64:65], v[40:41]
  v_pk_mul_f32 v[66:67], v[66:67], v[42:43]
  v_pk_mul_f32 v[68:69], v[68:69], v[44:45]
  v_pk_mul_f32 v[70:71], v[70:71], v[46:47]
  v_pk_mul_f32 v[72:73], v[72:73], v[48:49]
  v_pk_mul_f32 v[74:75], v[74:75], v[50:51]
  v_pk_mul_f32 v[76:77], v[76:77], v[52:53]
  v_pk_mul_f32 v[78:79], v[78:79], v[54:55]
  v_pk_mul_f32 v[40:41], v[80:81], v[80:81]
  v_pk_mul_f32 v[42:43], v[82:83], v[82:83]
  v_pk_mul_f32 v[44:45], v[84:85], v[84:85]
  v_pk_mul_f32 v[46:47], v[86:87], v[86:87]
  v_pk_mul_f32 v[48:49], v[88:89], v[88:89]
  v_pk_mul_f32 v[50:51], v[90:91], v[90:91]
  v_pk_mul_f32 v[52:53], v[92:93], v[92:93]
  v_pk_mul_f32 v[54:55], v[94:95], v[94:95]
  v_pk_fma_f32 v[40:41], v[40:41], v[60:61], v[58:59]
  v_pk_fma_f32 v[42:43], v[42:43], v[60:61], v[58:59]
  v_pk_fma_f32 v[44:45], v[44:45], v[60:61], v[58:59]
  v_pk_fma_f32 v[46:47], v[46:47], v[60:61], v[58:59]
  v_pk_fma_f32 v[48:49], v[48:49], v[60:61], v[58:59]
  v_pk_fma_f32 v[50:51], v[50:51], v[60:61], v[58:59]
  v_pk_fma_f32 v[52:53], v[52:53], v[60:61], v[58:59]
  v_pk_fma_f32 v[54:55], v[54:55], v[60:61], v[58:59]
  v_pk_mul_f32 v[40:41], v[40:41], v[80:81]
  v_pk_mul_f32 v[42:43], v[42:43], v[82:83]
  v_pk_mul_f32 v[44:45], v[44:45], v[84:85]
  v_pk_mul_f32 v[46:47], v[46:47], v[86:87]
  v_pk_mul_f32 v[48:49], v[48:49], v[88:89]
  v_pk_mul_f32 v[50:51], v[50:51], v[90:91]
  v_pk_mul_f32 v[52:53], v[52:53], v[92:93]
  v_pk_mul_f32 v[54:55], v[54:55], v[94:95]
  v_exp_f32 v40, v40
  v_exp_f32 v41, v41
  v_exp_f32 v42, v42
  v_exp_f32 v43, v43
  v_exp_f32 v44, v44
  v_exp_f32 v45, v45
  v_exp_f32 v46, v46
  v_exp_f32 v47, v47
  v_exp_f32 v48, v48
  v_exp_f32 v49, v49
  v_exp_f32 v50, v50
  v_exp_f32 v51, v51
  v_exp_f32 v52, v52
  v_exp_f32 v53, v53
  v_exp_f32 v54, v54
  v_exp_f32 v55, v55
  v_pk_add_f32 v[40:41], v[40:41], 1.0 op_sel_hi:[1,0]
  v_pk_add_f32 v[42:43], v[42:43], 1.0 op_sel_hi:[1,0]
  v_pk_add_f32 v[44:45], v[44:45], 1.0 op_sel_hi:[1,0]
  v_pk_add_f32 v[46:47], v[46:47], 1.0 op_sel_hi:[1,0]
  v_pk_add_f32 v[48:49], v[48:49], 1.0 op_sel_hi:[1,0]
  v_pk_add_f32 v[50:51], v[50:51], 1.0 op_sel_hi:[1,0]
  v_pk_add_f32 v[52:53], v[52:53], 1.0 op_sel_hi:[1,0]
  v_pk_add_f32 v[54:55], v[54:55], 1.0 op_sel_hi:[1,0]
  v_rcp_f32 v40, v40
  v_rcp_f32 v41, v41
  v_rcp_f32 v42, v42
  v_rcp_f32 v43, v43
  v_rcp_f32 v44, v44
  v_rcp_f32 v45, v45
  v_rcp_f32 v46, v46
  v_rcp_f32 v47, v47
  v_rcp_f32 v48, v48
  v_rcp_f32 v49, v49
  v_rcp_f32 v50, v50
  v_rcp_f32 v51, v51
  v_rcp_f32 v52, v52
  v_rcp_f32 v53, v53
  v_rcp_f32 v54, v54
  v_rcp_f32 v55, v55
  v_pk_mul_f32 v[80:81], v[80:81], v[40:41]
  v_pk_mul_f32 v[82:83], v[82:83], v[42:43]
  v_pk_mul_f32 v[84:85], v[84:85], v[44:45]
  v_pk_mul_f32 v[86:87], v[86:87], v[46:47]
  v_pk_mul_f32 v[88:89], v[88:89], v[48:49]
  v_pk_mul_f32 v[90:91], v[90:91], v[50:51]
  v_pk_mul_f32 v[92:93], v[92:93], v[52:53]
  v_pk_mul_f32 v[94:95], v[94:95], v[54:55]
  v_cvt_pk_bf16_f32 v64, v64, v65
  v_cvt_pk_bf16_f32 v65, v66, v67
  v_cvt_pk_bf16_f32 v66, v68, v69
  v_cvt_pk_bf16_f32 v67, v70, v71
  v_cvt_pk_bf16_f32 v68, v72, v73
  v_cvt_pk_bf16_f32 v69, v74, v75
  v_cvt_pk_bf16_f32 v70, v76, v77
  v_cvt_pk_bf16_f32 v71, v78, v79
  v_cvt_pk_bf16_f32 v72, v80, v81
  v_cvt_pk_bf16_f32 v73, v82, v83
  v_cvt_pk_bf16_f32 v74, v84, v85
  v_cvt_pk_bf16_f32 v75, v86, v87
  v_cvt_pk_bf16_f32 v76, v88, v89
  v_cvt_pk_bf16_f32 v77, v90, v91
  v_cvt_pk_bf16_f32 v78, v92, v93
  v_cvt_pk_bf16_f32 v79, v94, v95
  v_mul_u32_u24 v2, 4128, v7
  v_add_u32 v2, v2, v6
  v_lshlrev_b32 v2, 4, v2
  s_lshl_b32 s29, s24, 3
  s_lshl_b32 s30, s5, 2
  s_add_u32 s29, s29, s30
  s_mul_i32 s29, s29, 2064
  s_lshl_b32 s30, s6, 7
  s_add_u32 s29, s29, s30
  s_add_u32 s29, s29, 8
  s_lshl_b32 s30, s41, 5
  s_add_u32 s30, s30, s29
  s_lshl_b32 s30, s30, 4
  s_add_u32 s30, s30, 6291456
  buffer_store_dwordx4 v[64:67], v2, s[20:23], s30 offen sc1
  s_add_u32 s30, s30, 33024
  buffer_store_dwordx4 v[68:71], v2, s[20:23], s30 offen sc1
  s_lshl_b32 s30, s42, 5
  s_add_u32 s30, s30, s29
  s_lshl_b32 s30, s30, 4
  s_add_u32 s30, s30, 6291456
  buffer_store_dwordx4 v[72:75], v2, s[20:23], s30 offen sc1
  s_add_u32 s30, s30, 33024
  buffer_store_dwordx4 v[76:79], v2, s[20:23], s30 offen sc1
  v_mul_f32 v32, 0x3e8b97f6, v32
  v_mul_f32 v33, 0x3e8b97f6, v33
  v_mul_f32 v35, 0x3e8b97f6, v35
  v_mul_f32 v36, 0x3e8b97f6, v36
  v_mul_f32 v96, v96, v32
  v_fma_f32 v96, v33, v8, v96
  v_mul_f32 v97, v97, v32
  v_fma_f32 v97, v33, v9, v97
  v_mul_f32 v98, v98, v32
  v_fma_f32 v98, v33, v10, v98
  v_mul_f32 v99, v99, v32
  v_fma_f32 v99, v33, v11, v99
  v_mul_f32 v100, v100, v32
  v_fma_f32 v100, v33, v12, v100
  v_mul_f32 v101, v101, v32
  v_fma_f32 v101, v33, v13, v101
  v_mul_f32 v102, v102, v32
  v_fma_f32 v102, v33, v14, v102
  v_mul_f32 v103, v103, v32
  v_fma_f32 v103, v33, v15, v103
  v_mul_f32 v104, v104, v32
  v_fma_f32 v104, v33, v16, v104
  v_mul_f32 v105, v105, v32
  v_fma_f32 v105, v33, v17, v105
  v_mul_f32 v106, v106, v32
  v_fma_f32 v106, v33, v18, v106
  v_mul_f32 v107, v107, v32
  v_fma_f32 v107, v33, v19, v107
  v_mul_f32 v108, v108, v32
  v_fma_f32 v108, v33, v20, v108
  v_mul_f32 v109, v109, v32
  v_fma_f32 v109, v33, v21, v109
  v_mul_f32 v110, v110, v32
  v_fma_f32 v110, v33, v22, v110
  v_mul_f32 v111, v111, v32
  v_fma_f32 v111, v33, v23, v111
  v_mul_f32 v112, v112, v35
  v_fma_f32 v112, v36, v8, v112
  v_mul_f32 v113, v113, v35
  v_fma_f32 v113, v36, v9, v113
  v_mul_f32 v114, v114, v35
  v_fma_f32 v114, v36, v10, v114
  v_mul_f32 v115, v115, v35
  v_fma_f32 v115, v36, v11, v115
  v_mul_f32 v116, v116, v35
  v_fma_f32 v116, v36, v12, v116
  v_mul_f32 v117, v117, v35
  v_fma_f32 v117, v36, v13, v117
  v_mul_f32 v118, v118, v35
  v_fma_f32 v118, v36, v14, v118
  v_mul_f32 v119, v119, v35
  v_fma_f32 v119, v36, v15, v119
  v_mul_f32 v120, v120, v35
  v_fma_f32 v120, v36, v16, v120
  v_mul_f32 v121, v121, v35
  v_fma_f32 v121, v36, v17, v121
  v_mul_f32 v122, v122, v35
  v_fma_f32 v122, v36, v18, v122
  v_mul_f32 v123, v123, v35
  v_fma_f32 v123, v36, v19, v123
  v_mul_f32 v124, v124, v35
  v_fma_f32 v124, v36, v20, v124
  v_mul_f32 v125, v125, v35
  v_fma_f32 v125, v36, v21, v125
  v_mul_f32 v126, v126, v35
  v_fma_f32 v126, v36, v22, v126
  v_mul_f32 v127, v127, v35
  v_fma_f32 v127, v36, v23, v127
  s_mov_b32 s45, 0
  s_branch qkstore_35
ekv_32:
  v_and_b32 v2, 31, v0
  v_lshl_add_u32 v3, v2, 2, s29
  ds_read_b32 v38, v3 offset:256
  s_lshl_b32 s29, s41, 7
  s_add_u32 s29, s29, 65536
  v_lshl_add_u32 v3, v7, 4, s29
  s_lshl_b32 s29, s42, 7
  s_add_u32 s29, s29, 65536
  v_lshl_add_u32 v4, v7, 4, s29
  ds_read_b128 v[8:11], v3 offset:0
  ds_read_b128 v[12:15], v3 offset:32
  ds_read_b128 v[16:19], v3 offset:64
  ds_read_b128 v[20:23], v3 offset:96
  ds_read_b128 v[128:131], v3 offset:512
  ds_read_b128 v[132:135], v3 offset:544
  ds_read_b128 v[136:139], v3 offset:576
  ds_read_b128 v[140:143], v3 offset:608
  ds_read_b128 v[144:147], v4 offset:0
  ds_read_b128 v[148:151], v4 offset:32
  ds_read_b128 v[152:155], v4 offset:64
  ds_read_b128 v[156:159], v4 offset:96
  ds_read_b128 v[160:163], v4 offset:512
  ds_read_b128 v[164:167], v4 offset:544
  ds_read_b128 v[168:171], v4 offset:576
  ds_read_b128 v[172:175], v4 offset:608
  s_waitcnt lgkmcnt(0)
  v_mul_f32 v96, v96, v8
  v_fma_f32 v96, v128, v38, v96
  v_mul_f32 v97, v97, v9
  v_fma_f32 v97, v129, v38, v97
  v_mul_f32 v98, v98, v10
  v_fma_f32 v98, v130, v38, v98
  v_mul_f32 v99, v99, v11
  v_fma_f32 v99, v131, v38, v99
  v_mul_f32 v100, v100, v12
  v_fma_f32 v100, v132, v38, v100
  v_mul_f32 v101, v101, v13
  v_fma_f32 v101, v133, v38, v101
  v_mul_f32 v102, v102, v14
  v_fma_f32 v102, v134, v38, v102
  v_mul_f32 v103, v103, v15
  v_fma_f32 v103, v135, v38, v103
  v_mul_f32 v104, v104, v16
  v_fma_f32 v104, v136, v38, v104
  v_mul_f32 v105, v105, v17
  v_fma_f32 v105, v137, v38, v105
  v_mul_f32 v106, v106, v18
  v_fma_f32 v106, v138, v38, v106
  v_mul_f32 v107, v107, v19
  v_fma_f32 v107, v139, v38, v107
  v_mul_f32 v108, v108, v20
  v_fma_f32 v108, v140, v38, v108
  v_mul_f32 v109, v109, v21
  v_fma_f32 v109, v141, v38, v109
  v_mul_f32 v110, v110, v22
  v_fma_f32 v110, v142, v38, v110
  v_mul_f32 v111, v111, v23
  v_fma_f32 v111, v143, v38, v111
  v_mul_f32 v112, v112, v144
  v_fma_f32 v112, v160, v38, v112
  v_mul_f32 v113, v113, v145
  v_fma_f32 v113, v161, v38, v113
  v_mul_f32 v114, v114, v146
  v_fma_f32 v114, v162, v38, v114
  v_mul_f32 v115, v115, v147
  v_fma_f32 v115, v163, v38, v115
  v_mul_f32 v116, v116, v148
  v_fma_f32 v116, v164, v38, v116
  v_mul_f32 v117, v117, v149
  v_fma_f32 v117, v165, v38, v117
  v_mul_f32 v118, v118, v150
  v_fma_f32 v118, v166, v38, v118
  v_mul_f32 v119, v119, v151
  v_fma_f32 v119, v167, v38, v119
  v_mul_f32 v120, v120, v152
  v_fma_f32 v120, v168, v38, v120
  v_mul_f32 v121, v121, v153
  v_fma_f32 v121, v169, v38, v121
  v_mul_f32 v122, v122, v154
  v_fma_f32 v122, v170, v38, v122
  v_mul_f32 v123, v123, v155
  v_fma_f32 v123, v171, v38, v123
  v_mul_f32 v124, v124, v156
  v_fma_f32 v124, v172, v38, v124
  v_mul_f32 v125, v125, v157
  v_fma_f32 v125, v173, v38, v125
  v_mul_f32 v126, v126, v158
  v_fma_f32 v126, v174, v38, v126
  v_mul_f32 v127, v127, v159
  v_fma_f32 v127, v175, v38, v127
  v_cvt_pk_bf16_f32 v96, v96, v97
  v_cvt_pk_bf16_f32 v97, v98, v99
  v_cvt_pk_bf16_f32 v98, v100, v101
  v_cvt_pk_bf16_f32 v99, v102, v103
  v_cvt_pk_bf16_f32 v100, v104, v105
  v_cvt_pk_bf16_f32 v101, v106, v107
  v_cvt_pk_bf16_f32 v102, v108, v109
  v_cvt_pk_bf16_f32 v103, v110, v111
  v_cvt_pk_bf16_f32 v104, v112, v113
  v_cvt_pk_bf16_f32 v105, v114, v115
  v_cvt_pk_bf16_f32 v106, v116, v117
  v_cvt_pk_bf16_f32 v107, v118, v119
  v_cvt_pk_bf16_f32 v108, v120, v121
  v_cvt_pk_bf16_f32 v109, v122, v123
  v_cvt_pk_bf16_f32 v110, v124, v125
  v_cvt_pk_bf16_f32 v111, v126, v127
  s_lshl_b32 s29, s24, 6
  s_lshl_b32 s30, s5, 5
  s_add_u32 s29, s29, s30
  v_add_u32 v2, s29, v6
  v_mul_u32_u24 v3, 2341, v2
  v_lshrrev_b32 v3, 16, v3
  v_mul_u32_u24 v4, 28, v3
  v_sub_u32 v4, v2, v4
  v_bfe_u32 v5, v4, 2, 2
  v_lshlrev_b32 v5, 3, v5
  v_lshrrev_b32 v8, 4, v4
  v_lshl_add_u32 v5, v8, 2, v5
  v_and_b32 v8, 3, v4
  v_add_u32 v5, v5, v8
  v_lshl_add_u32 v5, v7, 5, v5
  v_lshlrev_b32 v5, 4, v5
  v_lshl_add_u32 v5, v3, 17, v5
  s_lshl_b32 s30, s6, 2
  s_add_u32 s30, s30, s41
  s_lshl_b32 s30, s30, 11
  s_add_u32 s30, s30, 4194304
  buffer_store_dwordx4 v[96:99], v5, s[20:23], s30 offen sc1
  buffer_store_dwordx4 v[100:103], v5, s[20:23], s30 offen offset:1024 sc1
  s_lshl_b32 s30, s6, 2
  s_add_u32 s30, s30, s42
  s_lshl_b32 s30, s30, 11
  s_add_u32 s30, s30, 4194304
  buffer_store_dwordx4 v[104:107], v5, s[20:23], s30 offen sc1
  buffer_store_dwordx4 v[108:111], v5, s[20:23], s30 offen offset:1024 sc1
  v_mul_f32 v64, v64, v32
  v_mul_f32 v65, v65, v32
  v_mul_f32 v66, v66, v32
  v_mul_f32 v67, v67, v32
  v_mul_f32 v68, v68, v32
  v_mul_f32 v69, v69, v32
  v_mul_f32 v70, v70, v32
  v_mul_f32 v71, v71, v32
  v_mul_f32 v72, v72, v32
  v_mul_f32 v73, v73, v32
  v_mul_f32 v74, v74, v32
  v_mul_f32 v75, v75, v32
  v_mul_f32 v76, v76, v32
  v_mul_f32 v77, v77, v32
  v_mul_f32 v78, v78, v32
  v_mul_f32 v79, v79, v32
  v_fma_f32 v96, v33, v40, v64
  v_fma_f32 v97, v33, v41, v65
  v_fma_f32 v98, v33, v42, v66
  v_fma_f32 v99, v33, v43, v67
  v_fma_f32 v100, v33, v44, v68
  v_fma_f32 v101, v33, v45, v69
  v_fma_f32 v102, v33, v46, v70
  v_fma_f32 v103, v33, v47, v71
  v_fma_f32 v104, v33, v48, v72
  v_fma_f32 v105, v33, v49, v73
  v_fma_f32 v106, v33, v50, v74
  v_fma_f32 v107, v33, v51, v75
  v_fma_f32 v108, v33, v52, v76
  v_fma_f32 v109, v33, v53, v77
  v_fma_f32 v110, v33, v54, v78
  v_fma_f32 v111, v33, v55, v79
  v_mul_f32 v80, v80, v35
  v_mul_f32 v81, v81, v35
  v_mul_f32 v82, v82, v35
  v_mul_f32 v83, v83, v35
  v_mul_f32 v84, v84, v35
  v_mul_f32 v85, v85, v35
  v_mul_f32 v86, v86, v35
  v_mul_f32 v87, v87, v35
  v_mul_f32 v88, v88, v35
  v_mul_f32 v89, v89, v35
  v_mul_f32 v90, v90, v35
  v_mul_f32 v91, v91, v35
  v_mul_f32 v92, v92, v35
  v_mul_f32 v93, v93, v35
  v_mul_f32 v94, v94, v35
  v_mul_f32 v95, v95, v35
  v_fma_f32 v112, v36, v40, v80
  v_fma_f32 v113, v36, v41, v81
  v_fma_f32 v114, v36, v42, v82
  v_fma_f32 v115, v36, v43, v83
  v_fma_f32 v116, v36, v44, v84
  v_fma_f32 v117, v36, v45, v85
  v_fma_f32 v118, v36, v46, v86
  v_fma_f32 v119, v36, v47, v87
  v_fma_f32 v120, v36, v48, v88
  v_fma_f32 v121, v36, v49, v89
  v_fma_f32 v122, v36, v50, v90
  v_fma_f32 v123, v36, v51, v91
  v_fma_f32 v124, v36, v52, v92
  v_fma_f32 v125, v36, v53, v93
  v_fma_f32 v126, v36, v54, v94
  v_fma_f32 v127, v36, v55, v95
  s_mov_b32 s45, 2097152
qkstore_35:
  v_cvt_pk_bf16_f32 v96, v96, v97
  v_cvt_pk_bf16_f32 v97, v98, v99
  v_cvt_pk_bf16_f32 v98, v100, v101
  v_cvt_pk_bf16_f32 v99, v102, v103
  v_cvt_pk_bf16_f32 v100, v104, v105
  v_cvt_pk_bf16_f32 v101, v106, v107
  v_cvt_pk_bf16_f32 v102, v108, v109
  v_cvt_pk_bf16_f32 v103, v110, v111
  v_cvt_pk_bf16_f32 v104, v112, v113
  v_cvt_pk_bf16_f32 v105, v114, v115
  v_cvt_pk_bf16_f32 v106, v116, v117
  v_cvt_pk_bf16_f32 v107, v118, v119
  v_cvt_pk_bf16_f32 v108, v120, v121
  v_cvt_pk_bf16_f32 v109, v122, v123
  v_cvt_pk_bf16_f32 v110, v124, v125
  v_cvt_pk_bf16_f32 v111, v126, v127
  s_lshl_b32 s29, s24, 4
  s_lshl_b32 s30, s5, 3
  s_add_u32 s29, s29, s30
  v_lshl_add_u32 v2, v7, 2, s29
  s_lshl_b32 s30, s6, 7
  s_lshl_b32 s31, s41, 5
  s_add_u32 s31, s31, s30
  s_lshl_b32 s31, s31, 4
  s_add_u32 s31, s31, s45
  s_lshl_b32 s46, s42, 5
  s_add_u32 s46, s46, s30
  s_lshl_b32 s46, s46, 4
  s_add_u32 s46, s46, s45
  v_mov_b32 v18, 0x3f803f80
  v_mov_b32 v19, 0
  v_mov_b32 v22, 0x3f803f80
  v_mov_b32 v23, 0
  s_mov_b32 s47, 0
  v_add_u32 v3, 0, v2
  v_mul_u32_u24 v4, 147, v3
  v_lshrrev_b32 v4, 10, v4
  v_mul_u32_u24 v5, 7, v4
  v_sub_u32 v5, v3, v5
  v_cmp_eq_u32 vcc, 6, v5
  v_lshrrev_b32 v8, 1, v5
  v_lshl_add_u32 v8, v4, 2, v8
  v_lshlrev_b32 v8, 15, v8
  v_lshl_add_u32 v12, v6, 4, v8
  s_cbranch_vccz nostr_36
  v_add_u32 v14, 0x20000, v12
  s_add_u32 s47, s47, 1
  v_mov_b32 v16, v98
  v_mov_b32 v17, v99
  v_mov_b32 v20, v106
  v_mov_b32 v21, v107
  s_mov_b64 exec, vcc
  buffer_store_dwordx4 v[16:19], v14, s[20:23], s31 offen sc1
  buffer_store_dwordx4 v[20:23], v14, s[20:23], s46 offen sc1
  v_mov_b32 v98, v18
  v_mov_b32 v99, v19
  v_mov_b32 v106, v18
  v_mov_b32 v107, v19
  s_mov_b64 exec, -1
  s_nop 1
nostr_36:
  buffer_store_dwordx4 v[96:99], v12, s[20:23], s31 offen sc1
  buffer_store_dwordx4 v[104:107], v12, s[20:23], s46 offen sc1
  v_add_u32 v3, 2, v2
  v_mul_u32_u24 v4, 147, v3
  v_lshrrev_b32 v4, 10, v4
  v_mul_u32_u24 v5, 7, v4
  v_sub_u32 v5, v3, v5
  v_cmp_eq_u32 vcc, 6, v5
  v_lshrrev_b32 v8, 1, v5
  v_lshl_add_u32 v8, v4, 2, v8
  v_lshlrev_b32 v8, 15, v8
  v_lshl_add_u32 v13, v6, 4, v8
  s_cbranch_vccz nostr_37
  v_add_u32 v14, 0x20000, v13
  s_add_u32 s47, s47, 1
  v_mov_b32 v16, v102
  v_mov_b32 v17, v103
  v_mov_b32 v20, v110
  v_mov_b32 v21, v111
  s_mov_b64 exec, vcc
  buffer_store_dwordx4 v[16:19], v14, s[20:23], s31 offen sc1
  buffer_store_dwordx4 v[20:23], v14, s[20:23], s46 offen sc1
  v_mov_b32 v102, v18
  v_mov_b32 v103, v19
  v_mov_b32 v110, v18
  v_mov_b32 v111, v19
  s_mov_b64 exec, -1
nostr_37:
  buffer_store_dwordx4 v[100:103], v13, s[20:23], s31 offen sc1
  buffer_store_dwordx4 v[108:111], v13, s[20:23], s46 offen sc1
  v_mov_b32 v1, 139328
  s_mov_b32 s59, 131072
  v_mov_b32 v3, 1
  s_mov_b64 exec, 1
  ds_add_u32 v1, v3 offset:64
  s_mov_b64 exec, -1
  s_cmp_eq_u32 s25, 1
  s_nop 0
  s_cbranch_scc1 nohf_38
  s_cmp_eq_u32 s47, 1
  s_cbranch_scc1 hf1_39
  s_cmp_eq_u32 s47, 2
  s_nop 0
  s_cbranch_scc1 hf2_40
  s_waitcnt vmcnt(4)
  s_nop 0
  s_branch hfg_41
hf1_39:
  s_waitcnt vmcnt(6)
  s_nop 0
  s_branch hfg_41
hf2_40:
  s_waitcnt vmcnt(8)
hfg_41:
  v_mov_b32 v3, 1
  s_mov_b64 exec, 1
  ds_add_rtn_u32 v2, v1, v3 offset:68
  s_mov_b64 exec, -1
  s_waitcnt lgkmcnt(0)
  v_readfirstlane_b32 s4, v2
  s_nop 0
  s_cmp_lg_u32 s4, 3
  s_nop 0
  s_cbranch_scc1 hnl_42
lw_43:
  ds_read_b32 v2, v1 offset:44
  s_waitcnt lgkmcnt(0)
  v_readfirstlane_b32 s4, v2
  s_nop 0
  s_cmp_ge_u32 s4, 1
  s_cbranch_scc1 lwd_44
  s_sub_u32 s59, s59, 1
  s_nop 0
  s_cbranch_scc0 lw_43
  s_mov_b32 s59, 0
lwd_44:
  s_lshl_b32 s4, s2, 7
  s_add_u32 s4, s4, 44605440
  v_mov_b32 v2, 0
  v_mov_b32 v3, 1
  s_mov_b64 exec, 1
  buffer_store_dword v3, v2, s[20:23], s4 offen sc1
  s_mov_b64 exec, -1
hnl_42:
nohf_38:
  s_waitcnt vmcnt(0)
  v_mov_b32 v1, 139328
  s_mov_b32 s59, 131072
  v_mov_b32 v3, 1
  s_mov_b64 exec, 1
  ds_add_rtn_u32 v2, v1, v3 offset:40
  s_mov_b64 exec, -1
  s_waitcnt lgkmcnt(0)
  v_readfirstlane_b32 s4, v2
  s_nop 0
  s_cmp_lg_u32 s4, 3
  s_cbranch_scc1 notlast_45
lw_46:
  ds_read_b32 v2, v1 offset:44
  s_waitcnt lgkmcnt(0)
  v_readfirstlane_b32 s4, v2
  s_nop 0
  s_cmp_ge_u32 s4, 1
  s_cbranch_scc1 lwd_47
  s_sub_u32 s59, s59, 1
  s_nop 0
  s_cbranch_scc0 lw_46
  s_mov_b32 s59, 0
lwd_47:
  s_lshl_b32 s4, s2, 7
  s_add_u32 s4, s4, 44564480
  v_mov_b32 v2, 0
  v_mov_b32 v3, 1
  s_mov_b64 exec, 1
  buffer_store_dword v3, v2, s[20:23], s4 offen sc1
  s_mov_b64 exec, -1
notlast_45:
  s_branch KMA_2
K1spare_4:
  s_waitcnt lgkmcnt(0)
  s_load_dwordx2 s[48:49], s[0:1], 72
  s_mov_b32 s50, 256
  s_mov_b32 s51, 0x00020000
  s_load_dwordx2 s[12:13], s[0:1], 48
  s_load_dwordx2 s[24:25], s[0:1], 40
  s_mov_b32 s14, 0x188000
  s_mov_b32 s15, 0x00020000
  s_mov_b32 s26, 0x62000
  s_mov_b32 s27, 0x00020000
  s_sub_u32 s4, s2, 224
  v_lshl_add_u32 v1, v1, 6, v0
  s_mul_i32 s28, s3, 16384
  v_lshlrev_b32 v14, 4, v0
  v_lshrrev_b32 v4, 5, v0
  v_lshlrev_b32 v13, 10, v4
  v_bfe_u32 v4, v0, 2, 2
  v_lshl_add_u32 v13, v4, 6, v13
  v_and_b32 v4, 1, v0
  v_lshl_add_u32 v13, v4, 5, v13
  v_bfe_u32 v4, v0, 4, 1
  v_lshl_add_u32 v13, v4, 4, v13
  v_bfe_u32 v4, v0, 1, 1
  v_lshl_add_u32 v13, v4, 3, v13
  v_add_u32 v13, s28, v13
  s_cmp_ge_u32 s4, 28
  s_cbranch_scc1 pkno_48
  s_lshl_b32 s5, s3, 2
  s_movk_i32 s43, 3584
  v_lshrrev_b32 v11, 5, v0
  v_bfe_u32 v12, v0, 2, 2
  v_lshl_add_u32 v11, v11, 2, v12
  v_mul_lo_u32 v10, v11, s43
  v_bfe_u32 v11, v0, 4, 1
  v_lshl_add_u32 v10, v11, 6, v10
  v_and_b32 v11, 3, v0
  v_lshl_add_u32 v10, v11, 4, v10
  v_add_u32 v11, 28672, v10
  s_mul_i32 s33, s5, 57344
  s_lshl_b32 s34, s4, 7
  s_add_u32 s33, s33, s34
  s_movk_i32 s43, 896
  v_lshrrev_b32 v9, 5, v0
  v_bfe_u32 v12, v0, 2, 2
  v_lshl_add_u32 v9, v9, 2, v12
  v_mul_lo_u32 v8, v9, s43
  v_bfe_u32 v9, v0, 4, 1
  v_lshl_add_u32 v8, v9, 6, v8
  v_and_b32 v9, 3, v0
  v_lshl_add_u32 v8, v9, 4, v8
  s_and_b32 s30, s4, 3
  s_mul_i32 s30, s30, 100352
  s_mul_i32 s31, s3, 14336
  s_add_u32 s30, s30, s31
  s_lshr_b32 s31, s4, 2
  s_lshl_b32 s31, s31, 7
  s_add_u32 s30, s30, s31
  v_add_u32 v8, s30, v8
  v_add_u32 v9, 7168, v8
  s_waitcnt lgkmcnt(0)
  s_add_u32 m0, s28, 8192
  s_nop 0
  buffer_load_dwordx4 v8, s[24:27], 0 offen lds
  s_add_u32 m0, m0, 1024
  s_nop 0
  buffer_load_dwordx4 v9, s[24:27], 0 offen lds
  s_mov_b32 m0, s28
  s_nop 0
  buffer_load_dwordx4 v10, s[12:15], s33 offen lds
  s_add_u32 m0, m0, 1024
  s_nop 0
  buffer_load_dwordx4 v11, s[12:15], s33 offen lds
  s_add_u32 m0, m0, 1024
  s_add_u32 s33, s33, 57344
  buffer_load_dwordx4 v10, s[12:15], s33 offen lds
  s_add_u32 m0, m0, 1024
  s_nop 0
  buffer_load_dwordx4 v11, s[12:15], s33 offen lds
  s_add_u32 m0, m0, 1024
  s_add_u32 s33, s33, 57344
  buffer_load_dwordx4 v10, s[12:15], s33 offen lds
  s_add_u32 m0, m0, 1024
  s_nop 0
  buffer_load_dwordx4 v11, s[12:15], s33 offen lds
  s_add_u32 m0, m0, 1024
  s_add_u32 s33, s33, 57344
  buffer_load_dwordx4 v10, s[12:15], s33 offen lds
  s_add_u32 m0, m0, 1024
  s_nop 0
  buffer_load_dwordx4 v11, s[12:15], s33 offen lds
  v_mov_b32 v28, 0x3f803f80
  v_mov_b32 v29, 0x3f803f80
  v_mov_b32 v30, 0x3f803f80
  v_mov_b32 v31, 0x3f803f80
  s_waitcnt vmcnt(0)
  ds_read_b64_tr_b16 v[80:81], v13 offset:8192
  ds_read_b64_tr_b16 v[82:83], v13 offset:8704
  ds_read_b64_tr_b16 v[84:85], v13 offset:8448
  ds_read_b64_tr_b16 v[86:87], v13 offset:8960
  s_mul_i32 s35, s4, 14336
  s_lshl_b32 s36, s3, 11
  s_add_u32 s35, s35, s36
  s_add_u32 s35, s35, 8388608
  s_waitcnt lgkmcnt(0)
  s_cmp_ge_u32 s3, 7
  s_cbranch_scc1 now2_49
  buffer_store_dwordx4 v[80:83], v14, s[20:23], s35 offen sc1
  buffer_store_dwordx4 v[84:87], v14, s[20:23], s35 offen offset:1024 sc1
now2_49:
  ds_read_b64_tr_b16 v[32:33], v13 offset:0
  ds_read_b64_tr_b16 v[34:35], v13 offset:512
  ds_read_b64_tr_b16 v[36:37], v13 offset:256
  ds_read_b64_tr_b16 v[38:39], v13 offset:768
  ds_read_b64_tr_b16 v[40:41], v13 offset:2048
  ds_read_b64_tr_b16 v[42:43], v13 offset:2560
  ds_read_b64_tr_b16 v[44:45], v13 offset:2304
  ds_read_b64_tr_b16 v[46:47], v13 offset:2816
  ds_read_b64_tr_b16 v[48:49], v13 offset:4096
  ds_read_b64_tr_b16 v[50:51], v13 offset:4608
  ds_read_b64_tr_b16 v[52:53], v13 offset:4352
  ds_read_b64_tr_b16 v[54:55], v13 offset:4864
  ds_read_b64_tr_b16 v[56:57], v13 offset:6144
  ds_read_b64_tr_b16 v[58:59], v13 offset:6656
  ds_read_b64_tr_b16 v[60:61], v13 offset:6400
  ds_read_b64_tr_b16 v[62:63], v13 offset:6912
  s_waitcnt lgkmcnt(0)
  v_mfma_f32_32x32x16_bf16 v[144:159], v[28:31], v[32:35], 0
  v_mfma_f32_32x32x16_bf16 v[160:175], v[28:31], v[36:39], 0
  v_mfma_f32_32x32x16_bf16 v[144:159], v[28:31], v[40:43], v[144:159]
  v_mfma_f32_32x32x16_bf16 v[160:175], v[28:31], v[44:47], v[160:175]
  v_mfma_f32_32x32x16_bf16 v[144:159], v[28:31], v[48:51], v[144:159]
  v_mfma_f32_32x32x16_bf16 v[160:175], v[28:31], v[52:55], v[160:175]
  v_mfma_f32_32x32x16_bf16 v[144:159], v[28:31], v[56:59], v[144:159]
  v_mfma_f32_32x32x16_bf16 v[160:175], v[28:31], v[60:63], v[160:175]
  v_lshlrev_b32 v2, 2, v0
  s_add_u32 s30, s28, 14336
  v_add_u32 v3, s30, v2
  v_add_u32 v4, 14336, v2
  v_add_u32 v7, 79872, v2
  s_nop 5
  ds_write_b32 v3, v144
  ds_write_b32 v3, v160 offset:256
  s_waitcnt lgkmcnt(0)
  s_barrier
  ds_read_b32 v96, v4 offset:0
  ds_read_b32 v97, v4 offset:256
  ds_read_b32 v98, v4 offset:16384
  ds_read_b32 v99, v4 offset:16640
  ds_read_b32 v100, v4 offset:32768
  ds_read_b32 v101, v4 offset:33024
  ds_read_b32 v102, v4 offset:49152
  ds_read_b32 v103, v4 offset:49408
  ds_read_b32 v104, v7 offset:0
  ds_read_b32 v105, v7 offset:256
  ds_read_b32 v106, v7 offset:16384
  ds_read_b32 v107, v7 offset:16640
  ds_read_b32 v108, v7 offset:32768
  ds_read_b32 v109, v7 offset:33024
  ds_read_b32 v110, v7 offset:49152
  ds_read_b32 v111, v7 offset:49408
  s_waitcnt lgkmcnt(0)
  v_add_f32 v96, v96, v104
  v_add_f32 v97, v97, v105
  v_add_f32 v98, v98, v106
  v_add_f32 v99, v99, v107
  v_add_f32 v100, v100, v108
  v_add_f32 v101, v101, v109
  v_add_f32 v102, v102, v110
  v_add_f32 v103, v103, v111
  v_add_f32 v96, v96, v100
  v_add_f32 v97, v97, v101
  v_add_f32 v98, v98, v102
  v_add_f32 v99, v99, v103
  v_add_f32 v96, v96, v98
  v_add_f32 v97, v97, v99
  v_mul_f32 v5, 0x3b124925, v96
  v_mul_f32 v6, 0x3b124925, v97
  s_mul_i32 s32, s4, 57344
  s_lshl_b32 s33, s5, 11
  s_add_u32 s32, s32, s33
  s_add_u32 s32, s32, 8912896
  v_lshlrev_b32 v16, 16, v32
  v_and_b32 v17, 0xffff0000, v32
  v_lshlrev_b32 v18, 16, v33
  v_and_b32 v19, 0xffff0000, v33
  v_lshlrev_b32 v20, 16, v34
  v_and_b32 v21, 0xffff0000, v34
  v_lshlrev_b32 v22, 16, v35
  v_and_b32 v23, 0xffff0000, v35
  v_sub_f32 v16, v16, v5
  v_sub_f32 v17, v17, v5
  v_sub_f32 v18, v18, v5
  v_sub_f32 v19, v19, v5
  v_sub_f32 v20, v20, v5
  v_sub_f32 v21, v21, v5
  v_sub_f32 v22, v22, v5
  v_sub_f32 v23, v23, v5
  v_cvt_pk_bf16_f32 v32, v16, v17
  v_cvt_pk_bf16_f32 v33, v18, v19
  v_cvt_pk_bf16_f32 v34, v20, v21
  v_cvt_pk_bf16_f32 v35, v22, v23
  v_lshlrev_b32 v16, 16, v36
  v_and_b32 v17, 0xffff0000, v36
  v_lshlrev_b32 v18, 16, v37
  v_and_b32 v19, 0xffff0000, v37
  v_lshlrev_b32 v20, 16, v38
  v_and_b32 v21, 0xffff0000, v38
  v_lshlrev_b32 v22, 16, v39
  v_and_b32 v23, 0xffff0000, v39
  v_sub_f32 v16, v16, v6
  v_sub_f32 v17, v17, v6
  v_sub_f32 v18, v18, v6
  v_sub_f32 v19, v19, v6
  v_sub_f32 v20, v20, v6
  v_sub_f32 v21, v21, v6
  v_sub_f32 v22, v22, v6
  v_sub_f32 v23, v23, v6
  v_cvt_pk_bf16_f32 v36, v16, v17
  v_cvt_pk_bf16_f32 v37, v18, v19
  v_cvt_pk_bf16_f32 v38, v20, v21
  v_cvt_pk_bf16_f32 v39, v22, v23
  buffer_store_dwordx4 v[32:35], v14, s[20:23], s32 offen offset:0 sc1
  buffer_store_dwordx4 v[36:39], v14, s[20:23], s32 offen offset:1024 sc1
  v_lshlrev_b32 v16, 16, v40
  v_and_b32 v17, 0xffff0000, v40
  v_lshlrev_b32 v18, 16, v41
  v_and_b32 v19, 0xffff0000, v41
  v_lshlrev_b32 v20, 16, v42
  v_and_b32 v21, 0xffff0000, v42
  v_lshlrev_b32 v22, 16, v43
  v_and_b32 v23, 0xffff0000, v43
  v_sub_f32 v16, v16, v5
  v_sub_f32 v17, v17, v5
  v_sub_f32 v18, v18, v5
  v_sub_f32 v19, v19, v5
  v_sub_f32 v20, v20, v5
  v_sub_f32 v21, v21, v5
  v_sub_f32 v22, v22, v5
  v_sub_f32 v23, v23, v5
  v_cvt_pk_bf16_f32 v40, v16, v17
  v_cvt_pk_bf16_f32 v41, v18, v19
  v_cvt_pk_bf16_f32 v42, v20, v21
  v_cvt_pk_bf16_f32 v43, v22, v23
  v_lshlrev_b32 v16, 16, v44
  v_and_b32 v17, 0xffff0000, v44
  v_lshlrev_b32 v18, 16, v45
  v_and_b32 v19, 0xffff0000, v45
  v_lshlrev_b32 v20, 16, v46
  v_and_b32 v21, 0xffff0000, v46
  v_lshlrev_b32 v22, 16, v47
  v_and_b32 v23, 0xffff0000, v47
  v_sub_f32 v16, v16, v6
  v_sub_f32 v17, v17, v6
  v_sub_f32 v18, v18, v6
  v_sub_f32 v19, v19, v6
  v_sub_f32 v20, v20, v6
  v_sub_f32 v21, v21, v6
  v_sub_f32 v22, v22, v6
  v_sub_f32 v23, v23, v6
  v_cvt_pk_bf16_f32 v44, v16, v17
  v_cvt_pk_bf16_f32 v45, v18, v19
  v_cvt_pk_bf16_f32 v46, v20, v21
  v_cvt_pk_bf16_f32 v47, v22, v23
  buffer_store_dwordx4 v[40:43], v14, s[20:23], s32 offen offset:2048 sc1
  buffer_store_dwordx4 v[44:47], v14, s[20:23], s32 offen offset:3072 sc1
  s_add_u32 s32, s32, 4096
  v_lshlrev_b32 v16, 16, v48
  v_and_b32 v17, 0xffff0000, v48
  v_lshlrev_b32 v18, 16, v49
  v_and_b32 v19, 0xffff0000, v49
  v_lshlrev_b32 v20, 16, v50
  v_and_b32 v21, 0xffff0000, v50
  v_lshlrev_b32 v22, 16, v51
  v_and_b32 v23, 0xffff0000, v51
  v_sub_f32 v16, v16, v5
  v_sub_f32 v17, v17, v5
  v_sub_f32 v18, v18, v5
  v_sub_f32 v19, v19, v5
  v_sub_f32 v20, v20, v5
  v_sub_f32 v21, v21, v5
  v_sub_f32 v22, v22, v5
  v_sub_f32 v23, v23, v5
  v_cvt_pk_bf16_f32 v48, v16, v17
  v_cvt_pk_bf16_f32 v49, v18, v19
  v_cvt_pk_bf16_f32 v50, v20, v21
  v_cvt_pk_bf16_f32 v51, v22, v23
  v_lshlrev_b32 v16, 16, v52
  v_and_b32 v17, 0xffff0000, v52
  v_lshlrev_b32 v18, 16, v53
  v_and_b32 v19, 0xffff0000, v53
  v_lshlrev_b32 v20, 16, v54
  v_and_b32 v21, 0xffff0000, v54
  v_lshlrev_b32 v22, 16, v55
  v_and_b32 v23, 0xffff0000, v55
  v_sub_f32 v16, v16, v6
  v_sub_f32 v17, v17, v6
  v_sub_f32 v18, v18, v6
  v_sub_f32 v19, v19, v6
  v_sub_f32 v20, v20, v6
  v_sub_f32 v21, v21, v6
  v_sub_f32 v22, v22, v6
  v_sub_f32 v23, v23, v6
  v_cvt_pk_bf16_f32 v52, v16, v17
  v_cvt_pk_bf16_f32 v53, v18, v19
  v_cvt_pk_bf16_f32 v54, v20, v21
  v_cvt_pk_bf16_f32 v55, v22, v23
  buffer_store_dwordx4 v[48:51], v14, s[20:23], s32 offen offset:0 sc1
  buffer_store_dwordx4 v[52:55], v14, s[20:23], s32 offen offset:1024 sc1
  v_lshlrev_b32 v16, 16, v56
  v_and_b32 v17, 0xffff0000, v56
  v_lshlrev_b32 v18, 16, v57
  v_and_b32 v19, 0xffff0000, v57
  v_lshlrev_b32 v20, 16, v58
  v_and_b32 v21, 0xffff0000, v58
  v_lshlrev_b32 v22, 16, v59
  v_and_b32 v23, 0xffff0000, v59
  v_sub_f32 v16, v16, v5
  v_sub_f32 v17, v17, v5
  v_sub_f32 v18, v18, v5
  v_sub_f32 v19, v19, v5
  v_sub_f32 v20, v20, v5
  v_sub_f32 v21, v21, v5
  v_sub_f32 v22, v22, v5
  v_sub_f32 v23, v23, v5
  v_cvt_pk_bf16_f32 v56, v16, v17
  v_cvt_pk_bf16_f32 v57, v18, v19
  v_cvt_pk_bf16_f32 v58, v20, v21
  v_cvt_pk_bf16_f32 v59, v22, v23
  v_lshlrev_b32 v16, 16, v60
  v_and_b32 v17, 0xffff0000, v60
  v_lshlrev_b32 v18, 16, v61
  v_and_b32 v19, 0xffff0000, v61
  v_lshlrev_b32 v20, 16, v62
  v_and_b32 v21, 0xffff0000, v62
  v_lshlrev_b32 v22, 16, v63
  v_and_b32 v23, 0xffff0000, v63
  v_sub_f32 v16, v16, v6
  v_sub_f32 v17, v17, v6
  v_sub_f32 v18, v18, v6
  v_sub_f32 v19, v19, v6
  v_sub_f32 v20, v20, v6
  v_sub_f32 v21, v21, v6
  v_sub_f32 v22, v22, v6
  v_sub_f32 v23, v23, v6
  v_cvt_pk_bf16_f32 v60, v16, v17
  v_cvt_pk_bf16_f32 v61, v18, v19
  v_cvt_pk_bf16_f32 v62, v20, v21
  v_cvt_pk_bf16_f32 v63, v22, v23
  buffer_store_dwordx4 v[56:59], v14, s[20:23], s32 offen offset:2048 sc1
  buffer_store_dwordx4 v[60:63], v14, s[20:23], s32 offen offset:3072 sc1
  s_add_u32 s32, s32, 4096
  s_cmp_ge_u32 s3, 2
  s_cbranch_scc1 spv_50
  v_lshrrev_b32 v2, 1, v1
  v_lshlrev_b32 v2, 10, v2
  v_and_b32 v3, 1, v1
  v_lshl_add_u32 v2, v3, 9, v2
  s_lshl_b32 s35, s4, 16
  s_add_u32 s35, s35, 4194752
  v_mov_b32 v4, 0x3f803f80
  v_mov_b32 v5, 0x3f803f80
  v_mov_b32 v6, 0x3f803f80
  v_mov_b32 v7, 0x3f803f80
  buffer_store_dwordx4 v[4:7], v2, s[20:23], s35 offen sc1
spv_50:
  s_nop 1
  v_mov_b32 v4, 0
  v_mov_b32 v5, 0
  v_mov_b32 v6, 0
  v_mov_b32 v7, 0
  v_lshlrev_b32 v2, 4, v1
  s_lshl_b32 s35, s4, 14
  s_add_u32 s35, s35, 44040192
  s_add_u32 s36, s35, 0
  buffer_store_dwordx4 v[4:7], v2, s[20:23], s36 offen sc1
  s_add_u32 s36, s35, 4096
  buffer_store_dwordx4 v[4:7], v2, s[20:23], s36 offen sc1
  s_add_u32 s36, s35, 8192
  buffer_store_dwordx4 v[4:7], v2, s[20:23], s36 offen sc1
  s_add_u32 s36, s35, 12288
  buffer_store_dwordx4 v[4:7], v2, s[20:23], s36 offen sc1
  s_cmp_lg_u32 s4, 28
  s_cbranch_scc1 padx_51
  v_lshrrev_b32 v2, 2, v1
  v_mul_u32_u24 v2, 2064, v2
  v_and_b32 v3, 1, v1
  v_bfe_u32 v8, v1, 1, 1
  v_mul_u32_u24 v8, 2050, v8
  v_add_u32 v3, v3, v8
  v_add_u32 v3, 6, v3
  v_add_u32 v2, v2, v3
  v_lshlrev_b32 v2, 4, v2
  v_cmp_gt_u32 vcc, 224, v1
  s_nop 0
  s_and_saveexec_b64 s[30:31], vcc
  s_cbranch_execz pady_52
  s_mov_b32 s35, 6291456
  buffer_store_dwordx4 v[4:7], v2, s[20:23], s35 offen sc1
pady_52:
  s_mov_b64 exec, s[30:31]
padx_51:
  s_branch KMspdone_3
pkno_48:
  s_waitcnt lgkmcnt(0)
  s_cmp_ge_u32 s3, 2
  s_cbranch_scc1 spv_53
  v_lshrrev_b32 v2, 1, v1
  v_lshlrev_b32 v2, 10, v2
  v_and_b32 v3, 1, v1
  v_lshl_add_u32 v2, v3, 9, v2
  s_lshl_b32 s35, s4, 16
  s_add_u32 s35, s35, 4194752
  v_mov_b32 v4, 0x3f803f80
  v_mov_b32 v5, 0x3f803f80
  v_mov_b32 v6, 0x3f803f80
  v_mov_b32 v7, 0x3f803f80
  buffer_store_dwordx4 v[4:7], v2, s[20:23], s35 offen sc1
spv_53:
  s_nop 1
  v_mov_b32 v4, 0
  v_mov_b32 v5, 0
  v_mov_b32 v6, 0
  v_mov_b32 v7, 0
  v_lshlrev_b32 v2, 4, v1
  s_lshl_b32 s35, s4, 14
  s_add_u32 s35, s35, 44040192
  s_add_u32 s36, s35, 0
  buffer_store_dwordx4 v[4:7], v2, s[20:23], s36 offen sc1
  s_add_u32 s36, s35, 4096
  buffer_store_dwordx4 v[4:7], v2, s[20:23], s36 offen sc1
  s_add_u32 s36, s35, 8192
  buffer_store_dwordx4 v[4:7], v2, s[20:23], s36 offen sc1
  s_add_u32 s36, s35, 12288
  buffer_store_dwordx4 v[4:7], v2, s[20:23], s36 offen sc1
  s_cmp_lg_u32 s4, 28
  s_cbranch_scc1 padx_54
  v_lshrrev_b32 v2, 2, v1
  v_mul_u32_u24 v2, 2064, v2
  v_and_b32 v3, 1, v1
  v_bfe_u32 v8, v1, 1, 1
  v_mul_u32_u24 v8, 2050, v8
  v_add_u32 v3, v3, v8
  v_add_u32 v3, 6, v3
  v_add_u32 v2, v2, v3
  v_lshlrev_b32 v2, 4, v2
  v_cmp_gt_u32 vcc, 224, v1
  s_nop 0
  s_and_saveexec_b64 s[30:31], vcc
  s_cbranch_execz pady_55
  s_mov_b32 s35, 6291456
  buffer_store_dwordx4 v[4:7], v2, s[20:23], s35 offen sc1
pady_55:
  s_mov_b64 exec, s[30:31]
padx_54:
  s_barrier
  s_branch KMspdone_3
SC1off_56:
KMspdone_3:
  s_waitcnt vmcnt(0)
  s_barrier
  v_mov_b32 v1, 139328
  s_mov_b32 s59, 131072
  s_cmp_lg_u32 s3, 0
  s_cbranch_scc1 sdx_57
  v_mov_b32 v4, 0
  v_mov_b32 v5, 0
  v_mov_b32 v6, 0
  v_mov_b32 v7, 0
  ds_write_b128 v1, v[4:7] offset:0
  ds_write_b128 v1, v[4:7] offset:16
  ds_write_b128 v1, v[4:7] offset:32
  ds_write_b128 v1, v[4:7] offset:48
  ds_write_b128 v1, v[4:7] offset:64
  v_mov_b32 v2, 0
dp_58:
  buffer_load_dword v3, v2, s[48:51], 0 offen sc1
  s_waitcnt vmcnt(0)
  v_cmp_eq_u32 vcc, 0, v3
  s_nop 0
  s_cmp_eq_u64 vcc, 0
  s_cbranch_scc1 dpd_59
  s_sub_u32 s59, s59, 1
  s_nop 0
  s_cbranch_scc0 dp_58
  s_mov_b32 s59, 0
dpd_59:
  s_lshl_b32 s4, s2, 7
  s_add_u32 s4, s4, 44564480
  v_mov_b32 v2, 0
  v_mov_b32 v3, 1
  s_mov_b64 exec, 1
  buffer_store_dword v3, v2, s[20:23], s4 offen sc1
  s_mov_b64 exec, -1
  v_mov_b32 v3, 1
  s_mov_b64 exec, 1
  ds_add_u32 v1, v3 offset:44
  s_mov_b64 exec, -1
  s_waitcnt lgkmcnt(0)
sdx_57:
  s_barrier
KMA_2:
  s_and_b32 s43, s2, 7
  s_lshr_b32 s41, s43, 1
  s_lshl_b32 s41, s41, 3
  s_and_b32 s43, s43, 1
  s_lshl_b32 s42, s43, 2
  s_cmp_ge_u32 s2, 192
  s_cbranch_scc1 bm1_60
  s_lshr_b32 s43, s2, 3
  s_and_b32 s43, s43, 7
  s_add_u32 s41, s41, s43
  s_lshr_b32 s43, s2, 6
  s_add_u32 s42, s42, s43
  s_branch bm2_61
bm1_60:
  s_add_u32 s41, s41, s42
  s_lshr_b32 s43, s2, 3
  s_and_b32 s43, s43, 3
  s_add_u32 s41, s41, s43
  s_cmp_ge_u32 s2, 224
  s_cselect_b32 s42, 7, 3
bm2_61:
  s_mov_b32 s58, 0
  s_setprio 1
  s_and_b32 s24, s2, 7
  s_lshr_b32 s25, s2, 3
  s_lshr_b32 s26, s25, 4
  s_lshl_b32 s24, s24, 1
  s_add_u32 s24, s24, s26
  s_and_b32 s25, s25, 15
  v_and_b32 v5, 31, v0
  v_and_b32 v6, 3, v5
  v_lshrrev_b32 v7, 3, v5
  v_lshl_add_u32 v6, v7, 2, v6
  v_bfe_u32 v7, v5, 2, 1
  v_lshl_add_u32 v6, v7, 4, v6
  v_lshrrev_b32 v7, 5, v0
  v_lshlrev_b32 v2, 11, v7
  v_add_u32 v2, v2, v6
  v_lshlrev_b32 v2, 4, v2
  v_add_u32 v3, 0x10000, v2
  v_lshlrev_b32 v4, 4, v0
  s_lshl_b32 s26, s24, 17
  s_add_u32 s27, s26, 2097152
  s_add_u32 s28, s26, 4194304
  s_add_u32 s29, s26, 0
  v_mov_b32 v112, 0
  v_mov_b32 v113, 0
  v_mov_b32 v114, 0
  v_mov_b32 v115, 0
  v_mov_b32 v116, 0
  v_mov_b32 v117, 0
  v_mov_b32 v118, 0
  v_mov_b32 v119, 0
  v_mov_b32 v120, 0
  v_mov_b32 v121, 0
  v_mov_b32 v122, 0
  v_mov_b32 v123, 0
  v_mov_b32 v124, 0
  v_mov_b32 v125, 0
  v_mov_b32 v126, 0
  v_mov_b32 v127, 0
  v_mov_b32 v128, 0
  v_mov_b32 v129, 0
  v_mov_b32 v130, 0
  v_mov_b32 v131, 0
  v_mov_b32 v132, 0
  v_mov_b32 v133, 0
  v_mov_b32 v134, 0
  v_mov_b32 v135, 0
  v_mov_b32 v136, 0
  v_mov_b32 v137, 0
  v_mov_b32 v138, 0
  v_mov_b32 v139, 0
  v_mov_b32 v140, 0
  v_mov_b32 v141, 0
  v_mov_b32 v142, 0
  v_mov_b32 v143, 0
  v_mov_b32 v144, 0
  v_mov_b32 v145, 0
  v_mov_b32 v146, 0
  v_mov_b32 v147, 0
  v_mov_b32 v148, 0
  v_mov_b32 v149, 0
  v_mov_b32 v150, 0
  v_mov_b32 v151, 0
  v_mov_b32 v152, 0
  v_mov_b32 v153, 0
  v_mov_b32 v154, 0
  v_mov_b32 v155, 0
  v_mov_b32 v156, 0
  v_mov_b32 v157, 0
  v_mov_b32 v158, 0
  v_mov_b32 v159, 0
  v_mov_b32 v160, 0
  v_mov_b32 v161, 0
  v_mov_b32 v162, 0
  v_mov_b32 v163, 0
  v_mov_b32 v164, 0
  v_mov_b32 v165, 0
  v_mov_b32 v166, 0
  v_mov_b32 v167, 0
  v_mov_b32 v168, 0
  v_mov_b32 v169, 0
  v_mov_b32 v170, 0
  v_mov_b32 v171, 0
  v_mov_b32 v172, 0
  v_mov_b32 v173, 0
  v_mov_b32 v174, 0
  v_mov_b32 v175, 0
  s_cmp_lg_u32 s3, 0
  s_nop 0
  s_cbranch_scc1 adw_63
lw_65:
  ds_read_b32 v95, v1 offset:44
  s_waitcnt lgkmcnt(0)
  v_readfirstlane_b32 s57, v95
  s_nop 0
  s_cmp_ge_u32 s57, 1
  s_nop 1
  s_cbranch_scc1 lwd_66
  s_sub_u32 s59, s59, 1
  s_nop 0
  s_cbranch_scc0 lw_65
  s_mov_b32 s59, 0
lwd_66:
  s_mul_i32 s30, s24, 28
  s_add_u32 s31, s30, 27
  s_lshr_b32 s30, s30, 6
  s_lshr_b32 s31, s31, 6
  s_lshl_b32 s30, s30, 5
  s_lshl_b32 s31, s31, 5
  v_mov_b32 v90, s30
  v_mov_b32 v91, s31
  v_cmp_gt_u32 vcc, 32, v0
  s_nop 1
  v_cndmask_b32 v90, v91, v90, vcc
  v_and_b32 v91, 15, v0
  v_mov_b32 v92, s25
  v_and_b32 v93, 16, v0
  v_cmp_eq_u32 vcc, 0, v93
  s_nop 1
  v_cndmask_b32 v91, v92, v91, vcc
  v_cndmask_b32 v93, 0, 1, vcc
  v_add_u32 v90, v90, v93
  v_and_b32 v92, 3, v91
  v_lshl_add_u32 v90, v92, 3, v90
  v_lshrrev_b32 v92, 2, v91
  v_lshl_add_u32 v90, v92, 1, v90
  v_lshlrev_b32 v90, 7, v90
  v_and_b32 v91, 31, v0
  v_add_u32 v91, 224, v91
  v_lshlrev_b32 v91, 7, v91
  s_mov_b32 s30, 44564480
gm_67:
  buffer_load_dword v92, v90, s[20:23], s30 offen sc1
  buffer_load_dword v93, v91, s[20:23], s30 offen sc1
  s_waitcnt vmcnt(0)
  v_min_u32 v92, v92, v93
  v_cmp_eq_u32 vcc, 0, v92
  s_nop 0
  s_cmp_eq_u64 vcc, 0
  s_cbranch_scc1 gmd_68
  s_sub_u32 s59, s59, 1
  s_nop 0
  s_cbranch_scc0 gm_67
  s_mov_b32 s59, 0
gmd_68:
  v_mov_b32 v95, 1
  s_mov_b64 exec, 1
  ds_add_u32 v1, v95 offset:52
  s_mov_b64 exec, -1
  s_branch add_64
adw_63:
lw_69:
  ds_read_b32 v95, v1 offset:52
  s_waitcnt lgkmcnt(0)
  v_readfirstlane_b32 s57, v95
  s_nop 0
  s_cmp_ge_u32 s57, 1
  s_cbranch_scc1 lwd_70
  s_sub_u32 s59, s59, 1
  s_nop 0
  s_cbranch_scc0 lw_69
  s_mov_b32 s59, 0
lwd_70:
add_64:
  s_add_u32 s30, s3, 0
  s_and_b32 s30, s30, 3
  s_lshl_b32 s30, s30, 9
  s_lshl_b32 s31, s25, 11
  s_add_u32 s30, s30, s31
  s_add_u32 s30, s30, s29
  buffer_load_dwordx4 v[8:11], v2, s[20:23], s30 offen
  buffer_load_dwordx4 v[12:15], v3, s[20:23], s30 offen
  s_add_u32 s30, s3, 1
  s_and_b32 s30, s30, 3
  s_lshl_b32 s30, s30, 9
  s_lshl_b32 s31, s25, 11
  s_add_u32 s30, s30, s31
  s_add_u32 s30, s30, s29
  buffer_load_dwordx4 v[16:19], v2, s[20:23], s30 offen
  buffer_load_dwordx4 v[20:23], v3, s[20:23], s30 offen
  s_add_u32 s30, s3, 2
  s_and_b32 s30, s30, 3
  s_lshl_b32 s30, s30, 9
  s_lshl_b32 s31, s25, 11
  s_add_u32 s30, s30, s31
  s_add_u32 s30, s30, s29
  buffer_load_dwordx4 v[24:27], v2, s[20:23], s30 offen
  buffer_load_dwordx4 v[28:31], v3, s[20:23], s30 offen
  s_add_u32 s30, s3, 3
  s_and_b32 s30, s30, 3
  s_lshl_b32 s30, s30, 9
  s_lshl_b32 s31, s25, 11
  s_add_u32 s30, s30, s31
  s_add_u32 s30, s30, s29
  buffer_load_dwordx4 v[32:35], v2, s[20:23], s30 offen
  buffer_load_dwordx4 v[36:39], v3, s[20:23], s30 offen
  s_lshl_b32 s30, s25, 11
  s_add_u32 s30, s30, s27
  buffer_load_dwordx4 v[208:211], v2, s[20:23], s30 offen
  buffer_load_dwordx4 v[212:215], v3, s[20:23], s30 offen
  s_lshl_b32 s33, s3, 4
  s_mov_b32 s32, s25
  s_add_u32 s39, s32, 0
  s_and_b32 s34, s39, 15
  s_add_u32 s34, s34, s33
  s_lshl_b32 s34, s34, 9
  s_add_u32 s34, s34, s27
  buffer_load_dwordx4 v[40:43], v2, s[20:23], s34 offen
  buffer_load_dwordx4 v[44:47], v3, s[20:23], s34 offen
  s_and_b32 s35, s39, 15
  s_add_u32 s35, s35, s33
  s_lshl_b32 s35, s35, 11
  s_add_u32 s35, s35, s28
  buffer_load_dwordx4 v[56:59], v4, s[20:23], s35 offen
  buffer_load_dwordx4 v[60:63], v4, s[20:23], s35 offen offset:1024
  s_add_u32 s39, s32, 1
  s_and_b32 s34, s39, 15
  s_add_u32 s34, s34, s33
  s_lshl_b32 s34, s34, 9
  s_add_u32 s34, s34, s27
  buffer_load_dwordx4 v[48:51], v2, s[20:23], s34 offen
  buffer_load_dwordx4 v[52:55], v3, s[20:23], s34 offen
  s_and_b32 s35, s39, 15
  s_add_u32 s35, s35, s33
  s_lshl_b32 s35, s35, 11
  s_add_u32 s35, s35, s28
  buffer_load_dwordx4 v[64:67], v4, s[20:23], s35 offen
  buffer_load_dwordx4 v[68:71], v4, s[20:23], s35 offen offset:1024
  s_add_u32 s39, s32, 2
  s_and_b32 s34, s39, 15
  s_add_u32 s34, s34, s33
  s_lshl_b32 s34, s34, 9
  s_add_u32 s34, s34, s27
  buffer_load_dwordx4 v[176:179], v2, s[20:23], s34 offen
  buffer_load_dwordx4 v[180:183], v3, s[20:23], s34 offen
  s_and_b32 s35, s39, 15
  s_add_u32 s35, s35, s33
  s_lshl_b32 s35, s35, 11
  s_add_u32 s35, s35, s28
  buffer_load_dwordx4 v[192:195], v4, s[20:23], s35 offen
  buffer_load_dwordx4 v[196:199], v4, s[20:23], s35 offen offset:1024
  s_add_u32 s39, s32, 3
  s_and_b32 s34, s39, 15
  s_add_u32 s34, s34, s33
  s_lshl_b32 s34, s34, 9
  s_add_u32 s34, s34, s27
  buffer_load_dwordx4 v[184:187], v2, s[20:23], s34 offen
  buffer_load_dwordx4 v[188:191], v3, s[20:23], s34 offen
  v_cmp_eq_u32 s[36:37], 1, v7
  s_waitcnt vmcnt(16)
  s_nop 0
  v_cndmask_b32_e64 v14, v14, 0, s[36:37]
  v_cndmask_b32_e64 v15, v15, 0, s[36:37]
  v_cndmask_b32_e64 v22, v22, 0, s[36:37]
  v_cndmask_b32_e64 v23, v23, 0, s[36:37]
  v_cndmask_b32_e64 v30, v30, 0, s[36:37]
  v_cndmask_b32_e64 v31, v31, 0, s[36:37]
  v_cndmask_b32_e64 v38, v38, 0, s[36:37]
  v_cndmask_b32_e64 v39, v39, 0, s[36:37]
  s_waitcnt vmcnt(14)
  v_mfma_f32_32x32x16_bf16 v[72:87], v[208:211], v[8:11], 0
  v_mfma_f32_32x32x16_bf16 v[72:87], v[212:215], v[12:15], v[72:87]
  v_mfma_f32_32x32x16_bf16 v[88:103], v[208:211], v[16:19], 0
  v_mfma_f32_32x32x16_bf16 v[88:103], v[212:215], v[20:23], v[88:103]
  v_mfma_f32_32x32x16_bf16 v[224:239], v[208:211], v[24:27], 0
  v_mfma_f32_32x32x16_bf16 v[224:239], v[212:215], v[28:31], v[224:239]
  v_mfma_f32_32x32x16_bf16 v[240:255], v[208:211], v[32:35], 0
  v_mfma_f32_32x32x16_bf16 v[240:255], v[212:215], v[36:39], v[240:255]
  s_nop 5
  v_max3_f32 v104, v72, v73, v74
  v_max_f32 v104, v104, v75
  v_max3_f32 v104, v104, v76, v77
  v_max3_f32 v104, v104, v78, v79
  v_max3_f32 v104, v104, v80, v81
  v_max3_f32 v104, v104, v82, v83
  v_max3_f32 v104, v104, v84, v85
  v_max3_f32 v104, v104, v86, v87
  v_max3_f32 v105, v88, v89, v90
  v_max_f32 v105, v105, v91
  v_max3_f32 v105, v105, v92, v93
  v_max3_f32 v105, v105, v94, v95
  v_max3_f32 v105, v105, v96, v97
  v_max3_f32 v105, v105, v98, v99
  v_max3_f32 v105, v105, v100, v101
  v_max3_f32 v105, v105, v102, v103
  v_max3_f32 v106, v224, v225, v226
  v_max_f32 v106, v106, v227
  v_max3_f32 v106, v106, v228, v229
  v_max3_f32 v106, v106, v230, v231
  v_max3_f32 v106, v106, v232, v233
  v_max3_f32 v106, v106, v234, v235
  v_max3_f32 v106, v106, v236, v237
  v_max3_f32 v106, v106, v238, v239
  v_max3_f32 v107, v240, v241, v242
  v_max_f32 v107, v107, v243
  v_max3_f32 v107, v107, v244, v245
  v_max3_f32 v107, v107, v246, v247
  v_max3_f32 v107, v107, v248, v249
  v_max3_f32 v107, v107, v250, v251
  v_max3_f32 v107, v107, v252, v253
  v_max3_f32 v107, v107, v254, v255
  s_mov_b32 s38, 0
setm_71:
  v_mov_b32 v108, v104
  v_mov_b32 v109, v105
  v_mov_b32 v110, v106
  v_mov_b32 v111, v107
  v_permlane32_swap_b32 v104, v108
  v_permlane32_swap_b32 v105, v109
  v_permlane32_swap_b32 v106, v110
  v_permlane32_swap_b32 v107, v111
  v_max_f32 v104, v104, v108
  v_max_f32 v105, v105, v109
  v_max_f32 v106, v106, v110
  v_max_f32 v107, v107, v111
  v_sub_f32 v104, 0, v104
  v_sub_f32 v105, 0, v105
  v_sub_f32 v106, 0, v106
  v_sub_f32 v107, 0, v107
  v_cvt_pk_bf16_f32 v108, v104, v104
  v_cvt_pk_bf16_f32 v109, v105, v105
  v_cvt_pk_bf16_f32 v110, v106, v106
  v_cvt_pk_bf16_f32 v111, v107, v107
  v_and_b32 v72, 0xffff0000, v108
  v_and_b32 v73, 0xffff0000, v109
  v_and_b32 v74, 0xffff0000, v110
  v_and_b32 v75, 0xffff0000, v111
  v_sub_f32 v104, v104, v72
  v_sub_f32 v105, v105, v73
  v_sub_f32 v106, v106, v74
  v_sub_f32 v107, v107, v75
  v_cvt_pk_bf16_f32 v104, v72, v104
  v_cvt_pk_bf16_f32 v105, v73, v105
  v_cvt_pk_bf16_f32 v106, v74, v106
  v_cvt_pk_bf16_f32 v107, v75, v107
  v_cndmask_b32_e64 v14, v14, v104, s[36:37]
  v_cndmask_b32_e64 v22, v22, v105, s[36:37]
  v_cndmask_b32_e64 v30, v30, v106, s[36:37]
  v_cndmask_b32_e64 v38, v38, v107, s[36:37]
  s_waitcnt vmcnt(12)
  v_mfma_f32_32x32x16_bf16 v[72:87], v[40:43], v[8:11], 0
  v_mfma_f32_32x32x16_bf16 v[72:87], v[44:47], v[12:15], v[72:87]
  v_mov_b32 v108, 0
  v_mov_b32 v109, 0
  v_mov_b32 v110, 0
  v_mov_b32 v111, 0
  v_mov_b32 v204, 0
  v_mov_b32 v205, 0
  v_mov_b32 v206, 0
  v_mov_b32 v207, 0
  s_mov_b32 s40, 0
attnloop_72:
  v_mfma_f32_32x32x16_bf16 v[88:103], v[40:43], v[16:19], 0
  s_nop 1
  v_exp_f32 v72, v72
  v_exp_f32 v73, v73
  v_exp_f32 v74, v74
  v_exp_f32 v75, v75
  v_cvt_pk_bf16_f32 v104, v72, v73
  v_cvt_pk_bf16_f32 v105, v74, v75
  v_mfma_f32_32x32x16_bf16 v[160:175], v[204:207], v[108:111], v[160:175]
  v_exp_f32 v76, v76
  v_exp_f32 v77, v77
  v_exp_f32 v78, v78
  v_exp_f32 v79, v79
  v_cvt_pk_bf16_f32 v106, v76, v77
  v_cvt_pk_bf16_f32 v107, v78, v79
  s_add_u32 s39, s32, 3
  s_and_b32 s35, s39, 15
  s_add_u32 s35, s35, s33
  s_lshl_b32 s35, s35, 11
  s_add_u32 s35, s35, s28
  buffer_load_dwordx4 v[200:203], v4, s[20:23], s35 offen
  buffer_load_dwordx4 v[204:207], v4, s[20:23], s35 offen offset:1024
  v_mfma_f32_32x32x16_bf16 v[88:103], v[44:47], v[20:23], v[88:103]
  v_exp_f32 v80, v80
  v_exp_f32 v81, v81
  v_exp_f32 v82, v82
  v_exp_f32 v83, v83
  v_cvt_pk_bf16_f32 v108, v80, v81
  v_cvt_pk_bf16_f32 v109, v82, v83
  s_waitcnt vmcnt(12)
  v_mfma_f32_32x32x16_bf16 v[112:127], v[56:59], v[104:107], v[112:127]
  v_exp_f32 v84, v84
  v_exp_f32 v85, v85
  v_exp_f32 v86, v86
  v_exp_f32 v87, v87
  v_cvt_pk_bf16_f32 v110, v84, v85
  v_cvt_pk_bf16_f32 v111, v86, v87
  v_mfma_f32_32x32x16_bf16 v[72:87], v[40:43], v[24:27], 0
  v_exp_f32 v88, v88
  v_exp_f32 v89, v89
  v_exp_f32 v90, v90
  v_exp_f32 v91, v91
  v_cvt_pk_bf16_f32 v104, v88, v89
  v_cvt_pk_bf16_f32 v105, v90, v91
  v_mfma_f32_32x32x16_bf16 v[112:127], v[60:63], v[108:111], v[112:127]
  v_exp_f32 v92, v92
  v_exp_f32 v93, v93
  v_exp_f32 v94, v94
  v_exp_f32 v95, v95
  v_cvt_pk_bf16_f32 v106, v92, v93
  v_cvt_pk_bf16_f32 v107, v94, v95
  v_mfma_f32_32x32x16_bf16 v[72:87], v[44:47], v[28:31], v[72:87]
  v_exp_f32 v96, v96
  v_exp_f32 v97, v97
  v_exp_f32 v98, v98
  v_exp_f32 v99, v99
  v_cvt_pk_bf16_f32 v108, v96, v97
  v_cvt_pk_bf16_f32 v109, v98, v99
  v_mfma_f32_32x32x16_bf16 v[128:143], v[56:59], v[104:107], v[128:143]
  v_exp_f32 v100, v100
  v_exp_f32 v101, v101
  v_exp_f32 v102, v102
  v_exp_f32 v103, v103
  v_cvt_pk_bf16_f32 v110, v100, v101
  v_cvt_pk_bf16_f32 v111, v102, v103
  v_mfma_f32_32x32x16_bf16 v[88:103], v[40:43], v[32:35], 0
  v_exp_f32 v72, v72
  v_exp_f32 v73, v73
  v_exp_f32 v74, v74
  v_exp_f32 v75, v75
  v_cvt_pk_bf16_f32 v104, v72, v73
  v_cvt_pk_bf16_f32 v105, v74, v75
  v_mfma_f32_32x32x16_bf16 v[128:143], v[60:63], v[108:111], v[128:143]
  v_exp_f32 v76, v76
  v_exp_f32 v77, v77
  v_exp_f32 v78, v78
  v_exp_f32 v79, v79
  v_cvt_pk_bf16_f32 v106, v76, v77
  v_cvt_pk_bf16_f32 v107, v78, v79
  v_mfma_f32_32x32x16_bf16 v[88:103], v[44:47], v[36:39], v[88:103]
  v_exp_f32 v80, v80
  v_exp_f32 v81, v81
  v_exp_f32 v82, v82
  v_exp_f32 v83, v83
  v_cvt_pk_bf16_f32 v108, v80, v81
  v_cvt_pk_bf16_f32 v109, v82, v83
  v_mfma_f32_32x32x16_bf16 v[144:159], v[56:59], v[104:107], v[144:159]
  v_exp_f32 v84, v84
  v_exp_f32 v85, v85
  v_exp_f32 v86, v86
  v_exp_f32 v87, v87
  v_cvt_pk_bf16_f32 v110, v84, v85
  v_cvt_pk_bf16_f32 v111, v86, v87
  s_add_u32 s39, s32, 4
  s_and_b32 s34, s39, 15
  s_add_u32 s34, s34, s33
  s_lshl_b32 s34, s34, 9
  s_add_u32 s34, s34, s27
  buffer_load_dwordx4 v[40:43], v2, s[20:23], s34 offen
  buffer_load_dwordx4 v[44:47], v3, s[20:23], s34 offen
  s_waitcnt vmcnt(12)
  v_mfma_f32_32x32x16_bf16 v[72:87], v[48:51], v[8:11], 0
  v_exp_f32 v88, v88
  v_exp_f32 v89, v89
  v_exp_f32 v90, v90
  v_exp_f32 v91, v91
  v_cvt_pk_bf16_f32 v104, v88, v89
  v_cvt_pk_bf16_f32 v105, v90, v91
  v_mfma_f32_32x32x16_bf16 v[144:159], v[60:63], v[108:111], v[144:159]
  v_exp_f32 v92, v92
  v_exp_f32 v93, v93
  v_exp_f32 v94, v94
  v_exp_f32 v95, v95
  v_cvt_pk_bf16_f32 v106, v92, v93
  v_cvt_pk_bf16_f32 v107, v94, v95
  v_mfma_f32_32x32x16_bf16 v[72:87], v[52:55], v[12:15], v[72:87]
  v_exp_f32 v96, v96
  v_exp_f32 v97, v97
  v_exp_f32 v98, v98
  v_exp_f32 v99, v99
  v_cvt_pk_bf16_f32 v108, v96, v97
  v_cvt_pk_bf16_f32 v109, v98, v99
  v_mfma_f32_32x32x16_bf16 v[160:175], v[56:59], v[104:107], v[160:175]
  v_exp_f32 v100, v100
  v_exp_f32 v101, v101
  v_exp_f32 v102, v102
  v_exp_f32 v103, v103
  v_cvt_pk_bf16_f32 v110, v100, v101
  v_cvt_pk_bf16_f32 v111, v102, v103
  s_add_u32 s32, s32, 1
  v_mfma_f32_32x32x16_bf16 v[88:103], v[48:51], v[16:19], 0
  v_exp_f32 v72, v72
  v_exp_f32 v73, v73
  v_exp_f32 v74, v74
  v_exp_f32 v75, v75
  v_cvt_pk_bf16_f32 v104, v72, v73
  v_cvt_pk_bf16_f32 v105, v74, v75
  v_mfma_f32_32x32x16_bf16 v[160:175], v[60:63], v[108:111], v[160:175]
  v_exp_f32 v76, v76
  v_exp_f32 v77, v77
  v_exp_f32 v78, v78
  v_exp_f32 v79, v79
  v_cvt_pk_bf16_f32 v106, v76, v77
  v_cvt_pk_bf16_f32 v107, v78, v79
  s_add_u32 s39, s32, 3
  s_and_b32 s35, s39, 15
  s_add_u32 s35, s35, s33
  s_lshl_b32 s35, s35, 11
  s_add_u32 s35, s35, s28
  buffer_load_dwordx4 v[56:59], v4, s[20:23], s35 offen
  buffer_load_dwordx4 v[60:63], v4, s[20:23], s35 offen offset:1024
  v_mfma_f32_32x32x16_bf16 v[88:103], v[52:55], v[20:23], v[88:103]
  v_exp_f32 v80, v80
  v_exp_f32 v81, v81
  v_exp_f32 v82, v82
  v_exp_f32 v83, v83
  v_cvt_pk_bf16_f32 v108, v80, v81
  v_cvt_pk_bf16_f32 v109, v82, v83
  s_waitcnt vmcnt(12)
  v_mfma_f32_32x32x16_bf16 v[112:127], v[64:67], v[104:107], v[112:127]
  v_exp_f32 v84, v84
  v_exp_f32 v85, v85
  v_exp_f32 v86, v86
  v_exp_f32 v87, v87
  v_cvt_pk_bf16_f32 v110, v84, v85
  v_cvt_pk_bf16_f32 v111, v86, v87
  v_mfma_f32_32x32x16_bf16 v[72:87], v[48:51], v[24:27], 0
  v_exp_f32 v88, v88
  v_exp_f32 v89, v89
  v_exp_f32 v90, v90
  v_exp_f32 v91, v91
  v_cvt_pk_bf16_f32 v104, v88, v89
  v_cvt_pk_bf16_f32 v105, v90, v91
  v_mfma_f32_32x32x16_bf16 v[112:127], v[68:71], v[108:111], v[112:127]
  v_exp_f32 v92, v92
  v_exp_f32 v93, v93
  v_exp_f32 v94, v94
  v_exp_f32 v95, v95
  v_cvt_pk_bf16_f32 v106, v92, v93
  v_cvt_pk_bf16_f32 v107, v94, v95
  v_mfma_f32_32x32x16_bf16 v[72:87], v[52:55], v[28:31], v[72:87]
  v_exp_f32 v96, v96
  v_exp_f32 v97, v97
  v_exp_f32 v98, v98
  v_exp_f32 v99, v99
  v_cvt_pk_bf16_f32 v108, v96, v97
  v_cvt_pk_bf16_f32 v109, v98, v99
  v_mfma_f32_32x32x16_bf16 v[128:143], v[64:67], v[104:107], v[128:143]
  v_exp_f32 v100, v100
  v_exp_f32 v101, v101
  v_exp_f32 v102, v102
  v_exp_f32 v103, v103
  v_cvt_pk_bf16_f32 v110, v100, v101
  v_cvt_pk_bf16_f32 v111, v102, v103
  v_mfma_f32_32x32x16_bf16 v[88:103], v[48:51], v[32:35], 0
  v_exp_f32 v72, v72
  v_exp_f32 v73, v73
  v_exp_f32 v74, v74
  v_exp_f32 v75, v75
  v_cvt_pk_bf16_f32 v104, v72, v73
  v_cvt_pk_bf16_f32 v105, v74, v75
  v_mfma_f32_32x32x16_bf16 v[128:143], v[68:71], v[108:111], v[128:143]
  v_exp_f32 v76, v76
  v_exp_f32 v77, v77
  v_exp_f32 v78, v78
  v_exp_f32 v79, v79
  v_cvt_pk_bf16_f32 v106, v76, v77
  v_cvt_pk_bf16_f32 v107, v78, v79
  v_mfma_f32_32x32x16_bf16 v[88:103], v[52:55], v[36:39], v[88:103]
  v_exp_f32 v80, v80
  v_exp_f32 v81, v81
  v_exp_f32 v82, v82
  v_exp_f32 v83, v83
  v_cvt_pk_bf16_f32 v108, v80, v81
  v_cvt_pk_bf16_f32 v109, v82, v83
  v_mfma_f32_32x32x16_bf16 v[144:159], v[64:67], v[104:107], v[144:159]
  v_exp_f32 v84, v84
  v_exp_f32 v85, v85
  v_exp_f32 v86, v86
  v_exp_f32 v87, v87
  v_cvt_pk_bf16_f32 v110, v84, v85
  v_cvt_pk_bf16_f32 v111, v86, v87
  s_add_u32 s39, s32, 4
  s_and_b32 s34, s39, 15
  s_add_u32 s34, s34, s33
  s_lshl_b32 s34, s34, 9
  s_add_u32 s34, s34, s27
  buffer_load_dwordx4 v[48:51], v2, s[20:23], s34 offen
  buffer_load_dwordx4 v[52:55], v3, s[20:23], s34 offen
  s_waitcnt vmcnt(12)
  v_mfma_f32_32x32x16_bf16 v[72:87], v[176:179], v[8:11], 0
  v_exp_f32 v88, v88
  v_exp_f32 v89, v89
  v_exp_f32 v90, v90
  v_exp_f32 v91, v91
  v_cvt_pk_bf16_f32 v104, v88, v89
  v_cvt_pk_bf16_f32 v105, v90, v91
  v_mfma_f32_32x32x16_bf16 v[144:159], v[68:71], v[108:111], v[144:159]
  v_exp_f32 v92, v92
  v_exp_f32 v93, v93
  v_exp_f32 v94, v94
  v_exp_f32 v95, v95
  v_cvt_pk_bf16_f32 v106, v92, v93
  v_cvt_pk_bf16_f32 v107, v94, v95
  v_mfma_f32_32x32x16_bf16 v[72:87], v[180:183], v[12:15], v[72:87]
  v_exp_f32 v96, v96
  v_exp_f32 v97, v97
  v_exp_f32 v98, v98
  v_exp_f32 v99, v99
  v_cvt_pk_bf16_f32 v108, v96, v97
  v_cvt_pk_bf16_f32 v109, v98, v99
  v_mfma_f32_32x32x16_bf16 v[160:175], v[64:67], v[104:107], v[160:175]
  v_exp_f32 v100, v100
  v_exp_f32 v101, v101
  v_exp_f32 v102, v102
  v_exp_f32 v103, v103
  v_cvt_pk_bf16_f32 v110, v100, v101
  v_cvt_pk_bf16_f32 v111, v102, v103
  s_add_u32 s32, s32, 1
  v_mfma_f32_32x32x16_bf16 v[88:103], v[176:179], v[16:19], 0
  v_exp_f32 v72, v72
  v_exp_f32 v73, v73
  v_exp_f32 v74, v74
  v_exp_f32 v75, v75
  v_cvt_pk_bf16_f32 v104, v72, v73
  v_cvt_pk_bf16_f32 v105, v74, v75
  v_mfma_f32_32x32x16_bf16 v[160:175], v[68:71], v[108:111], v[160:175]
  v_exp_f32 v76, v76
  v_exp_f32 v77, v77
  v_exp_f32 v78, v78
  v_exp_f32 v79, v79
  v_cvt_pk_bf16_f32 v106, v76, v77
  v_cvt_pk_bf16_f32 v107, v78, v79
  s_add_u32 s39, s32, 3
  s_and_b32 s35, s39, 15
  s_add_u32 s35, s35, s33
  s_lshl_b32 s35, s35, 11
  s_add_u32 s35, s35, s28
  buffer_load_dwordx4 v[64:67], v4, s[20:23], s35 offen
  buffer_load_dwordx4 v[68:71], v4, s[20:23], s35 offen offset:1024
  v_mfma_f32_32x32x16_bf16 v[88:103], v[180:183], v[20:23], v[88:103]
  v_exp_f32 v80, v80
  v_exp_f32 v81, v81
  v_exp_f32 v82, v82
  v_exp_f32 v83, v83
  v_cvt_pk_bf16_f32 v108, v80, v81
  v_cvt_pk_bf16_f32 v109, v82, v83
  s_waitcnt vmcnt(12)
  v_mfma_f32_32x32x16_bf16 v[112:127], v[192:195], v[104:107], v[112:127]
  v_exp_f32 v84, v84
  v_exp_f32 v85, v85
  v_exp_f32 v86, v86
  v_exp_f32 v87, v87
  v_cvt_pk_bf16_f32 v110, v84, v85
  v_cvt_pk_bf16_f32 v111, v86, v87
  v_mfma_f32_32x32x16_bf16 v[72:87], v[176:179], v[24:27], 0
  v_exp_f32 v88, v88
  v_exp_f32 v89, v89
  v_exp_f32 v90, v90
  v_exp_f32 v91, v91
  v_cvt_pk_bf16_f32 v104, v88, v89
  v_cvt_pk_bf16_f32 v105, v90, v91
  v_mfma_f32_32x32x16_bf16 v[112:127], v[196:199], v[108:111], v[112:127]
  v_exp_f32 v92, v92
  v_exp_f32 v93, v93
  v_exp_f32 v94, v94
  v_exp_f32 v95, v95
  v_cvt_pk_bf16_f32 v106, v92, v93
  v_cvt_pk_bf16_f32 v107, v94, v95
  v_mfma_f32_32x32x16_bf16 v[72:87], v[180:183], v[28:31], v[72:87]
  v_exp_f32 v96, v96
  v_exp_f32 v97, v97
  v_exp_f32 v98, v98
  v_exp_f32 v99, v99
  v_cvt_pk_bf16_f32 v108, v96, v97
  v_cvt_pk_bf16_f32 v109, v98, v99
  v_mfma_f32_32x32x16_bf16 v[128:143], v[192:195], v[104:107], v[128:143]
  v_exp_f32 v100, v100
  v_exp_f32 v101, v101
  v_exp_f32 v102, v102
  v_exp_f32 v103, v103
  v_cvt_pk_bf16_f32 v110, v100, v101
  v_cvt_pk_bf16_f32 v111, v102, v103
  v_mfma_f32_32x32x16_bf16 v[88:103], v[176:179], v[32:35], 0
  v_exp_f32 v72, v72
  v_exp_f32 v73, v73
  v_exp_f32 v74, v74
  v_exp_f32 v75, v75
  v_cvt_pk_bf16_f32 v104, v72, v73
  v_cvt_pk_bf16_f32 v105, v74, v75
  v_mfma_f32_32x32x16_bf16 v[128:143], v[196:199], v[108:111], v[128:143]
  v_exp_f32 v76, v76
  v_exp_f32 v77, v77
  v_exp_f32 v78, v78
  v_exp_f32 v79, v79
  v_cvt_pk_bf16_f32 v106, v76, v77
  v_cvt_pk_bf16_f32 v107, v78, v79
  v_mfma_f32_32x32x16_bf16 v[88:103], v[180:183], v[36:39], v[88:103]
  v_exp_f32 v80, v80
  v_exp_f32 v81, v81
  v_exp_f32 v82, v82
  v_exp_f32 v83, v83
  v_cvt_pk_bf16_f32 v108, v80, v81
  v_cvt_pk_bf16_f32 v109, v82, v83
  v_mfma_f32_32x32x16_bf16 v[144:159], v[192:195], v[104:107], v[144:159]
  v_exp_f32 v84, v84
  v_exp_f32 v85, v85
  v_exp_f32 v86, v86
  v_exp_f32 v87, v87
  v_cvt_pk_bf16_f32 v110, v84, v85
  v_cvt_pk_bf16_f32 v111, v86, v87
  s_add_u32 s39, s32, 4
  s_and_b32 s34, s39, 15
  s_add_u32 s34, s34, s33
  s_lshl_b32 s34, s34, 9
  s_add_u32 s34, s34, s27
  buffer_load_dwordx4 v[176:179], v2, s[20:23], s34 offen
  buffer_load_dwordx4 v[180:183], v3, s[20:23], s34 offen
  s_waitcnt vmcnt(12)
  v_mfma_f32_32x32x16_bf16 v[72:87], v[184:187], v[8:11], 0
  v_exp_f32 v88, v88
  v_exp_f32 v89, v89
  v_exp_f32 v90, v90
  v_exp_f32 v91, v91
  v_cvt_pk_bf16_f32 v104, v88, v89
  v_cvt_pk_bf16_f32 v105, v90, v91
  v_mfma_f32_32x32x16_bf16 v[144:159], v[196:199], v[108:111], v[144:159]
  v_exp_f32 v92, v92
  v_exp_f32 v93, v93
  v_exp_f32 v94, v94
  v_exp_f32 v95, v95
  v_cvt_pk_bf16_f32 v106, v92, v93
  v_cvt_pk_bf16_f32 v107, v94, v95
  v_mfma_f32_32x32x16_bf16 v[72:87], v[188:191], v[12:15], v[72:87]
  v_exp_f32 v96, v96
  v_exp_f32 v97, v97
  v_exp_f32 v98, v98
  v_exp_f32 v99, v99
  v_cvt_pk_bf16_f32 v108, v96, v97
  v_cvt_pk_bf16_f32 v109, v98, v99
  v_mfma_f32_32x32x16_bf16 v[160:175], v[192:195], v[104:107], v[160:175]
  v_exp_f32 v100, v100
  v_exp_f32 v101, v101
  v_exp_f32 v102, v102
  v_exp_f32 v103, v103
  v_cvt_pk_bf16_f32 v110, v100, v101
  v_cvt_pk_bf16_f32 v111, v102, v103
  s_add_u32 s32, s32, 1
  v_mfma_f32_32x32x16_bf16 v[88:103], v[184:187], v[16:19], 0
  v_exp_f32 v72, v72
  v_exp_f32 v73, v73
  v_exp_f32 v74, v74
  v_exp_f32 v75, v75
  v_cvt_pk_bf16_f32 v104, v72, v73
  v_cvt_pk_bf16_f32 v105, v74, v75
  v_mfma_f32_32x32x16_bf16 v[160:175], v[196:199], v[108:111], v[160:175]
  v_exp_f32 v76, v76
  v_exp_f32 v77, v77
  v_exp_f32 v78, v78
  v_exp_f32 v79, v79
  v_cvt_pk_bf16_f32 v106, v76, v77
  v_cvt_pk_bf16_f32 v107, v78, v79
  s_add_u32 s39, s32, 3
  s_and_b32 s35, s39, 15
  s_add_u32 s35, s35, s33
  s_lshl_b32 s35, s35, 11
  s_add_u32 s35, s35, s28
  buffer_load_dwordx4 v[192:195], v4, s[20:23], s35 offen
  buffer_load_dwordx4 v[196:199], v4, s[20:23], s35 offen offset:1024
  v_mfma_f32_32x32x16_bf16 v[88:103], v[188:191], v[20:23], v[88:103]
  v_exp_f32 v80, v80
  v_exp_f32 v81, v81
  v_exp_f32 v82, v82
  v_exp_f32 v83, v83
  v_cvt_pk_bf16_f32 v108, v80, v81
  v_cvt_pk_bf16_f32 v109, v82, v83
  s_waitcnt vmcnt(12)
  v_mfma_f32_32x32x16_bf16 v[112:127], v[200:203], v[104:107], v[112:127]
  v_exp_f32 v84, v84
  v_exp_f32 v85, v85
  v_exp_f32 v86, v86
  v_exp_f32 v87, v87
  v_cvt_pk_bf16_f32 v110, v84, v85
  v_cvt_pk_bf16_f32 v111, v86, v87
  v_mfma_f32_32x32x16_bf16 v[72:87], v[184:187], v[24:27], 0
  v_exp_f32 v88, v88
  v_exp_f32 v89, v89
  v_exp_f32 v90, v90
  v_exp_f32 v91, v91
  v_cvt_pk_bf16_f32 v104, v88, v89
  v_cvt_pk_bf16_f32 v105, v90, v91
  v_mfma_f32_32x32x16_bf16 v[112:127], v[204:207], v[108:111], v[112:127]
  v_exp_f32 v92, v92
  v_exp_f32 v93, v93
  v_exp_f32 v94, v94
  v_exp_f32 v95, v95
  v_cvt_pk_bf16_f32 v106, v92, v93
  v_cvt_pk_bf16_f32 v107, v94, v95
  v_mfma_f32_32x32x16_bf16 v[72:87], v[188:191], v[28:31], v[72:87]
  v_exp_f32 v96, v96
  v_exp_f32 v97, v97
  v_exp_f32 v98, v98
  v_exp_f32 v99, v99
  v_cvt_pk_bf16_f32 v108, v96, v97
  v_cvt_pk_bf16_f32 v109, v98, v99
  v_mfma_f32_32x32x16_bf16 v[128:143], v[200:203], v[104:107], v[128:143]
  v_exp_f32 v100, v100
  v_exp_f32 v101, v101
  v_exp_f32 v102, v102
  v_exp_f32 v103, v103
  v_cvt_pk_bf16_f32 v110, v100, v101
  v_cvt_pk_bf16_f32 v111, v102, v103
  v_mfma_f32_32x32x16_bf16 v[88:103], v[184:187], v[32:35], 0
  v_exp_f32 v72, v72
  v_exp_f32 v73, v73
  v_exp_f32 v74, v74
  v_exp_f32 v75, v75
  v_cvt_pk_bf16_f32 v104, v72, v73
  v_cvt_pk_bf16_f32 v105, v74, v75
  v_mfma_f32_32x32x16_bf16 v[128:143], v[204:207], v[108:111], v[128:143]
  v_exp_f32 v76, v76
  v_exp_f32 v77, v77
  v_exp_f32 v78, v78
  v_exp_f32 v79, v79
  v_cvt_pk_bf16_f32 v106, v76, v77
  v_cvt_pk_bf16_f32 v107, v78, v79
  v_mfma_f32_32x32x16_bf16 v[88:103], v[188:191], v[36:39], v[88:103]
  v_exp_f32 v80, v80
  v_exp_f32 v81, v81
  v_exp_f32 v82, v82
  v_exp_f32 v83, v83
  v_cvt_pk_bf16_f32 v108, v80, v81
  v_cvt_pk_bf16_f32 v109, v82, v83
  v_mfma_f32_32x32x16_bf16 v[144:159], v[200:203], v[104:107], v[144:159]
  v_exp_f32 v84, v84
  v_exp_f32 v85, v85
  v_exp_f32 v86, v86
  v_exp_f32 v87, v87
  v_cvt_pk_bf16_f32 v110, v84, v85
  v_cvt_pk_bf16_f32 v111, v86, v87
  s_add_u32 s39, s32, 4
  s_and_b32 s34, s39, 15
  s_add_u32 s34, s34, s33
  s_lshl_b32 s34, s34, 9
  s_add_u32 s34, s34, s27
  buffer_load_dwordx4 v[184:187], v2, s[20:23], s34 offen
  buffer_load_dwordx4 v[188:191], v3, s[20:23], s34 offen
  s_waitcnt vmcnt(12)
  v_mfma_f32_32x32x16_bf16 v[72:87], v[40:43], v[8:11], 0
  v_exp_f32 v88, v88
  v_exp_f32 v89, v89
  v_exp_f32 v90, v90
  v_exp_f32 v91, v91
  v_cvt_pk_bf16_f32 v104, v88, v89
  v_cvt_pk_bf16_f32 v105, v90, v91
  v_mfma_f32_32x32x16_bf16 v[144:159], v[204:207], v[108:111], v[144:159]
  v_exp_f32 v92, v92
  v_exp_f32 v93, v93
  v_exp_f32 v94, v94
  v_exp_f32 v95, v95
  v_cvt_pk_bf16_f32 v106, v92, v93
  v_cvt_pk_bf16_f32 v107, v94, v95
  v_mfma_f32_32x32x16_bf16 v[72:87], v[44:47], v[12:15], v[72:87]
  v_exp_f32 v96, v96
  v_exp_f32 v97, v97
  v_exp_f32 v98, v98
  v_exp_f32 v99, v99
  v_cvt_pk_bf16_f32 v108, v96, v97
  v_cvt_pk_bf16_f32 v109, v98, v99
  v_mfma_f32_32x32x16_bf16 v[160:175], v[200:203], v[104:107], v[160:175]
  v_exp_f32 v100, v100
  v_exp_f32 v101, v101
  v_exp_f32 v102, v102
  v_exp_f32 v103, v103
  v_cvt_pk_bf16_f32 v110, v100, v101
  v_cvt_pk_bf16_f32 v111, v102, v103
  s_add_u32 s32, s32, 1
  s_add_u32 s40, s40, 1
  s_cmp_lt_u32 s40, 4
  s_cbranch_scc1 attnloop_72
  v_mfma_f32_32x32x16_bf16 v[160:175], v[204:207], v[108:111], v[160:175]
  s_waitcnt vmcnt(0)
  v_mov_b32 v74, 0x66800000
  v_cmp_nlt_f32 vcc, v124, v74
  s_nop 0
  s_mov_b64 s[30:31], vcc
  v_cmp_nlt_f32 vcc, v140, v74
  s_nop 0
  s_or_b64 s[30:31], s[30:31], vcc
  v_cmp_nlt_f32 vcc, v156, v74
  s_nop 0
  s_or_b64 s[30:31], s[30:31], vcc
  s_nop 0
  v_cmp_nlt_f32 vcc, v172, v74
  s_nop 0
  s_or_b64 s[30:31], s[30:31], vcc
  s_and_b64 s[30:31], s[30:31], s[36:37]
  s_cmp_lg_u64 s[30:31], 0
  s_cselect_b32 s30, 1, 0
  v_mov_b32 v75, s30
  s_lshl_b32 s31, s3, 2
  s_add_u32 s31, s31, 139264
  v_mov_b32 v6, s31
  ds_write_b32 v6, v75
  s_lshl_b32 s30, s3, 12
  s_add_u32 s30, s30, 90112
  v_lshl_add_u32 v5, v0, 4, s30
  ds_write_b128 v5, v[128:131] offset:0
  ds_write_b128 v5, v[132:135] offset:1024
  ds_write_b128 v5, v[136:139] offset:2048
  ds_write_b128 v5, v[140:143] offset:3072
  ds_write_b128 v5, v[144:147] offset:16384
  ds_write_b128 v5, v[148:151] offset:17408
  ds_write_b128 v5, v[152:155] offset:18432
  ds_write_b128 v5, v[156:159] offset:19456
  ds_write_b128 v5, v[160:163] offset:32768
  ds_write_b128 v5, v[164:167] offset:33792
  ds_write_b128 v5, v[168:171] offset:34816
  ds_write_b128 v5, v[172:175] offset:35840
  s_waitcnt lgkmcnt(0)
  s_add_u32 s58, s58, 4
  v_mov_b32 v95, 1
  s_mov_b64 exec, 1
  ds_add_u32 v1, v95 offset:0
  s_mov_b64 exec, -1
lw_75:
  ds_read_b32 v95, v1 offset:0
  s_waitcnt lgkmcnt(0)
  v_readfirstlane_b32 s57, v95
  s_nop 0
  s_cmp_ge_u32 s57, s58
  s_cbranch_scc1 lwd_76
  s_sub_u32 s59, s59, 1
  s_nop 0
  s_cbranch_scc0 lw_75
  s_mov_b32 s59, 0
lwd_76:
  v_mov_b32 v6, 139264
  ds_read_b128 v[76:79], v6
  s_sub_u32 s30, s3, 1
  s_and_b32 s30, s30, 3
  s_lshl_b32 s30, s30, 12
  s_add_u32 s30, s30, 90112
  v_lshl_add_u32 v5, v0, 4, s30
  ds_read_b128 v[128:131], v5 offset:0
  ds_read_b128 v[132:135], v5 offset:1024
  ds_read_b128 v[136:139], v5 offset:2048
  ds_read_b128 v[140:143], v5 offset:3072
  s_sub_u32 s30, s3, 2
  s_and_b32 s30, s30, 3
  s_lshl_b32 s30, s30, 12
  s_add_u32 s30, s30, 106496
  v_lshl_add_u32 v5, v0, 4, s30
  ds_read_b128 v[144:147], v5 offset:0
  ds_read_b128 v[148:151], v5 offset:1024
  ds_read_b128 v[152:155], v5 offset:2048
  ds_read_b128 v[156:159], v5 offset:3072
  s_sub_u32 s30, s3, 3
  s_and_b32 s30, s30, 3
  s_lshl_b32 s30, s30, 12
  s_add_u32 s30, s30, 122880
  v_lshl_add_u32 v5, v0, 4, s30
  ds_read_b128 v[160:163], v5 offset:0
  ds_read_b128 v[164:167], v5 offset:1024
  ds_read_b128 v[168:171], v5 offset:2048
  ds_read_b128 v[172:175], v5 offset:3072
  s_waitcnt lgkmcnt(8)
  v_add_f32 v112, v112, v128
  v_add_f32 v113, v113, v129
  v_add_f32 v114, v114, v130
  v_add_f32 v115, v115, v131
  v_add_f32 v116, v116, v132
  v_add_f32 v117, v117, v133
  v_add_f32 v118, v118, v134
  v_add_f32 v119, v119, v135
  v_add_f32 v120, v120, v136
  v_add_f32 v121, v121, v137
  v_add_f32 v122, v122, v138
  v_add_f32 v123, v123, v139
  v_add_f32 v124, v124, v140
  v_add_f32 v125, v125, v141
  v_add_f32 v126, v126, v142
  v_add_f32 v127, v127, v143
  s_waitcnt lgkmcnt(4)
  v_add_f32 v112, v112, v144
  v_add_f32 v113, v113, v145
  v_add_f32 v114, v114, v146
  v_add_f32 v115, v115, v147
  v_add_f32 v116, v116, v148
  v_add_f32 v117, v117, v149
  v_add_f32 v118, v118, v150
  v_add_f32 v119, v119, v151
  v_add_f32 v120, v120, v152
  v_add_f32 v121, v121, v153
  v_add_f32 v122, v122, v154
  v_add_f32 v123, v123, v155
  v_add_f32 v124, v124, v156
  v_add_f32 v125, v125, v157
  v_add_f32 v126, v126, v158
  v_add_f32 v127, v127, v159
  s_waitcnt lgkmcnt(0)
  v_add_f32 v112, v112, v160
  v_add_f32 v113, v113, v161
  v_add_f32 v114, v114, v162
  v_add_f32 v115, v115, v163
  v_add_f32 v116, v116, v164
  v_add_f32 v117, v117, v165
  v_add_f32 v118, v118, v166
  v_add_f32 v119, v119, v167
  v_add_f32 v120, v120, v168
  v_add_f32 v121, v121, v169
  v_add_f32 v122, v122, v170
  v_add_f32 v123, v123, v171
  v_add_f32 v124, v124, v172
  v_add_f32 v125, v125, v173
  v_add_f32 v126, v126, v174
  v_add_f32 v127, v127, v175
  v_mov_b32 v72, v124
  v_mov_b32 v73, v124
  s_nop 1
  v_permlane32_swap_b32 v72, v73
  s_cmp_eq_u32 s38, 1
  s_nop 0
  s_cbranch_scc1 attok_73
  v_or_b32 v76, v76, v77
  v_or_b32 v78, v78, v79
  v_or_b32 v76, v76, v78
  s_nop 0
  v_readfirstlane_b32 s30, v76
  s_nop 0
  s_cmp_lg_u32 s30, 0
  s_cbranch_scc1 attfb_74
attok_73:
  v_rcp_f32 v73, v73
  s_nop 0
  v_mul_f32 v112, v112, v73
  v_mul_f32 v113, v113, v73
  v_mul_f32 v114, v114, v73
  v_mul_f32 v115, v115, v73
  v_mul_f32 v116, v116, v73
  v_mul_f32 v117, v117, v73
  v_mul_f32 v118, v118, v73
  v_mul_f32 v119, v119, v73
  v_mul_f32 v120, v120, v73
  v_mul_f32 v121, v121, v73
  v_mul_f32 v122, v122, v73
  v_mul_f32 v123, v123, v73
  v_mul_f32 v124, v124, v73
  v_mul_f32 v125, v125, v73
  v_mul_f32 v126, v126, v73
  v_mul_f32 v127, v127, v73
  v_cndmask_b32_e64 v124, v124, 0, s[36:37]
  v_cndmask_b32_e64 v125, v125, 0, s[36:37]
  v_cndmask_b32_e64 v126, v126, 0, s[36:37]
  v_cndmask_b32_e64 v127, v127, 0, s[36:37]
  v_cvt_pk_bf16_f32 v112, v112, v113
  v_cvt_pk_bf16_f32 v113, v114, v115
  v_cvt_pk_bf16_f32 v114, v116, v117
  v_cvt_pk_bf16_f32 v115, v118, v119
  v_cvt_pk_bf16_f32 v116, v120, v121
  v_cvt_pk_bf16_f32 v117, v122, v123
  v_cvt_pk_bf16_f32 v118, v124, v125
  v_cvt_pk_bf16_f32 v119, v126, v127
  v_and_b32 v5, 31, v0
  v_and_b32 v6, 3, v5
  v_lshrrev_b32 v7, 3, v5
  v_lshl_add_u32 v6, v7, 2, v6
  v_bfe_u32 v7, v5, 2, 1
  v_lshl_add_u32 v6, v7, 4, v6
  v_lshrrev_b32 v7, 5, v0
  v_lshlrev_b32 v7, 12, v7
  v_add_u32 v7, v7, v6
  v_lshlrev_b32 v7, 4, v7
  s_lshl_b32 s30, s25, 7
  s_lshl_b32 s31, s3, 5
  s_add_u32 s30, s30, s31
  s_lshl_b32 s30, s30, 4
  s_add_u32 s30, s30, s26
  s_add_u32 s30, s30, 15171584
  buffer_store_dwordx4 v[112:115], v7, s[20:23], s30 offen sc1
  s_add_u32 s30, s30, 32768
  buffer_store_dwordx4 v[116:119], v7, s[20:23], s30 offen sc1
  s_lshl_b32 s30, s25, 1
  s_lshr_b32 s31, s3, 1
  s_add_u32 s30, s30, s31
  s_lshl_b32 s30, s30, 5
  s_and_b32 s31, s3, 1
  s_lshl_b32 s31, s31, 4
  s_add_u32 s31, s31, s24
  s_add_u32 s30, s30, s31
  s_mul_i32 s30, s30, 128
  s_add_u32 s30, s30, 44171264
  s_cmp_ge_u32 s42, 7
  s_cbranch_scc1 psinv_77
lw_79:
  ds_read_b32 v5, v1 offset:8
  s_waitcnt lgkmcnt(0)
  v_readfirstlane_b32 s57, v5
  s_nop 0
  s_cmp_ge_u32 s57, 1
  s_cbranch_scc1 lwd_80
  s_sub_u32 s59, s59, 1
  s_nop 0
  s_cbranch_scc0 lw_79
  s_mov_b32 s59, 0
lwd_80:
  v_lshlrev_b32 v101, 4, v0
  s_and_b32 s47, s3, 1
  s_lshr_b32 s48, s3, 1
  s_lshl_b32 s43, s42, 2
  s_add_u32 s43, s43, s3
  s_lshl_b32 s43, s43, 14
  s_add_u32 s43, s43, 12582912
  s_lshl_b32 s44, s48, 10
  s_add_u32 s45, s43, s44
  s_xor_b32 s44, s44, 1024
  s_add_u32 s44, s43, s44
  buffer_load_dwordx4 v[176:179], v101, s[20:23], s45 offen offset:0
  buffer_load_dwordx4 v[180:183], v101, s[20:23], s44 offen offset:0
  buffer_load_dwordx4 v[184:187], v101, s[20:23], s45 offen offset:2048
  buffer_load_dwordx4 v[188:191], v101, s[20:23], s44 offen offset:2048
  s_add_u32 s45, s45, 4096
  s_add_u32 s44, s44, 4096
  buffer_load_dwordx4 v[192:195], v101, s[20:23], s45 offen offset:0
  buffer_load_dwordx4 v[196:199], v101, s[20:23], s44 offen offset:0
  buffer_load_dwordx4 v[200:203], v101, s[20:23], s45 offen offset:2048
  buffer_load_dwordx4 v[204:207], v101, s[20:23], s44 offen offset:2048
  s_add_u32 s45, s45, 4096
  s_add_u32 s44, s44, 4096
  s_waitcnt vmcnt(8)
  v_mov_b32 v5, 0
  v_mov_b32 v6, 1
  s_mov_b64 exec, 1
  buffer_store_dword v6, v5, s[20:23], s30 offen sc1
  s_mov_b64 exec, -1
  buffer_load_dwordx4 v[208:211], v101, s[20:23], s45 offen offset:0
  buffer_load_dwordx4 v[212:215], v101, s[20:23], s44 offen offset:0
  buffer_load_dwordx4 v[216:219], v101, s[20:23], s45 offen offset:2048
  buffer_load_dwordx4 v[220:223], v101, s[20:23], s44 offen offset:2048
  s_add_u32 s45, s45, 4096
  s_add_u32 s44, s44, 4096
  buffer_load_dwordx4 v[224:227], v101, s[20:23], s45 offen offset:0
  buffer_load_dwordx4 v[228:231], v101, s[20:23], s44 offen offset:0
  buffer_load_dwordx4 v[232:235], v101, s[20:23], s45 offen offset:2048
  buffer_load_dwordx4 v[236:239], v101, s[20:23], s44 offen offset:2048
  s_branch psd_78
psinv_77:
  s_waitcnt vmcnt(0)
  v_mov_b32 v5, 0
  v_mov_b32 v6, 1
  s_mov_b64 exec, 1
  buffer_store_dword v6, v5, s[20:23], s30 offen sc1
  s_mov_b64 exec, -1
psd_78:
  s_branch attexit_81
attfb_74:
  s_mov_b32 s38, 1
  v_cndmask_b32_e64 v14, v14, 0, s[36:37]
  v_cndmask_b32_e64 v22, v22, 0, s[36:37]
  v_cndmask_b32_e64 v30, v30, 0, s[36:37]
  v_cndmask_b32_e64 v38, v38, 0, s[36:37]
  v_mov_b32 v104, 0xff800000
  v_mov_b32 v105, 0xff800000
  v_mov_b32 v106, 0xff800000
  v_mov_b32 v107, 0xff800000
  s_mov_b32 s32, 0
fbloop_82:
  s_and_b32 s34, s32, 15
  s_add_u32 s34, s34, s33
  s_lshl_b32 s34, s34, 9
  s_add_u32 s34, s34, s27
  buffer_load_dwordx4 v[40:43], v2, s[20:23], s34 offen
  buffer_load_dwordx4 v[44:47], v3, s[20:23], s34 offen
  s_waitcnt vmcnt(0)
  v_mfma_f32_32x32x16_bf16 v[72:87], v[40:43], v[8:11], 0
  v_mfma_f32_32x32x16_bf16 v[72:87], v[44:47], v[12:15], v[72:87]
  v_mfma_f32_32x32x16_bf16 v[88:103], v[40:43], v[16:19], 0
  v_mfma_f32_32x32x16_bf16 v[88:103], v[44:47], v[20:23], v[88:103]
  v_mfma_f32_32x32x16_bf16 v[224:239], v[40:43], v[24:27], 0
  v_mfma_f32_32x32x16_bf16 v[224:239], v[44:47], v[28:31], v[224:239]
  v_mfma_f32_32x32x16_bf16 v[240:255], v[40:43], v[32:35], 0
  v_mfma_f32_32x32x16_bf16 v[240:255], v[44:47], v[36:39], v[240:255]
  s_nop 5
  v_max3_f32 v104, v104, v72, v73
  v_max3_f32 v104, v104, v74, v75
  v_max3_f32 v104, v104, v76, v77
  v_max3_f32 v104, v104, v78, v79
  v_max3_f32 v104, v104, v80, v81
  v_max3_f32 v104, v104, v82, v83
  v_max3_f32 v104, v104, v84, v85
  v_max3_f32 v104, v104, v86, v87
  v_max3_f32 v105, v105, v88, v89
  v_max3_f32 v105, v105, v90, v91
  v_max3_f32 v105, v105, v92, v93
  v_max3_f32 v105, v105, v94, v95
  v_max3_f32 v105, v105, v96, v97
  v_max3_f32 v105, v105, v98, v99
  v_max3_f32 v105, v105, v100, v101
  v_max3_f32 v105, v105, v102, v103
  v_max3_f32 v106, v106, v224, v225
  v_max3_f32 v106, v106, v226, v227
  v_max3_f32 v106, v106, v228, v229
  v_max3_f32 v106, v106, v230, v231
  v_max3_f32 v106, v106, v232, v233
  v_max3_f32 v106, v106, v234, v235
  v_max3_f32 v106, v106, v236, v237
  v_max3_f32 v106, v106, v238, v239
  v_max3_f32 v107, v107, v240, v241
  v_max3_f32 v107, v107, v242, v243
  v_max3_f32 v107, v107, v244, v245
  v_max3_f32 v107, v107, v246, v247
  v_max3_f32 v107, v107, v248, v249
  v_max3_f32 v107, v107, v250, v251
  v_max3_f32 v107, v107, v252, v253
  v_max3_f32 v107, v107, v254, v255
  s_add_u32 s32, s32, 1
  s_cmp_lt_u32 s32, 16
  s_cbranch_scc1 fbloop_82
  s_add_u32 s58, s58, 4
  v_mov_b32 v95, 1
  s_mov_b64 exec, 1
  ds_add_u32 v1, v95 offset:0
  s_mov_b64 exec, -1
lw_83:
  ds_read_b32 v95, v1 offset:0
  s_waitcnt lgkmcnt(0)
  v_readfirstlane_b32 s57, v95
  s_nop 0
  s_cmp_ge_u32 s57, s58
  s_cbranch_scc1 lwd_84
  s_sub_u32 s59, s59, 1
  s_nop 0
  s_cbranch_scc0 lw_83
  s_mov_b32 s59, 0
lwd_84:
  s_add_u32 s30, s3, 0
  s_and_b32 s30, s30, 3
  s_lshl_b32 s30, s30, 8
  s_lshl_b32 s31, s3, 10
  s_add_u32 s30, s30, s31
  s_add_u32 s30, s30, 90112
  v_lshl_add_u32 v5, v0, 2, s30
  ds_write_b32 v5, v104
  s_add_u32 s30, s3, 1
  s_and_b32 s30, s30, 3
  s_lshl_b32 s30, s30, 8
  s_lshl_b32 s31, s3, 10
  s_add_u32 s30, s30, s31
  s_add_u32 s30, s30, 90112
  v_lshl_add_u32 v5, v0, 2, s30
  ds_write_b32 v5, v105
  s_add_u32 s30, s3, 2
  s_and_b32 s30, s30, 3
  s_lshl_b32 s30, s30, 8
  s_lshl_b32 s31, s3, 10
  s_add_u32 s30, s30, s31
  s_add_u32 s30, s30, 90112
  v_lshl_add_u32 v5, v0, 2, s30
  ds_write_b32 v5, v106
  s_add_u32 s30, s3, 3
  s_and_b32 s30, s30, 3
  s_lshl_b32 s30, s30, 8
  s_lshl_b32 s31, s3, 10
  s_add_u32 s30, s30, s31
  s_add_u32 s30, s30, 90112
  v_lshl_add_u32 v5, v0, 2, s30
  ds_write_b32 v5, v107
  s_waitcnt lgkmcnt(0)
  s_add_u32 s58, s58, 4
  v_mov_b32 v95, 1
  s_mov_b64 exec, 1
  ds_add_u32 v1, v95 offset:0
  s_mov_b64 exec, -1
lw_85:
  ds_read_b32 v95, v1 offset:0
  s_waitcnt lgkmcnt(0)
  v_readfirstlane_b32 s57, v95
  s_nop 0
  s_cmp_ge_u32 s57, s58
  s_cbranch_scc1 lwd_86
  s_sub_u32 s59, s59, 1
  s_nop 0
  s_cbranch_scc0 lw_85
  s_mov_b32 s59, 0
lwd_86:
  s_add_u32 s30, s3, 0
  s_and_b32 s30, s30, 3
  s_lshl_b32 s30, s30, 8
  s_add_u32 s30, s30, 90112
  v_lshl_add_u32 v5, v0, 2, s30
  ds_read_b32 v72, v5 offset:0
  ds_read_b32 v73, v5 offset:1024
  ds_read_b32 v74, v5 offset:2048
  ds_read_b32 v75, v5 offset:3072
  s_add_u32 s30, s3, 1
  s_and_b32 s30, s30, 3
  s_lshl_b32 s30, s30, 8
  s_add_u32 s30, s30, 90112
  v_lshl_add_u32 v5, v0, 2, s30
  ds_read_b32 v76, v5 offset:0
  ds_read_b32 v77, v5 offset:1024
  ds_read_b32 v78, v5 offset:2048
  ds_read_b32 v79, v5 offset:3072
  s_add_u32 s30, s3, 2
  s_and_b32 s30, s30, 3
  s_lshl_b32 s30, s30, 8
  s_add_u32 s30, s30, 90112
  v_lshl_add_u32 v5, v0, 2, s30
  ds_read_b32 v80, v5 offset:0
  ds_read_b32 v81, v5 offset:1024
  ds_read_b32 v82, v5 offset:2048
  ds_read_b32 v83, v5 offset:3072
  s_add_u32 s30, s3, 3
  s_and_b32 s30, s30, 3
  s_lshl_b32 s30, s30, 8
  s_add_u32 s30, s30, 90112
  v_lshl_add_u32 v5, v0, 2, s30
  ds_read_b32 v84, v5 offset:0
  ds_read_b32 v85, v5 offset:1024
  ds_read_b32 v86, v5 offset:2048
  ds_read_b32 v87, v5 offset:3072
  s_waitcnt lgkmcnt(0)
  v_max3_f32 v104, v72, v73, v74
  v_max_f32 v104, v104, v75
  v_max3_f32 v105, v76, v77, v78
  v_max_f32 v105, v105, v79
  v_max3_f32 v106, v80, v81, v82
  v_max_f32 v106, v106, v83
  v_max3_f32 v107, v84, v85, v86
  v_max_f32 v107, v107, v87
  s_add_u32 s58, s58, 4
  v_mov_b32 v95, 1
  s_mov_b64 exec, 1
  ds_add_u32 v1, v95 offset:0
  s_mov_b64 exec, -1
lw_87:
  ds_read_b32 v95, v1 offset:0
  s_waitcnt lgkmcnt(0)
  v_readfirstlane_b32 s57, v95
  s_nop 0
  s_cmp_ge_u32 s57, s58
  s_cbranch_scc1 lwd_88
  s_sub_u32 s59, s59, 1
  s_nop 0
  s_cbranch_scc0 lw_87
  s_mov_b32 s59, 0
lwd_88:
  s_mov_b32 s32, s25
  s_add_u32 s39, s32, 0
  s_and_b32 s34, s39, 15
  s_add_u32 s34, s34, s33
  s_lshl_b32 s34, s34, 9
  s_add_u32 s34, s34, s27
  buffer_load_dwordx4 v[40:43], v2, s[20:23], s34 offen
  buffer_load_dwordx4 v[44:47], v3, s[20:23], s34 offen
  s_and_b32 s35, s39, 15
  s_add_u32 s35, s35, s33
  s_lshl_b32 s35, s35, 11
  s_add_u32 s35, s35, s28
  buffer_load_dwordx4 v[56:59], v4, s[20:23], s35 offen
  buffer_load_dwordx4 v[60:63], v4, s[20:23], s35 offen offset:1024
  s_add_u32 s39, s32, 1
  s_and_b32 s34, s39, 15
  s_add_u32 s34, s34, s33
  s_lshl_b32 s34, s34, 9
  s_add_u32 s34, s34, s27
  buffer_load_dwordx4 v[48:51], v2, s[20:23], s34 offen
  buffer_load_dwordx4 v[52:55], v3, s[20:23], s34 offen
  s_and_b32 s35, s39, 15
  s_add_u32 s35, s35, s33
  s_lshl_b32 s35, s35, 11
  s_add_u32 s35, s35, s28
  buffer_load_dwordx4 v[64:67], v4, s[20:23], s35 offen
  buffer_load_dwordx4 v[68:71], v4, s[20:23], s35 offen offset:1024
  s_add_u32 s39, s32, 2
  s_and_b32 s34, s39, 15
  s_add_u32 s34, s34, s33
  s_lshl_b32 s34, s34, 9
  s_add_u32 s34, s34, s27
  buffer_load_dwordx4 v[176:179], v2, s[20:23], s34 offen
  buffer_load_dwordx4 v[180:183], v3, s[20:23], s34 offen
  s_and_b32 s35, s39, 15
  s_add_u32 s35, s35, s33
  s_lshl_b32 s35, s35, 11
  s_add_u32 s35, s35, s28
  buffer_load_dwordx4 v[192:195], v4, s[20:23], s35 offen
  buffer_load_dwordx4 v[196:199], v4, s[20:23], s35 offen offset:1024
  s_add_u32 s39, s32, 3
  s_and_b32 s34, s39, 15
  s_add_u32 s34, s34, s33
  s_lshl_b32 s34, s34, 9
  s_add_u32 s34, s34, s27
  buffer_load_dwordx4 v[184:187], v2, s[20:23], s34 offen
  buffer_load_dwordx4 v[188:191], v3, s[20:23], s34 offen
  v_mov_b32 v112, 0
  v_mov_b32 v113, 0
  v_mov_b32 v114, 0
  v_mov_b32 v115, 0
  v_mov_b32 v116, 0
  v_mov_b32 v117, 0
  v_mov_b32 v118, 0
  v_mov_b32 v119, 0
  v_mov_b32 v120, 0
  v_mov_b32 v121, 0
  v_mov_b32 v122, 0
  v_mov_b32 v123, 0
  v_mov_b32 v124, 0
  v_mov_b32 v125, 0
  v_mov_b32 v126, 0
  v_mov_b32 v127, 0
  v_mov_b32 v128, 0
  v_mov_b32 v129, 0
  v_mov_b32 v130, 0
  v_mov_b32 v131, 0
  v_mov_b32 v132, 0
  v_mov_b32 v133, 0
  v_mov_b32 v134, 0
  v_mov_b32 v135, 0
  v_mov_b32 v136, 0
  v_mov_b32 v137, 0
  v_mov_b32 v138, 0
  v_mov_b32 v139, 0
  v_mov_b32 v140, 0
  v_mov_b32 v141, 0
  v_mov_b32 v142, 0
  v_mov_b32 v143, 0
  v_mov_b32 v144, 0
  v_mov_b32 v145, 0
  v_mov_b32 v146, 0
  v_mov_b32 v147, 0
  v_mov_b32 v148, 0
  v_mov_b32 v149, 0
  v_mov_b32 v150, 0
  v_mov_b32 v151, 0
  v_mov_b32 v152, 0
  v_mov_b32 v153, 0
  v_mov_b32 v154, 0
  v_mov_b32 v155, 0
  v_mov_b32 v156, 0
  v_mov_b32 v157, 0
  v_mov_b32 v158, 0
  v_mov_b32 v159, 0
  v_mov_b32 v160, 0
  v_mov_b32 v161, 0
  v_mov_b32 v162, 0
  v_mov_b32 v163, 0
  v_mov_b32 v164, 0
  v_mov_b32 v165, 0
  v_mov_b32 v166, 0
  v_mov_b32 v167, 0
  v_mov_b32 v168, 0
  v_mov_b32 v169, 0
  v_mov_b32 v170, 0
  v_mov_b32 v171, 0
  v_mov_b32 v172, 0
  v_mov_b32 v173, 0
  v_mov_b32 v174, 0
  v_mov_b32 v175, 0
  s_branch setm_71
attexit_81:
  s_cmp_ge_u32 s42, 7
  s_cbranch_scc1 Aend_62
  v_and_b32 v96, 31, v0
  v_lshrrev_b32 v97, 5, v0
  s_lshl_b32 s49, s41, 6
  s_lshl_b32 s50, s47, 5
  s_add_u32 s49, s49, s50
  v_add_u32 v99, s49, v96
  v_mul_u32_u24 v99, 896, v99
  v_lshl_add_u32 v99, v97, 5, v99
  s_lshl_b32 s50, s42, 7
  s_lshl_b32 s51, s48, 6
  s_add_u32 s50, s50, s51
  v_lshlrev_b32 v2, 11, v97
  v_add_u32 v2, v2, v96
  v_lshlrev_b32 v2, 4, v2
  s_lshl_b32 s52, s47, 9
  v_add_u32 v3, s52, v2
  s_xor_b32 s52, s52, 512
  v_add_u32 v4, s52, v2
  s_lshl_b32 s52, s3, 15
  s_lshl_b32 s53, s41, 6
  s_add_u32 s52, s52, s53
  s_lshl_b32 s52, s52, 4
  s_add_u32 s52, s52, 15171584
  s_cmp_lg_u32 s3, 0
  s_nop 0
  s_cbranch_scc1 fow_89
lw_91:
  ds_read_b32 v102, v1 offset:20
  s_waitcnt lgkmcnt(0)
  v_readfirstlane_b32 s57, v102
  s_nop 0
  s_cmp_ge_u32 s57, 4
  s_nop 0
  s_cbranch_scc1 lwd_92
  s_sub_u32 s59, s59, 1
  s_nop 0
  s_cbranch_scc0 lw_91
  s_mov_b32 s59, 0
lwd_92:
  v_and_b32 v102, 31, v0
  v_mul_u32_u24 v102, 128, v102
  s_mul_i32 s55, s41, 4096
  s_add_u32 s55, s55, 44171264
gp_93:
  buffer_load_dword v103, v102, s[20:23], s55 offen sc1
  s_waitcnt vmcnt(0)
  v_cmp_eq_u32 vcc, 0, v103
  s_nop 0
  s_cmp_eq_u64 vcc, 0
  s_cbranch_scc1 gpd_94
  s_sub_u32 s59, s59, 1
  s_nop 0
  s_cbranch_scc0 gp_93
  s_mov_b32 s59, 0
gpd_94:
  v_mov_b32 v102, 1
  s_mov_b64 exec, 1
  ds_add_u32 v1, v102 offset:16
  s_mov_b64 exec, -1
  s_branch fod_90
fow_89:
lw_95:
  ds_read_b32 v102, v1 offset:16
  s_waitcnt lgkmcnt(0)
  v_readfirstlane_b32 s57, v102
  s_nop 0
  s_cmp_ge_u32 s57, 1
  s_cbranch_scc1 lwd_96
  s_sub_u32 s59, s59, 1
  s_nop 0
  s_cbranch_scc0 lw_95
  s_mov_b32 s59, 0
lwd_96:
fod_90:
  buffer_load_dwordx4 v[8:11], v3, s[20:23], s52 offen sc1
  buffer_load_dwordx4 v[12:15], v4, s[20:23], s52 offen sc1
  s_add_u32 s52, s52, 65536
  buffer_load_dwordx4 v[16:19], v3, s[20:23], s52 offen sc1
  buffer_load_dwordx4 v[20:23], v4, s[20:23], s52 offen sc1
  s_add_u32 s52, s52, 65536
  buffer_load_dwordx4 v[24:27], v3, s[20:23], s52 offen sc1
  buffer_load_dwordx4 v[28:31], v4, s[20:23], s52 offen sc1
  s_add_u32 s52, s52, 65536
  buffer_load_dwordx4 v[32:35], v3, s[20:23], s52 offen sc1
  buffer_load_dwordx4 v[36:39], v4, s[20:23], s52 offen sc1
  s_add_u32 s52, s52, 65536
  buffer_load_dwordx4 v[40:43], v3, s[20:23], s52 offen sc1
  buffer_load_dwordx4 v[44:47], v4, s[20:23], s52 offen sc1
  s_add_u32 s52, s52, 65536
  buffer_load_dwordx4 v[48:51], v3, s[20:23], s52 offen sc1
  buffer_load_dwordx4 v[52:55], v4, s[20:23], s52 offen sc1
  s_add_u32 s52, s52, 65536
  buffer_load_dwordx4 v[56:59], v3, s[20:23], s52 offen sc1
  buffer_load_dwordx4 v[60:63], v4, s[20:23], s52 offen sc1
  s_add_u32 s52, s52, 65536
  buffer_load_dwordx4 v[64:67], v3, s[20:23], s52 offen sc1
  buffer_load_dwordx4 v[68:71], v4, s[20:23], s52 offen sc1
  s_waitcnt vmcnt(14)
  v_mfma_f32_32x32x16_bf16 v[112:127], v[176:179], v[8:11], 0
  v_mfma_f32_32x32x16_bf16 v[128:143], v[176:179], v[12:15], 0
  v_mfma_f32_32x32x16_bf16 v[144:159], v[180:183], v[8:11], 0
  v_mfma_f32_32x32x16_bf16 v[160:175], v[180:183], v[12:15], 0
  s_waitcnt vmcnt(12)
  v_mfma_f32_32x32x16_bf16 v[112:127], v[184:187], v[16:19], v[112:127]
  v_mfma_f32_32x32x16_bf16 v[128:143], v[184:187], v[20:23], v[128:143]
  v_mfma_f32_32x32x16_bf16 v[144:159], v[188:191], v[16:19], v[144:159]
  v_mfma_f32_32x32x16_bf16 v[160:175], v[188:191], v[20:23], v[160:175]
  s_waitcnt vmcnt(10)
  v_mfma_f32_32x32x16_bf16 v[112:127], v[192:195], v[24:27], v[112:127]
  v_mfma_f32_32x32x16_bf16 v[128:143], v[192:195], v[28:31], v[128:143]
  v_mfma_f32_32x32x16_bf16 v[144:159], v[196:199], v[24:27], v[144:159]
  v_mfma_f32_32x32x16_bf16 v[160:175], v[196:199], v[28:31], v[160:175]
  s_waitcnt vmcnt(8)
  v_mfma_f32_32x32x16_bf16 v[112:127], v[200:203], v[32:35], v[112:127]
  v_mfma_f32_32x32x16_bf16 v[128:143], v[200:203], v[36:39], v[128:143]
  v_mfma_f32_32x32x16_bf16 v[144:159], v[204:207], v[32:35], v[144:159]
  v_mfma_f32_32x32x16_bf16 v[160:175], v[204:207], v[36:39], v[160:175]
  s_waitcnt vmcnt(6)
  v_mfma_f32_32x32x16_bf16 v[112:127], v[208:211], v[40:43], v[112:127]
  v_mfma_f32_32x32x16_bf16 v[128:143], v[208:211], v[44:47], v[128:143]
  v_mfma_f32_32x32x16_bf16 v[144:159], v[212:215], v[40:43], v[144:159]
  v_mfma_f32_32x32x16_bf16 v[160:175], v[212:215], v[44:47], v[160:175]
  s_waitcnt vmcnt(4)
  v_mfma_f32_32x32x16_bf16 v[112:127], v[216:219], v[48:51], v[112:127]
  v_mfma_f32_32x32x16_bf16 v[128:143], v[216:219], v[52:55], v[128:143]
  v_mfma_f32_32x32x16_bf16 v[144:159], v[220:223], v[48:51], v[144:159]
  v_mfma_f32_32x32x16_bf16 v[160:175], v[220:223], v[52:55], v[160:175]
  s_waitcnt vmcnt(2)
  v_mfma_f32_32x32x16_bf16 v[112:127], v[224:227], v[56:59], v[112:127]
  v_mfma_f32_32x32x16_bf16 v[128:143], v[224:227], v[60:63], v[128:143]
  v_mfma_f32_32x32x16_bf16 v[144:159], v[228:231], v[56:59], v[144:159]
  v_mfma_f32_32x32x16_bf16 v[160:175], v[228:231], v[60:63], v[160:175]
  s_waitcnt vmcnt(0)
  v_mfma_f32_32x32x16_bf16 v[112:127], v[232:235], v[64:67], v[112:127]
  v_mfma_f32_32x32x16_bf16 v[128:143], v[232:235], v[68:71], v[128:143]
  v_mfma_f32_32x32x16_bf16 v[144:159], v[236:239], v[64:67], v[144:159]
  v_mfma_f32_32x32x16_bf16 v[160:175], v[236:239], v[68:71], v[160:175]
  s_add_u32 s58, s58, 4
  v_mov_b32 v102, 1
  s_mov_b64 exec, 1
  ds_add_u32 v1, v102 offset:0
  s_mov_b64 exec, -1
lw_97:
  ds_read_b32 v102, v1 offset:0
  s_waitcnt lgkmcnt(0)
  v_readfirstlane_b32 s57, v102
  s_nop 0
  s_cmp_ge_u32 s57, s58
  s_nop 0
  s_cbranch_scc1 lwd_98
  s_sub_u32 s59, s59, 1
  s_nop 0
  s_cbranch_scc0 lw_97
  s_mov_b32 s59, 0
lwd_98:
lw_99:
  ds_read_b32 v102, v1 offset:20
  s_waitcnt lgkmcnt(0)
  v_readfirstlane_b32 s57, v102
  s_nop 0
  s_cmp_ge_u32 s57, 4
  s_cbranch_scc1 lwd_100
  s_sub_u32 s59, s59, 1
  s_nop 0
  s_cbranch_scc0 lw_99
  s_mov_b32 s59, 0
lwd_100:
  s_mul_i32 s53, s3, 16384
  s_add_u32 s53, s53, 90112
  s_cmp_eq_u32 s3, 3
  s_cselect_b32 s53, 32768, s53
  s_xor_b32 s54, s3, 0
  s_lshl_b32 s54, s54, 12
  s_add_u32 s54, s54, s53
  v_lshl_add_u32 v5, v0, 4, s54
  ds_write_b128 v5, v[112:115] offset:0
  ds_write_b128 v5, v[116:119] offset:1024
  ds_write_b128 v5, v[120:123] offset:2048
  ds_write_b128 v5, v[124:127] offset:3072
  s_xor_b32 s54, s3, 1
  s_lshl_b32 s54, s54, 12
  s_add_u32 s54, s54, s53
  v_lshl_add_u32 v5, v0, 4, s54
  ds_write_b128 v5, v[128:131] offset:0
  ds_write_b128 v5, v[132:135] offset:1024
  ds_write_b128 v5, v[136:139] offset:2048
  ds_write_b128 v5, v[140:143] offset:3072
  s_xor_b32 s54, s3, 2
  s_lshl_b32 s54, s54, 12
  s_add_u32 s54, s54, s53
  v_lshl_add_u32 v5, v0, 4, s54
  ds_write_b128 v5, v[144:147] offset:0
  ds_write_b128 v5, v[148:151] offset:1024
  ds_write_b128 v5, v[152:155] offset:2048
  ds_write_b128 v5, v[156:159] offset:3072
  s_xor_b32 s54, s3, 3
  s_lshl_b32 s54, s54, 12
  s_add_u32 s54, s54, s53
  v_lshl_add_u32 v5, v0, 4, s54
  ds_write_b128 v5, v[160:163] offset:0
  ds_write_b128 v5, v[164:167] offset:1024
  ds_write_b128 v5, v[168:171] offset:2048
  ds_write_b128 v5, v[172:175] offset:3072
  s_waitcnt lgkmcnt(0)
  v_mov_b32 v102, 1
  s_mov_b64 exec, 1
  ds_add_u32 v1, v102 offset:12
  s_mov_b64 exec, -1
Aend_62:
  s_endpgm
KMB_1:
  s_cmp_ge_u32 s2, 224
  s_cbranch_scc1 KMBsp_101
  s_sub_u32 s40, s3, 4
  s_mov_b32 s38, 0
  s_mov_b32 s39, 131072
  s_and_b32 s43, s2, 7
  s_lshr_b32 s41, s43, 1
  s_lshl_b32 s41, s41, 3
  s_and_b32 s43, s43, 1
  s_lshl_b32 s42, s43, 2
  s_cmp_ge_u32 s2, 192
  s_cbranch_scc1 bm1_102
  s_lshr_b32 s43, s2, 3
  s_and_b32 s43, s43, 7
  s_add_u32 s41, s41, s43
  s_lshr_b32 s43, s2, 6
  s_add_u32 s42, s42, s43
  s_branch bm2_103
bm1_102:
  s_add_u32 s41, s41, s42
  s_lshr_b32 s43, s2, 3
  s_and_b32 s43, s43, 3
  s_add_u32 s41, s41, s43
  s_cmp_ge_u32 s2, 224
  s_cselect_b32 s42, 7, 3
bm2_103:
  s_waitcnt lgkmcnt(0)
  s_load_dwordx2 s[16:17], s[0:1], 64
  s_load_dwordx2 s[24:25], s[0:1], 72
  s_mov_b32 s18, 0x1c0000
  s_mov_b32 s19, 0x00020000
  s_mov_b32 s26, 256
  s_mov_b32 s27, 0x00020000
  v_mov_b32 v1, 139328
  v_and_b32 v2, 31, v0
  v_lshrrev_b32 v3, 5, v0
  v_bfe_u32 v4, v0, 1, 3
  v_xor_b32 v4, v4, v3
  v_lshlrev_b32 v5, 7, v2
  v_lshl_add_u32 v5, v4, 4, v5
  s_lshl_b32 s29, s40, 12
  v_add_u32 v12, s29, v5
  v_xor_b32 v13, 32, v12
  v_xor_b32 v14, 64, v12
  v_xor_b32 v15, 96, v12
  v_mov_b32 v24, 0
  v_mov_b32 v25, 0
  v_mov_b32 v26, 0
  v_mov_b32 v27, 0
  s_barrier
  ds_read_b128 v[32:35], v12 offset:0
  ds_read_b128 v[36:39], v13 offset:0
  ds_read_b128 v[40:43], v14 offset:0
  ds_read_b128 v[44:47], v15 offset:0
  v_add_u32 v16, 0x10000, v12
  v_add_u32 v20, 0x20000, v12
  v_add_u32 v17, 0x10000, v13
  v_add_u32 v21, 0x20000, v13
  v_add_u32 v18, 0x10000, v14
  v_add_u32 v22, 0x20000, v14
  v_add_u32 v19, 0x10000, v15
  v_add_u32 v23, 0x20000, v15
  s_waitcnt lgkmcnt(3)
  v_lshlrev_b32 v48, 16, v32
  v_and_b32 v49, 0xffff0000, v32
  v_add_f32 v24, v24, v48
  v_fma_f32 v25, v48, v48, v25
  v_add_f32 v26, v26, v49
  v_fma_f32 v27, v49, v49, v27
  v_lshlrev_b32 v48, 16, v33
  v_and_b32 v49, 0xffff0000, v33
  v_add_f32 v24, v24, v48
  v_fma_f32 v25, v48, v48, v25
  v_add_f32 v26, v26, v49
  v_fma_f32 v27, v49, v49, v27
  v_lshlrev_b32 v48, 16, v34
  v_and_b32 v49, 0xffff0000, v34
  v_add_f32 v24, v24, v48
  v_fma_f32 v25, v48, v48, v25
  v_add_f32 v26, v26, v49
  v_fma_f32 v27, v49, v49, v27
  v_lshlrev_b32 v48, 16, v35
  v_and_b32 v49, 0xffff0000, v35
  v_add_f32 v24, v24, v48
  v_fma_f32 v25, v48, v48, v25
  v_add_f32 v26, v26, v49
  v_fma_f32 v27, v49, v49, v27
  s_waitcnt lgkmcnt(2)
  v_lshlrev_b32 v48, 16, v36
  v_and_b32 v49, 0xffff0000, v36
  v_add_f32 v24, v24, v48
  v_fma_f32 v25, v48, v48, v25
  v_add_f32 v26, v26, v49
  v_fma_f32 v27, v49, v49, v27
  v_lshlrev_b32 v48, 16, v37
  v_and_b32 v49, 0xffff0000, v37
  v_add_f32 v24, v24, v48
  v_fma_f32 v25, v48, v48, v25
  v_add_f32 v26, v26, v49
  v_fma_f32 v27, v49, v49, v27
  v_lshlrev_b32 v48, 16, v38
  v_and_b32 v49, 0xffff0000, v38
  v_add_f32 v24, v24, v48
  v_fma_f32 v25, v48, v48, v25
  v_add_f32 v26, v26, v49
  v_fma_f32 v27, v49, v49, v27
  v_lshlrev_b32 v48, 16, v39
  v_and_b32 v49, 0xffff0000, v39
  v_add_f32 v24, v24, v48
  v_fma_f32 v25, v48, v48, v25
  v_add_f32 v26, v26, v49
  v_fma_f32 v27, v49, v49, v27
  s_waitcnt lgkmcnt(1)
  v_lshlrev_b32 v48, 16, v40
  v_and_b32 v49, 0xffff0000, v40
  v_add_f32 v24, v24, v48
  v_fma_f32 v25, v48, v48, v25
  v_add_f32 v26, v26, v49
  v_fma_f32 v27, v49, v49, v27
  v_lshlrev_b32 v48, 16, v41
  v_and_b32 v49, 0xffff0000, v41
  v_add_f32 v24, v24, v48
  v_fma_f32 v25, v48, v48, v25
  v_add_f32 v26, v26, v49
  v_fma_f32 v27, v49, v49, v27
  v_lshlrev_b32 v48, 16, v42
  v_and_b32 v49, 0xffff0000, v42
  v_add_f32 v24, v24, v48
  v_fma_f32 v25, v48, v48, v25
  v_add_f32 v26, v26, v49
  v_fma_f32 v27, v49, v49, v27
  v_lshlrev_b32 v48, 16, v43
  v_and_b32 v49, 0xffff0000, v43
  v_add_f32 v24, v24, v48
  v_fma_f32 v25, v48, v48, v25
  v_add_f32 v26, v26, v49
  v_fma_f32 v27, v49, v49, v27
  s_waitcnt lgkmcnt(0)
  v_lshlrev_b32 v48, 16, v44
  v_and_b32 v49, 0xffff0000, v44
  v_add_f32 v24, v24, v48
  v_fma_f32 v25, v48, v48, v25
  v_add_f32 v26, v26, v49
  v_fma_f32 v27, v49, v49, v27
  v_lshlrev_b32 v48, 16, v45
  v_and_b32 v49, 0xffff0000, v45
  v_add_f32 v24, v24, v48
  v_fma_f32 v25, v48, v48, v25
  v_add_f32 v26, v26, v49
  v_fma_f32 v27, v49, v49, v27
  v_lshlrev_b32 v48, 16, v46
  v_and_b32 v49, 0xffff0000, v46
  v_add_f32 v24, v24, v48
  v_fma_f32 v25, v48, v48, v25
  v_add_f32 v26, v26, v49
  v_fma_f32 v27, v49, v49, v27
  v_lshlrev_b32 v48, 16, v47
  v_and_b32 v49, 0xffff0000, v47
  v_add_f32 v24, v24, v48
  v_fma_f32 v25, v48, v48, v25
  v_add_f32 v26, v26, v49
  v_fma_f32 v27, v49, v49, v27
  s_barrier
  ds_read_b128 v[32:35], v12 offset:32768
  ds_read_b128 v[36:39], v13 offset:32768
  ds_read_b128 v[40:43], v14 offset:32768
  ds_read_b128 v[44:47], v15 offset:32768
  s_waitcnt lgkmcnt(3)
  v_lshlrev_b32 v48, 16, v32
  v_and_b32 v49, 0xffff0000, v32
  v_add_f32 v24, v24, v48
  v_fma_f32 v25, v48, v48, v25
  v_add_f32 v26, v26, v49
  v_fma_f32 v27, v49, v49, v27
  v_lshlrev_b32 v48, 16, v33
  v_and_b32 v49, 0xffff0000, v33
  v_add_f32 v24, v24, v48
  v_fma_f32 v25, v48, v48, v25
  v_add_f32 v26, v26, v49
  v_fma_f32 v27, v49, v49, v27
  v_lshlrev_b32 v48, 16, v34
  v_and_b32 v49, 0xffff0000, v34
  v_add_f32 v24, v24, v48
  v_fma_f32 v25, v48, v48, v25
  v_add_f32 v26, v26, v49
  v_fma_f32 v27, v49, v49, v27
  v_lshlrev_b32 v48, 16, v35
  v_and_b32 v49, 0xffff0000, v35
  v_add_f32 v24, v24, v48
  v_fma_f32 v25, v48, v48, v25
  v_add_f32 v26, v26, v49
  v_fma_f32 v27, v49, v49, v27
  s_waitcnt lgkmcnt(2)
  v_lshlrev_b32 v48, 16, v36
  v_and_b32 v49, 0xffff0000, v36
  v_add_f32 v24, v24, v48
  v_fma_f32 v25, v48, v48, v25
  v_add_f32 v26, v26, v49
  v_fma_f32 v27, v49, v49, v27
  v_lshlrev_b32 v48, 16, v37
  v_and_b32 v49, 0xffff0000, v37
  v_add_f32 v24, v24, v48
  v_fma_f32 v25, v48, v48, v25
  v_add_f32 v26, v26, v49
  v_fma_f32 v27, v49, v49, v27
  v_lshlrev_b32 v48, 16, v38
  v_and_b32 v49, 0xffff0000, v38
  v_add_f32 v24, v24, v48
  v_fma_f32 v25, v48, v48, v25
  v_add_f32 v26, v26, v49
  v_fma_f32 v27, v49, v49, v27
  v_lshlrev_b32 v48, 16, v39
  v_and_b32 v49, 0xffff0000, v39
  v_add_f32 v24, v24, v48
  v_fma_f32 v25, v48, v48, v25
  v_add_f32 v26, v26, v49
  v_fma_f32 v27, v49, v49, v27
  s_waitcnt lgkmcnt(1)
  v_lshlrev_b32 v48, 16, v40
  v_and_b32 v49, 0xffff0000, v40
  v_add_f32 v24, v24, v48
  v_fma_f32 v25, v48, v48, v25
  v_add_f32 v26, v26, v49
  v_fma_f32 v27, v49, v49, v27
  v_lshlrev_b32 v48, 16, v41
  v_and_b32 v49, 0xffff0000, v41
  v_add_f32 v24, v24, v48
  v_fma_f32 v25, v48, v48, v25
  v_add_f32 v26, v26, v49
  v_fma_f32 v27, v49, v49, v27
  v_lshlrev_b32 v48, 16, v42
  v_and_b32 v49, 0xffff0000, v42
  v_add_f32 v24, v24, v48
  v_fma_f32 v25, v48, v48, v25
  v_add_f32 v26, v26, v49
  v_fma_f32 v27, v49, v49, v27
  v_lshlrev_b32 v48, 16, v43
  v_and_b32 v49, 0xffff0000, v43
  v_add_f32 v24, v24, v48
  v_fma_f32 v25, v48, v48, v25
  v_add_f32 v26, v26, v49
  v_fma_f32 v27, v49, v49, v27
  s_waitcnt lgkmcnt(0)
  v_lshlrev_b32 v48, 16, v44
  v_and_b32 v49, 0xffff0000, v44
  v_add_f32 v24, v24, v48
  v_fma_f32 v25, v48, v48, v25
  v_add_f32 v26, v26, v49
  v_fma_f32 v27, v49, v49, v27
  v_lshlrev_b32 v48, 16, v45
  v_and_b32 v49, 0xffff0000, v45
  v_add_f32 v24, v24, v48
  v_fma_f32 v25, v48, v48, v25
  v_add_f32 v26, v26, v49
  v_fma_f32 v27, v49, v49, v27
  v_lshlrev_b32 v48, 16, v46
  v_and_b32 v49, 0xffff0000, v46
  v_add_f32 v24, v24, v48
  v_fma_f32 v25, v48, v48, v25
  v_add_f32 v26, v26, v49
  v_fma_f32 v27, v49, v49, v27
  v_lshlrev_b32 v48, 16, v47
  v_and_b32 v49, 0xffff0000, v47
  v_add_f32 v24, v24, v48
  v_fma_f32 v25, v48, v48, v25
  v_add_f32 v26, v26, v49
  v_fma_f32 v27, v49, v49, v27
  s_barrier
  ds_read_b128 v[32:35], v16 offset:0
  ds_read_b128 v[36:39], v17 offset:0
  ds_read_b128 v[40:43], v18 offset:0
  ds_read_b128 v[44:47], v19 offset:0
  s_waitcnt lgkmcnt(3)
  v_lshlrev_b32 v48, 16, v32
  v_and_b32 v49, 0xffff0000, v32
  v_add_f32 v24, v24, v48
  v_fma_f32 v25, v48, v48, v25
  v_add_f32 v26, v26, v49
  v_fma_f32 v27, v49, v49, v27
  v_lshlrev_b32 v48, 16, v33
  v_and_b32 v49, 0xffff0000, v33
  v_add_f32 v24, v24, v48
  v_fma_f32 v25, v48, v48, v25
  v_add_f32 v26, v26, v49
  v_fma_f32 v27, v49, v49, v27
  v_lshlrev_b32 v48, 16, v34
  v_and_b32 v49, 0xffff0000, v34
  v_add_f32 v24, v24, v48
  v_fma_f32 v25, v48, v48, v25
  v_add_f32 v26, v26, v49
  v_fma_f32 v27, v49, v49, v27
  v_lshlrev_b32 v48, 16, v35
  v_and_b32 v49, 0xffff0000, v35
  v_add_f32 v24, v24, v48
  v_fma_f32 v25, v48, v48, v25
  v_add_f32 v26, v26, v49
  v_fma_f32 v27, v49, v49, v27
  s_waitcnt lgkmcnt(2)
  v_lshlrev_b32 v48, 16, v36
  v_and_b32 v49, 0xffff0000, v36
  v_add_f32 v24, v24, v48
  v_fma_f32 v25, v48, v48, v25
  v_add_f32 v26, v26, v49
  v_fma_f32 v27, v49, v49, v27
  v_lshlrev_b32 v48, 16, v37
  v_and_b32 v49, 0xffff0000, v37
  v_add_f32 v24, v24, v48
  v_fma_f32 v25, v48, v48, v25
  v_add_f32 v26, v26, v49
  v_fma_f32 v27, v49, v49, v27
  v_lshlrev_b32 v48, 16, v38
  v_and_b32 v49, 0xffff0000, v38
  v_add_f32 v24, v24, v48
  v_fma_f32 v25, v48, v48, v25
  v_add_f32 v26, v26, v49
  v_fma_f32 v27, v49, v49, v27
  v_lshlrev_b32 v48, 16, v39
  v_and_b32 v49, 0xffff0000, v39
  v_add_f32 v24, v24, v48
  v_fma_f32 v25, v48, v48, v25
  v_add_f32 v26, v26, v49
  v_fma_f32 v27, v49, v49, v27
  s_waitcnt lgkmcnt(1)
  v_lshlrev_b32 v48, 16, v40
  v_and_b32 v49, 0xffff0000, v40
  v_add_f32 v24, v24, v48
  v_fma_f32 v25, v48, v48, v25
  v_add_f32 v26, v26, v49
  v_fma_f32 v27, v49, v49, v27
  v_lshlrev_b32 v48, 16, v41
  v_and_b32 v49, 0xffff0000, v41
  v_add_f32 v24, v24, v48
  v_fma_f32 v25, v48, v48, v25
  v_add_f32 v26, v26, v49
  v_fma_f32 v27, v49, v49, v27
  v_lshlrev_b32 v48, 16, v42
  v_and_b32 v49, 0xffff0000, v42
  v_add_f32 v24, v24, v48
  v_fma_f32 v25, v48, v48, v25
  v_add_f32 v26, v26, v49
  v_fma_f32 v27, v49, v49, v27
  v_lshlrev_b32 v48, 16, v43
  v_and_b32 v49, 0xffff0000, v43
  v_add_f32 v24, v24, v48
  v_fma_f32 v25, v48, v48, v25
  v_add_f32 v26, v26, v49
  v_fma_f32 v27, v49, v49, v27
  s_waitcnt lgkmcnt(0)
  v_lshlrev_b32 v48, 16, v44
  v_and_b32 v49, 0xffff0000, v44
  v_add_f32 v24, v24, v48
  v_fma_f32 v25, v48, v48, v25
  v_add_f32 v26, v26, v49
  v_fma_f32 v27, v49, v49, v27
  v_lshlrev_b32 v48, 16, v45
  v_and_b32 v49, 0xffff0000, v45
  v_add_f32 v24, v24, v48
  v_fma_f32 v25, v48, v48, v25
  v_add_f32 v26, v26, v49
  v_fma_f32 v27, v49, v49, v27
  v_lshlrev_b32 v48, 16, v46
  v_and_b32 v49, 0xffff0000, v46
  v_add_f32 v24, v24, v48
  v_fma_f32 v25, v48, v48, v25
  v_add_f32 v26, v26, v49
  v_fma_f32 v27, v49, v49, v27
  v_lshlrev_b32 v48, 16, v47
  v_and_b32 v49, 0xffff0000, v47
  v_add_f32 v24, v24, v48
  v_fma_f32 v25, v48, v48, v25
  v_add_f32 v26, v26, v49
  v_fma_f32 v27, v49, v49, v27
  s_barrier
  ds_read_b128 v[32:35], v16 offset:32768
  ds_read_b128 v[36:39], v17 offset:32768
  ds_read_b128 v[40:43], v18 offset:32768
  ds_read_b128 v[44:47], v19 offset:32768
  s_waitcnt lgkmcnt(3)
  v_lshlrev_b32 v48, 16, v32
  v_and_b32 v49, 0xffff0000, v32
  v_add_f32 v24, v24, v48
  v_fma_f32 v25, v48, v48, v25
  v_add_f32 v26, v26, v49
  v_fma_f32 v27, v49, v49, v27
  v_lshlrev_b32 v48, 16, v33
  v_and_b32 v49, 0xffff0000, v33
  v_add_f32 v24, v24, v48
  v_fma_f32 v25, v48, v48, v25
  v_add_f32 v26, v26, v49
  v_fma_f32 v27, v49, v49, v27
  v_lshlrev_b32 v48, 16, v34
  v_and_b32 v49, 0xffff0000, v34
  v_add_f32 v24, v24, v48
  v_fma_f32 v25, v48, v48, v25
  v_add_f32 v26, v26, v49
  v_fma_f32 v27, v49, v49, v27
  v_lshlrev_b32 v48, 16, v35
  v_and_b32 v49, 0xffff0000, v35
  v_add_f32 v24, v24, v48
  v_fma_f32 v25, v48, v48, v25
  v_add_f32 v26, v26, v49
  v_fma_f32 v27, v49, v49, v27
  s_waitcnt lgkmcnt(2)
  v_lshlrev_b32 v48, 16, v36
  v_and_b32 v49, 0xffff0000, v36
  v_add_f32 v24, v24, v48
  v_fma_f32 v25, v48, v48, v25
  v_add_f32 v26, v26, v49
  v_fma_f32 v27, v49, v49, v27
  v_lshlrev_b32 v48, 16, v37
  v_and_b32 v49, 0xffff0000, v37
  v_add_f32 v24, v24, v48
  v_fma_f32 v25, v48, v48, v25
  v_add_f32 v26, v26, v49
  v_fma_f32 v27, v49, v49, v27
  v_lshlrev_b32 v48, 16, v38
  v_and_b32 v49, 0xffff0000, v38
  v_add_f32 v24, v24, v48
  v_fma_f32 v25, v48, v48, v25
  v_add_f32 v26, v26, v49
  v_fma_f32 v27, v49, v49, v27
  v_lshlrev_b32 v48, 16, v39
  v_and_b32 v49, 0xffff0000, v39
  v_add_f32 v24, v24, v48
  v_fma_f32 v25, v48, v48, v25
  v_add_f32 v26, v26, v49
  v_fma_f32 v27, v49, v49, v27
  s_waitcnt lgkmcnt(1)
  v_lshlrev_b32 v48, 16, v40
  v_and_b32 v49, 0xffff0000, v40
  v_add_f32 v24, v24, v48
  v_fma_f32 v25, v48, v48, v25
  v_add_f32 v26, v26, v49
  v_fma_f32 v27, v49, v49, v27
  v_lshlrev_b32 v48, 16, v41
  v_and_b32 v49, 0xffff0000, v41
  v_add_f32 v24, v24, v48
  v_fma_f32 v25, v48, v48, v25
  v_add_f32 v26, v26, v49
  v_fma_f32 v27, v49, v49, v27
  v_lshlrev_b32 v48, 16, v42
  v_and_b32 v49, 0xffff0000, v42
  v_add_f32 v24, v24, v48
  v_fma_f32 v25, v48, v48, v25
  v_add_f32 v26, v26, v49
  v_fma_f32 v27, v49, v49, v27
  v_lshlrev_b32 v48, 16, v43
  v_and_b32 v49, 0xffff0000, v43
  v_add_f32 v24, v24, v48
  v_fma_f32 v25, v48, v48, v25
  v_add_f32 v26, v26, v49
  v_fma_f32 v27, v49, v49, v27
  s_waitcnt lgkmcnt(0)
  v_lshlrev_b32 v48, 16, v44
  v_and_b32 v49, 0xffff0000, v44
  v_add_f32 v24, v24, v48
  v_fma_f32 v25, v48, v48, v25
  v_add_f32 v26, v26, v49
  v_fma_f32 v27, v49, v49, v27
  v_lshlrev_b32 v48, 16, v45
  v_and_b32 v49, 0xffff0000, v45
  v_add_f32 v24, v24, v48
  v_fma_f32 v25, v48, v48, v25
  v_add_f32 v26, v26, v49
  v_fma_f32 v27, v49, v49, v27
  v_lshlrev_b32 v48, 16, v46
  v_and_b32 v49, 0xffff0000, v46
  v_add_f32 v24, v24, v48
  v_fma_f32 v25, v48, v48, v25
  v_add_f32 v26, v26, v49
  v_fma_f32 v27, v49, v49, v27
  v_lshlrev_b32 v48, 16, v47
  v_and_b32 v49, 0xffff0000, v47
  v_add_f32 v24, v24, v48
  v_fma_f32 v25, v48, v48, v25
  v_add_f32 v26, v26, v49
  v_fma_f32 v27, v49, v49, v27
  s_barrier
  v_mov_b32 v60, 0
  s_waitcnt lgkmcnt(0)
  buffer_load_dword v50, v60, s[24:27], 0 offen sc1
  ds_read_b128 v[32:35], v20 offset:0
  ds_read_b128 v[36:39], v21 offset:0
  ds_read_b128 v[40:43], v22 offset:0
  ds_read_b128 v[44:47], v23 offset:0
  s_waitcnt lgkmcnt(3)
  v_lshlrev_b32 v48, 16, v32
  v_and_b32 v49, 0xffff0000, v32
  v_add_f32 v24, v24, v48
  v_fma_f32 v25, v48, v48, v25
  v_add_f32 v26, v26, v49
  v_fma_f32 v27, v49, v49, v27
  v_lshlrev_b32 v48, 16, v33
  v_and_b32 v49, 0xffff0000, v33
  v_add_f32 v24, v24, v48
  v_fma_f32 v25, v48, v48, v25
  v_add_f32 v26, v26, v49
  v_fma_f32 v27, v49, v49, v27
  v_lshlrev_b32 v48, 16, v34
  v_and_b32 v49, 0xffff0000, v34
  v_add_f32 v24, v24, v48
  v_fma_f32 v25, v48, v48, v25
  v_add_f32 v26, v26, v49
  v_fma_f32 v27, v49, v49, v27
  v_lshlrev_b32 v48, 16, v35
  v_and_b32 v49, 0xffff0000, v35
  v_add_f32 v24, v24, v48
  v_fma_f32 v25, v48, v48, v25
  v_add_f32 v26, v26, v49
  v_fma_f32 v27, v49, v49, v27
  s_waitcnt lgkmcnt(2)
  v_lshlrev_b32 v48, 16, v36
  v_and_b32 v49, 0xffff0000, v36
  v_add_f32 v24, v24, v48
  v_fma_f32 v25, v48, v48, v25
  v_add_f32 v26, v26, v49
  v_fma_f32 v27, v49, v49, v27
  v_lshlrev_b32 v48, 16, v37
  v_and_b32 v49, 0xffff0000, v37
  v_add_f32 v24, v24, v48
  v_fma_f32 v25, v48, v48, v25
  v_add_f32 v26, v26, v49
  v_fma_f32 v27, v49, v49, v27
  v_lshlrev_b32 v48, 16, v38
  v_and_b32 v49, 0xffff0000, v38
  v_add_f32 v24, v24, v48
  v_fma_f32 v25, v48, v48, v25
  v_add_f32 v26, v26, v49
  v_fma_f32 v27, v49, v49, v27
  v_lshlrev_b32 v48, 16, v39
  v_and_b32 v49, 0xffff0000, v39
  v_add_f32 v24, v24, v48
  v_fma_f32 v25, v48, v48, v25
  v_add_f32 v26, v26, v49
  v_fma_f32 v27, v49, v49, v27
  s_waitcnt lgkmcnt(1)
  v_lshlrev_b32 v48, 16, v40
  v_and_b32 v49, 0xffff0000, v40
  v_add_f32 v24, v24, v48
  v_fma_f32 v25, v48, v48, v25
  v_add_f32 v26, v26, v49
  v_fma_f32 v27, v49, v49, v27
  v_lshlrev_b32 v48, 16, v41
  v_and_b32 v49, 0xffff0000, v41
  v_add_f32 v24, v24, v48
  v_fma_f32 v25, v48, v48, v25
  v_add_f32 v26, v26, v49
  v_fma_f32 v27, v49, v49, v27
  v_lshlrev_b32 v48, 16, v42
  v_and_b32 v49, 0xffff0000, v42
  v_add_f32 v24, v24, v48
  v_fma_f32 v25, v48, v48, v25
  v_add_f32 v26, v26, v49
  v_fma_f32 v27, v49, v49, v27
  v_lshlrev_b32 v48, 16, v43
  v_and_b32 v49, 0xffff0000, v43
  v_add_f32 v24, v24, v48
  v_fma_f32 v25, v48, v48, v25
  v_add_f32 v26, v26, v49
  v_fma_f32 v27, v49, v49, v27
  s_waitcnt lgkmcnt(0)
  v_lshlrev_b32 v48, 16, v44
  v_and_b32 v49, 0xffff0000, v44
  v_add_f32 v24, v24, v48
  v_fma_f32 v25, v48, v48, v25
  v_add_f32 v26, v26, v49
  v_fma_f32 v27, v49, v49, v27
  v_lshlrev_b32 v48, 16, v45
  v_and_b32 v49, 0xffff0000, v45
  v_add_f32 v24, v24, v48
  v_fma_f32 v25, v48, v48, v25
  v_add_f32 v26, v26, v49
  v_fma_f32 v27, v49, v49, v27
  v_lshlrev_b32 v48, 16, v46
  v_and_b32 v49, 0xffff0000, v46
  v_add_f32 v24, v24, v48
  v_fma_f32 v25, v48, v48, v25
  v_add_f32 v26, v26, v49
  v_fma_f32 v27, v49, v49, v27
  v_lshlrev_b32 v48, 16, v47
  v_and_b32 v49, 0xffff0000, v47
  v_add_f32 v24, v24, v48
  v_fma_f32 v25, v48, v48, v25
  v_add_f32 v26, v26, v49
  v_fma_f32 v27, v49, v49, v27
  s_barrier
  ds_read_b128 v[32:35], v12 offset:0
  ds_read_b128 v[36:39], v13 offset:0
  ds_read_b128 v[40:43], v14 offset:0
  ds_read_b128 v[44:47], v15 offset:0
  s_waitcnt lgkmcnt(3)
  v_lshlrev_b32 v48, 16, v32
  v_and_b32 v49, 0xffff0000, v32
  v_add_f32 v24, v24, v48
  v_fma_f32 v25, v48, v48, v25
  v_add_f32 v26, v26, v49
  v_fma_f32 v27, v49, v49, v27
  v_lshlrev_b32 v48, 16, v33
  v_and_b32 v49, 0xffff0000, v33
  v_add_f32 v24, v24, v48
  v_fma_f32 v25, v48, v48, v25
  v_add_f32 v26, v26, v49
  v_fma_f32 v27, v49, v49, v27
  v_lshlrev_b32 v48, 16, v34
  v_and_b32 v49, 0xffff0000, v34
  v_add_f32 v24, v24, v48
  v_fma_f32 v25, v48, v48, v25
  v_add_f32 v26, v26, v49
  v_fma_f32 v27, v49, v49, v27
  v_lshlrev_b32 v48, 16, v35
  v_and_b32 v49, 0xffff0000, v35
  v_add_f32 v24, v24, v48
  v_fma_f32 v25, v48, v48, v25
  v_add_f32 v26, v26, v49
  v_fma_f32 v27, v49, v49, v27
  s_waitcnt lgkmcnt(2)
  v_lshlrev_b32 v48, 16, v36
  v_and_b32 v49, 0xffff0000, v36
  v_add_f32 v24, v24, v48
  v_fma_f32 v25, v48, v48, v25
  v_add_f32 v26, v26, v49
  v_fma_f32 v27, v49, v49, v27
  v_lshlrev_b32 v48, 16, v37
  v_and_b32 v49, 0xffff0000, v37
  v_add_f32 v24, v24, v48
  v_fma_f32 v25, v48, v48, v25
  v_add_f32 v26, v26, v49
  v_fma_f32 v27, v49, v49, v27
  v_lshlrev_b32 v48, 16, v38
  v_and_b32 v49, 0xffff0000, v38
  v_add_f32 v24, v24, v48
  v_fma_f32 v25, v48, v48, v25
  v_add_f32 v26, v26, v49
  v_fma_f32 v27, v49, v49, v27
  v_lshlrev_b32 v48, 16, v39
  v_and_b32 v49, 0xffff0000, v39
  v_add_f32 v24, v24, v48
  v_fma_f32 v25, v48, v48, v25
  v_add_f32 v26, v26, v49
  v_fma_f32 v27, v49, v49, v27
  s_waitcnt lgkmcnt(1)
  v_lshlrev_b32 v48, 16, v40
  v_and_b32 v49, 0xffff0000, v40
  v_add_f32 v24, v24, v48
  v_fma_f32 v25, v48, v48, v25
  v_add_f32 v26, v26, v49
  v_fma_f32 v27, v49, v49, v27
  v_lshlrev_b32 v48, 16, v41
  v_and_b32 v49, 0xffff0000, v41
  v_add_f32 v24, v24, v48
  v_fma_f32 v25, v48, v48, v25
  v_add_f32 v26, v26, v49
  v_fma_f32 v27, v49, v49, v27
  v_lshlrev_b32 v48, 16, v42
  v_and_b32 v49, 0xffff0000, v42
  v_add_f32 v24, v24, v48
  v_fma_f32 v25, v48, v48, v25
  v_add_f32 v26, v26, v49
  v_fma_f32 v27, v49, v49, v27
  v_lshlrev_b32 v48, 16, v43
  v_and_b32 v49, 0xffff0000, v43
  v_add_f32 v24, v24, v48
  v_fma_f32 v25, v48, v48, v25
  v_add_f32 v26, v26, v49
  v_fma_f32 v27, v49, v49, v27
  s_waitcnt lgkmcnt(0)
  v_lshlrev_b32 v48, 16, v44
  v_and_b32 v49, 0xffff0000, v44
  v_add_f32 v24, v24, v48
  v_fma_f32 v25, v48, v48, v25
  v_add_f32 v26, v26, v49
  v_fma_f32 v27, v49, v49, v27
  v_lshlrev_b32 v48, 16, v45
  v_and_b32 v49, 0xffff0000, v45
  v_add_f32 v24, v24, v48
  v_fma_f32 v25, v48, v48, v25
  v_add_f32 v26, v26, v49
  v_fma_f32 v27, v49, v49, v27
  v_lshlrev_b32 v48, 16, v46
  v_and_b32 v49, 0xffff0000, v46
  v_add_f32 v24, v24, v48
  v_fma_f32 v25, v48, v48, v25
  v_add_f32 v26, v26, v49
  v_fma_f32 v27, v49, v49, v27
  v_lshlrev_b32 v48, 16, v47
  v_and_b32 v49, 0xffff0000, v47
  v_add_f32 v24, v24, v48
  v_fma_f32 v25, v48, v48, v25
  v_add_f32 v26, v26, v49
  v_fma_f32 v27, v49, v49, v27
  s_barrier
  s_waitcnt vmcnt(0)
  v_cmp_eq_u32 vcc, 0, v50
  s_nop 0
  s_cmp_eq_u64 vcc, 0
  s_cbranch_scc1 dbok_104
  v_mov_b32 v60, 0
dp_105:
  buffer_load_dword v61, v60, s[24:27], 0 offen sc1
  s_waitcnt vmcnt(0)
  v_cmp_eq_u32 vcc, 0, v61
  s_nop 0
  s_cmp_eq_u64 vcc, 0
  s_cbranch_scc1 dpd_106
  s_sub_u32 s39, s39, 1
  s_nop 0
  s_cbranch_scc0 dp_105
  s_mov_b32 s39, 0
dpd_106:
dbok_104:
  v_and_b32 v60, 31, v0
  v_add_u32 v60, 224, v60
  v_lshlrev_b32 v60, 7, v60
  s_mov_b32 s54, 44564480
  buffer_load_dword v51, v60, s[20:23], s54 offen sc1
  ds_read_b128 v[32:35], v12 offset:32768
  ds_read_b128 v[36:39], v13 offset:32768
  ds_read_b128 v[40:43], v14 offset:32768
  ds_read_b128 v[44:47], v15 offset:32768
  s_waitcnt lgkmcnt(3)
  v_lshlrev_b32 v48, 16, v32
  v_and_b32 v49, 0xffff0000, v32
  v_add_f32 v24, v24, v48
  v_fma_f32 v25, v48, v48, v25
  v_add_f32 v26, v26, v49
  v_fma_f32 v27, v49, v49, v27
  v_lshlrev_b32 v48, 16, v33
  v_and_b32 v49, 0xffff0000, v33
  v_add_f32 v24, v24, v48
  v_fma_f32 v25, v48, v48, v25
  v_add_f32 v26, v26, v49
  v_fma_f32 v27, v49, v49, v27
  v_lshlrev_b32 v48, 16, v34
  v_and_b32 v49, 0xffff0000, v34
  v_add_f32 v24, v24, v48
  v_fma_f32 v25, v48, v48, v25
  v_add_f32 v26, v26, v49
  v_fma_f32 v27, v49, v49, v27
  v_lshlrev_b32 v48, 16, v35
  v_and_b32 v49, 0xffff0000, v35
  v_add_f32 v24, v24, v48
  v_fma_f32 v25, v48, v48, v25
  v_add_f32 v26, v26, v49
  v_fma_f32 v27, v49, v49, v27
  s_waitcnt lgkmcnt(2)
  v_lshlrev_b32 v48, 16, v36
  v_and_b32 v49, 0xffff0000, v36
  v_add_f32 v24, v24, v48
  v_fma_f32 v25, v48, v48, v25
  v_add_f32 v26, v26, v49
  v_fma_f32 v27, v49, v49, v27
  v_lshlrev_b32 v48, 16, v37
  v_and_b32 v49, 0xffff0000, v37
  v_add_f32 v24, v24, v48
  v_fma_f32 v25, v48, v48, v25
  v_add_f32 v26, v26, v49
  v_fma_f32 v27, v49, v49, v27
  v_lshlrev_b32 v48, 16, v38
  v_and_b32 v49, 0xffff0000, v38
  v_add_f32 v24, v24, v48
  v_fma_f32 v25, v48, v48, v25
  v_add_f32 v26, v26, v49
  v_fma_f32 v27, v49, v49, v27
  v_lshlrev_b32 v48, 16, v39
  v_and_b32 v49, 0xffff0000, v39
  v_add_f32 v24, v24, v48
  v_fma_f32 v25, v48, v48, v25
  v_add_f32 v26, v26, v49
  v_fma_f32 v27, v49, v49, v27
  s_waitcnt lgkmcnt(1)
  v_lshlrev_b32 v48, 16, v40
  v_and_b32 v49, 0xffff0000, v40
  v_add_f32 v24, v24, v48
  v_fma_f32 v25, v48, v48, v25
  v_add_f32 v26, v26, v49
  v_fma_f32 v27, v49, v49, v27
  v_lshlrev_b32 v48, 16, v41
  v_and_b32 v49, 0xffff0000, v41
  v_add_f32 v24, v24, v48
  v_fma_f32 v25, v48, v48, v25
  v_add_f32 v26, v26, v49
  v_fma_f32 v27, v49, v49, v27
  v_lshlrev_b32 v48, 16, v42
  v_and_b32 v49, 0xffff0000, v42
  v_add_f32 v24, v24, v48
  v_fma_f32 v25, v48, v48, v25
  v_add_f32 v26, v26, v49
  v_fma_f32 v27, v49, v49, v27
  v_lshlrev_b32 v48, 16, v43
  v_and_b32 v49, 0xffff0000, v43
  v_add_f32 v24, v24, v48
  v_fma_f32 v25, v48, v48, v25
  v_add_f32 v26, v26, v49
  v_fma_f32 v27, v49, v49, v27
  s_waitcnt lgkmcnt(0)
  v_lshlrev_b32 v48, 16, v44
  v_and_b32 v49, 0xffff0000, v44
  v_add_f32 v24, v24, v48
  v_fma_f32 v25, v48, v48, v25
  v_add_f32 v26, v26, v49
  v_fma_f32 v27, v49, v49, v27
  v_lshlrev_b32 v48, 16, v45
  v_and_b32 v49, 0xffff0000, v45
  v_add_f32 v24, v24, v48
  v_fma_f32 v25, v48, v48, v25
  v_add_f32 v26, v26, v49
  v_fma_f32 v27, v49, v49, v27
  v_lshlrev_b32 v48, 16, v46
  v_and_b32 v49, 0xffff0000, v46
  v_add_f32 v24, v24, v48
  v_fma_f32 v25, v48, v48, v25
  v_add_f32 v26, v26, v49
  v_fma_f32 v27, v49, v49, v27
  v_lshlrev_b32 v48, 16, v47
  v_and_b32 v49, 0xffff0000, v47
  v_add_f32 v24, v24, v48
  v_fma_f32 v25, v48, v48, v25
  v_add_f32 v26, v26, v49
  v_fma_f32 v27, v49, v49, v27
  v_add_f32 v24, v24, v26
  v_add_f32 v25, v25, v27
  v_mov_b32 v26, v24
  v_mov_b32 v27, v25
  s_nop 0
  v_permlane32_swap_b32 v24, v26
  v_permlane32_swap_b32 v25, v27
  v_add_f32 v24, v24, v26
  v_add_f32 v25, v25, v27
  v_mul_f32 v24, 0x3b124925, v24
  v_mul_f32 v25, 0x3b124925, v25
  v_fma_f32 v25, -v24, v24, v25
  v_max_f32 v25, 0, v25
  v_add_f32 v28, 0x3727c5ac, v25
  v_rsq_f32 v28, v28
  s_nop 0
  v_mul_f32 v29, v28, v28
  v_mov_b32 v30, 0x3727c5ac
  v_fma_f32 v29, v25, v29, v30
  v_rsq_f32 v29, v29
  v_mul_f32 v30, v24, v28
  v_xor_b32 v30, 0x80000000, v30
  s_lshl_b32 s29, s40, 7
  s_add_u32 s29, s29, 65536
  v_lshl_add_u32 v3, v2, 2, s29
  ds_write_b32 v3, v28
  ds_write_b32 v3, v30 offset:512
  ds_write_b32 v3, v29 offset:1024
  s_cmp_lg_u32 s40, 0
  s_cbranch_scc1 bz_107
  v_mov_b32 v4, 0
  v_mov_b32 v5, 0
  v_mov_b32 v6, 0
  v_mov_b32 v7, 0
  ds_write_b128 v1, v[4:7] offset:0
  ds_write_b128 v1, v[4:7] offset:16
  ds_write_b128 v1, v[4:7] offset:32
  ds_write_b128 v1, v[4:7] offset:48
  ds_write_b128 v1, v[4:7] offset:64
  v_mov_b32 v62, 1
  s_mov_b64 exec, 1
  ds_add_u32 v1, v62 offset:44
  s_mov_b64 exec, -1
bz_107:
  s_waitcnt lgkmcnt(0)
  s_barrier
  s_setprio 0
  v_lshlrev_b32 v2, 4, v0
  v_and_b32 v4, 31, v0
  v_lshrrev_b32 v5, 5, v0
  s_and_b32 s47, s40, 1
  s_lshr_b32 s48, s40, 1
  s_lshl_b32 s44, s42, 2
  s_add_u32 s44, s44, s40
  s_mul_i32 s44, s44, 14336
  s_add_u32 s44, s44, 8388608
  s_lshl_b32 s45, s48, 10
  s_add_u32 s46, s44, s45
  s_xor_b32 s45, s45, 1024
  s_add_u32 s45, s44, s45
  v_mul_u32_u24 v3, 2064, v5
  v_add_u32 v3, v3, v4
  v_lshlrev_b32 v3, 4, v3
  s_lshl_b32 s52, s47, 9
  v_add_u32 v6, s52, v3
  s_xor_b32 s52, s52, 512
  v_add_u32 v7, s52, v3
  s_mul_i32 s52, s40, 28896
  s_lshl_b32 s53, s41, 6
  s_add_u32 s52, s52, s53
  s_lshl_b32 s53, s40, 2
  s_lshr_b32 s53, 0x4031, s53
  s_and_b32 s53, s53, 15
  s_add_u32 s52, s52, s53
  s_lshl_b32 s52, s52, 4
  s_add_u32 s52, s52, 6291552
  s_lshl_b32 s49, s41, 6
  s_lshl_b32 s50, s47, 5
  s_add_u32 s49, s49, s50
  v_add_u32 v4, s49, v4
  v_mul_u32_u24 v3, 896, v4
  v_lshl_add_u32 v3, v5, 5, v3
  s_lshl_b32 s50, s42, 7
  s_lshl_b32 s51, s48, 6
  s_add_u32 s50, s50, s51
  v_lshlrev_b32 v4, 3, v4
  s_mov_b32 s53, 8323072
  buffer_load_dwordx4 v[192:195], v3, s[8:11], s50 offen
  buffer_load_dwordx4 v[196:199], v3, s[8:11], s50 offen offset:16
  s_waitcnt vmcnt(2)
  v_cmp_eq_u32 vcc, 0, v51
  s_nop 0
  s_cmp_eq_u32 vcc_lo, 0
  s_nop 0
  s_cbranch_scc1 wsd_108
  v_and_b32 v60, 31, v0
  v_add_u32 v60, 224, v60
  v_lshlrev_b32 v60, 7, v60
  s_mov_b32 s54, 44564480
gp_109:
  buffer_load_dword v61, v60, s[20:23], s54 offen sc1
  s_waitcnt vmcnt(0)
  v_cmp_eq_u32 vcc, 0, v61
  s_nop 0
  s_cmp_eq_u64 vcc, 0
  s_nop 0
  s_cbranch_scc1 gpd_110
  s_sub_u32 s39, s39, 1
  s_nop 0
  s_cbranch_scc0 gp_109
  s_mov_b32 s39, 0
gpd_110:
wsd_108:
  s_mov_b32 s66, 1
lw_111:
  ds_read_b32 v62, v1 offset:64
  s_waitcnt lgkmcnt(0)
  v_readfirstlane_b32 s37, v62
  s_nop 0
  s_cmp_ge_u32 s37, 4
  s_cbranch_scc1 lwd_112
  s_sub_u32 s39, s39, 1
  s_nop 0
  s_cbranch_scc0 lw_111
  s_mov_b32 s39, 0
lwd_112:
  buffer_load_dwordx4 v[200:203], v2, s[20:23], s46 offen offset:0
  buffer_load_dwordx4 v[204:207], v2, s[20:23], s45 offen offset:0
  buffer_load_dwordx4 v[208:211], v2, s[20:23], s46 offen offset:2048
  buffer_load_dwordx4 v[212:215], v2, s[20:23], s45 offen offset:2048
  s_add_u32 s46, s46, 4096
  s_add_u32 s45, s45, 4096
  buffer_load_dwordx4 v[216:219], v2, s[20:23], s46 offen offset:0
  buffer_load_dwordx4 v[220:223], v2, s[20:23], s45 offen offset:0
  buffer_load_dwordx4 v[224:227], v2, s[20:23], s46 offen offset:2048
  buffer_load_dwordx4 v[228:231], v2, s[20:23], s45 offen offset:2048
  s_add_u32 s46, s46, 4096
  s_add_u32 s45, s45, 4096
  buffer_load_dwordx4 v[232:235], v2, s[20:23], s46 offen offset:0
  buffer_load_dwordx4 v[236:239], v2, s[20:23], s45 offen offset:0
  buffer_load_dwordx4 v[240:243], v2, s[20:23], s46 offen offset:2048
  buffer_load_dwordx4 v[244:247], v2, s[20:23], s45 offen offset:2048
  s_add_u32 s46, s46, 4096
  s_add_u32 s45, s45, 4096
  buffer_load_dwordx4 v[248:251], v2, s[20:23], s46 offen offset:0
  buffer_load_dwordx4 v[252:255], v2, s[20:23], s45 offen offset:0
lw_115:
  ds_read_b32 v102, v1 offset:64
  s_waitcnt lgkmcnt(0)
  v_readfirstlane_b32 s37, v102
  s_nop 0
  s_cmp_ge_u32 s37, 4
  s_nop 0
  s_cbranch_scc1 lwd_116
  s_sub_u32 s39, s39, 1
  s_nop 0
  s_cbranch_scc0 lw_115
  s_mov_b32 s39, 0
lwd_116:
  s_cmp_eq_u32 s66, 1
  s_cbranch_scc1 wsd_114
  v_and_b32 v100, 31, v0
  v_add_u32 v100, 224, v100
  v_lshlrev_b32 v100, 7, v100
  s_mov_b32 s54, 44564480
gp_117:
  buffer_load_dword v101, v100, s[20:23], s54 offen sc1
  s_waitcnt vmcnt(0)
  v_cmp_eq_u32 vcc, 0, v101
  s_nop 0
  s_cmp_eq_u64 vcc, 0
  s_cbranch_scc1 gpd_118
  s_sub_u32 s39, s39, 1
  s_nop 0
  s_cbranch_scc0 gp_117
  s_mov_b32 s39, 0
gpd_118:
wsd_114:
  s_mov_b32 s60, s20
  s_mov_b32 s61, s21
  s_mov_b32 s62, s22
  s_mov_b32 s63, s23
  s_lshl_b32 s64, s42, 2
  s_add_u32 s64, s64, s40
  s_mul_i32 s64, s64, 57344
  s_add_u32 s64, s64, 8912896
  buffer_load_dwordx4 v[128:131], v2, s[60:63], s64 offen offset:0
  buffer_load_dwordx4 v[132:135], v2, s[60:63], s64 offen offset:1024
  buffer_load_dwordx4 v[136:139], v2, s[60:63], s64 offen offset:2048
  buffer_load_dwordx4 v[140:143], v2, s[60:63], s64 offen offset:3072
  s_add_u32 s64, s64, 4096
  buffer_load_dwordx4 v[144:147], v2, s[60:63], s64 offen offset:0
  buffer_load_dwordx4 v[148:151], v2, s[60:63], s64 offen offset:1024
  buffer_load_dwordx4 v[152:155], v2, s[60:63], s64 offen offset:2048
  buffer_load_dwordx4 v[156:159], v2, s[60:63], s64 offen offset:3072
  s_add_u32 s64, s64, 4096
  buffer_load_dwordx4 v[160:163], v2, s[60:63], s64 offen offset:0
  buffer_load_dwordx4 v[164:167], v2, s[60:63], s64 offen offset:1024
  buffer_load_dwordx4 v[168:171], v2, s[60:63], s64 offen offset:2048
  buffer_load_dwordx4 v[172:175], v2, s[60:63], s64 offen offset:3072
  s_add_u32 s64, s64, 4096
  buffer_load_dwordx4 v[176:179], v2, s[60:63], s64 offen offset:0
  buffer_load_dwordx4 v[180:183], v2, s[60:63], s64 offen offset:1024
  buffer_load_dwordx4 v[184:187], v2, s[60:63], s64 offen offset:2048
  buffer_load_dwordx4 v[188:191], v2, s[60:63], s64 offen offset:3072
  s_add_u32 s64, s64, 4096
  s_cmp_lg_u32 s40, 0
  s_nop 0
  s_cbranch_scc1 wmw_119
  s_lshl_b32 s54, s41, 6
  s_add_u32 s55, s54, 65
  s_min_u32 s55, s55, 2047
  s_lshr_b32 s55, s55, 7
  s_max_u32 s54, s54, 2
  s_sub_u32 s54, s54, 2
  s_lshr_b32 s54, s54, 7
  s_and_b32 s56, s54, 3
  s_lshl_b32 s56, s56, 3
  s_lshr_b32 s54, s54, 2
  s_lshl_b32 s54, s54, 1
  s_add_u32 s54, s54, s56
  s_and_b32 s56, s55, 3
  s_lshl_b32 s56, s56, 3
  s_lshr_b32 s55, s55, 2
  s_lshl_b32 s55, s55, 1
  s_add_u32 s55, s55, s56
  v_mov_b32 v60, s54
  v_mov_b32 v61, s55
  v_and_b32 v59, 8, v0
  v_cmp_eq_u32 vcc, 0, v59
  s_nop 1
  v_cndmask_b32 v60, v61, v60, vcc
  v_and_b32 v59, 7, v0
  v_min_u32 v59, 6, v59
  v_lshl_add_u32 v60, v59, 5, v60
  v_lshlrev_b32 v60, 7, v60
  s_mov_b32 s54, 44605440
gp_121:
  buffer_load_dword v61, v60, s[20:23], s54 offen sc1
  s_waitcnt vmcnt(0)
  v_cmp_eq_u32 vcc, 0, v61
  s_nop 0
  s_cmp_eq_u64 vcc, 0
  s_cbranch_scc1 gpd_122
  s_sub_u32 s39, s39, 1
  s_nop 0
  s_cbranch_scc0 gp_121
  s_mov_b32 s39, 0
gpd_122:
  v_mov_b32 v62, 1
  s_mov_b64 exec, 1
  ds_add_u32 v1, v62 offset:56
  s_mov_b64 exec, -1
  s_nop 0
  s_branch wmd_120
wmw_119:
lw_123:
  ds_read_b32 v62, v1 offset:56
  s_waitcnt lgkmcnt(0)
  v_readfirstlane_b32 s37, v62
  s_nop 0
  s_cmp_ge_u32 s37, 1
  s_nop 0
  s_cbranch_scc1 lwd_124
  s_sub_u32 s39, s39, 1
  s_nop 0
  s_cbranch_scc0 lw_123
  s_mov_b32 s39, 0
lwd_124:
wmd_120:
lw_125:
  ds_read_b32 v62, v1 offset:64
  s_waitcnt lgkmcnt(0)
  v_readfirstlane_b32 s37, v62
  s_nop 0
  s_cmp_ge_u32 s37, 4
  s_cbranch_scc1 lwd_126
  s_sub_u32 s39, s39, 1
  s_nop 0
  s_cbranch_scc0 lw_125
  s_mov_b32 s39, 0
lwd_126:
  buffer_load_dwordx2 v[120:121], v4, s[20:23], s53 offen
  buffer_load_dwordx4 v[8:11], v6, s[20:23], s52 offen
  buffer_load_dwordx4 v[12:15], v7, s[20:23], s52 offen
  s_add_u32 s52, s52, 66048
  buffer_load_dwordx4 v[16:19], v6, s[20:23], s52 offen
  buffer_load_dwordx4 v[20:23], v7, s[20:23], s52 offen
  s_add_u32 s52, s52, 66048
  buffer_load_dwordx4 v[24:27], v6, s[20:23], s52 offen
  buffer_load_dwordx4 v[28:31], v7, s[20:23], s52 offen
  s_add_u32 s52, s52, 66048
  buffer_load_dwordx4 v[32:35], v6, s[20:23], s52 offen
  buffer_load_dwordx4 v[36:39], v7, s[20:23], s52 offen
  s_add_u32 s52, s52, 66048
  buffer_load_dwordx4 v[40:43], v6, s[20:23], s52 offen
  buffer_load_dwordx4 v[44:47], v7, s[20:23], s52 offen
  s_add_u32 s52, s52, 66048
  buffer_load_dwordx4 v[48:51], v6, s[20:23], s52 offen
  buffer_load_dwordx4 v[52:55], v7, s[20:23], s52 offen
  s_add_u32 s52, s52, 66048
  buffer_load_dwordx4 v[56:59], v6, s[20:23], s52 offen
  buffer_load_dwordx4 v[60:63], v7, s[20:23], s52 offen
  s_setprio 3
  s_waitcnt vmcnt(14)
  v_lshlrev_b32 v64, 16, v192
  v_and_b32 v65, 0xffff0000, v192
  v_lshlrev_b32 v66, 16, v193
  v_and_b32 v67, 0xffff0000, v193
  v_lshlrev_b32 v68, 16, v194
  v_and_b32 v69, 0xffff0000, v194
  v_lshlrev_b32 v70, 16, v195
  v_and_b32 v71, 0xffff0000, v195
  v_lshlrev_b32 v72, 16, v196
  v_and_b32 v73, 0xffff0000, v196
  v_lshlrev_b32 v74, 16, v197
  v_and_b32 v75, 0xffff0000, v197
  v_lshlrev_b32 v76, 16, v198
  v_and_b32 v77, 0xffff0000, v198
  v_lshlrev_b32 v78, 16, v199
  v_and_b32 v79, 0xffff0000, v199
  v_fma_f32 v64, v64, v120, v121
  v_fma_f32 v65, v65, v120, v121
  v_fma_f32 v66, v66, v120, v121
  v_fma_f32 v67, v67, v120, v121
  v_fma_f32 v68, v68, v120, v121
  v_fma_f32 v69, v69, v120, v121
  v_fma_f32 v70, v70, v120, v121
  v_fma_f32 v71, v71, v120, v121
  v_fma_f32 v72, v72, v120, v121
  v_fma_f32 v73, v73, v120, v121
  v_fma_f32 v74, v74, v120, v121
  v_fma_f32 v75, v75, v120, v121
  v_fma_f32 v76, v76, v120, v121
  v_fma_f32 v77, v77, v120, v121
  v_fma_f32 v78, v78, v120, v121
  v_fma_f32 v79, v79, v120, v121
  s_waitcnt vmcnt(12)
  s_nop 0
  v_mfma_f32_32x32x16_bf16 v[64:79], v[200:203], v[8:11], v[64:79]
  v_mfma_f32_32x32x16_bf16 v[80:95], v[200:203], v[12:15], 0
  v_mfma_f32_32x32x16_bf16 v[96:111], v[204:207], v[8:11], 0
  v_mfma_f32_32x32x16_bf16 v[112:127], v[204:207], v[12:15], 0
  s_waitcnt vmcnt(10)
  v_mfma_f32_32x32x16_bf16 v[64:79], v[208:211], v[16:19], v[64:79]
  v_mfma_f32_32x32x16_bf16 v[80:95], v[208:211], v[20:23], v[80:95]
  v_mfma_f32_32x32x16_bf16 v[96:111], v[212:215], v[16:19], v[96:111]
  v_mfma_f32_32x32x16_bf16 v[112:127], v[212:215], v[20:23], v[112:127]
  s_waitcnt vmcnt(8)
  v_mfma_f32_32x32x16_bf16 v[64:79], v[216:219], v[24:27], v[64:79]
  v_mfma_f32_32x32x16_bf16 v[80:95], v[216:219], v[28:31], v[80:95]
  v_mfma_f32_32x32x16_bf16 v[96:111], v[220:223], v[24:27], v[96:111]
  v_mfma_f32_32x32x16_bf16 v[112:127], v[220:223], v[28:31], v[112:127]
  s_waitcnt vmcnt(6)
  v_mfma_f32_32x32x16_bf16 v[64:79], v[224:227], v[32:35], v[64:79]
  v_mfma_f32_32x32x16_bf16 v[80:95], v[224:227], v[36:39], v[80:95]
  v_mfma_f32_32x32x16_bf16 v[96:111], v[228:231], v[32:35], v[96:111]
  v_mfma_f32_32x32x16_bf16 v[112:127], v[228:231], v[36:39], v[112:127]
  s_waitcnt vmcnt(4)
  v_mfma_f32_32x32x16_bf16 v[64:79], v[232:235], v[40:43], v[64:79]
  v_mfma_f32_32x32x16_bf16 v[80:95], v[232:235], v[44:47], v[80:95]
  v_mfma_f32_32x32x16_bf16 v[96:111], v[236:239], v[40:43], v[96:111]
  v_mfma_f32_32x32x16_bf16 v[112:127], v[236:239], v[44:47], v[112:127]
  s_waitcnt vmcnt(2)
  v_mfma_f32_32x32x16_bf16 v[64:79], v[240:243], v[48:51], v[64:79]
  v_mfma_f32_32x32x16_bf16 v[80:95], v[240:243], v[52:55], v[80:95]
  v_mfma_f32_32x32x16_bf16 v[96:111], v[244:247], v[48:51], v[96:111]
  v_mfma_f32_32x32x16_bf16 v[112:127], v[244:247], v[52:55], v[112:127]
  s_waitcnt vmcnt(0)
  v_mfma_f32_32x32x16_bf16 v[64:79], v[248:251], v[56:59], v[64:79]
  v_mfma_f32_32x32x16_bf16 v[80:95], v[248:251], v[60:63], v[80:95]
  v_mfma_f32_32x32x16_bf16 v[96:111], v[252:255], v[56:59], v[96:111]
  v_mfma_f32_32x32x16_bf16 v[112:127], v[252:255], v[60:63], v[112:127]
  s_lshl_b32 s53, s40, 12
  s_add_u32 s53, s53, 0
  v_add_u32 v3, s53, v2
  s_nop 6
  ds_write_b128 v3, v[80:83] offset:0
  ds_write_b128 v3, v[84:87] offset:1024
  ds_write_b128 v3, v[88:91] offset:2048
  ds_write_b128 v3, v[92:95] offset:3072
  ds_write_b128 v3, v[96:99] offset:16384
  ds_write_b128 v3, v[100:103] offset:17408
  ds_write_b128 v3, v[104:107] offset:18432
  ds_write_b128 v3, v[108:111] offset:19456
  ds_write_b128 v3, v[112:115] offset:32768
  ds_write_b128 v3, v[116:119] offset:33792
  ds_write_b128 v3, v[120:123] offset:34816
  ds_write_b128 v3, v[124:127] offset:35840
  v_and_b32 v8, 31, v0
  v_lshrrev_b32 v9, 5, v0
  v_add_u32 v8, s49, v8
  v_lshlrev_b32 v10, 12, v9
  v_add_u32 v10, v10, v8
  v_lshlrev_b32 v10, 4, v10
  s_lshl_b32 s51, s42, 3
  s_lshl_b32 s52, s48, 2
  s_add_u32 s51, s51, s52
  s_lshl_b32 s51, s51, 15
  s_waitcnt lgkmcnt(0)
  s_add_u32 s38, s38, 4
  v_mov_b32 v62, 1
  s_mov_b64 exec, 1
  ds_add_u32 v1, v62 offset:4
  s_mov_b64 exec, -1
lw_127:
  ds_read_b32 v62, v1 offset:4
  s_waitcnt lgkmcnt(0)
  v_readfirstlane_b32 s37, v62
  s_nop 0
  s_cmp_ge_u32 s37, s38
  s_cbranch_scc1 lwd_128
  s_sub_u32 s39, s39, 1
  s_nop 0
  s_cbranch_scc0 lw_127
  s_mov_b32 s39, 0
lwd_128:
  s_xor_b32 s53, s40, 1
  s_lshl_b32 s53, s53, 12
  s_add_u32 s53, s53, 0
  v_add_u32 v3, s53, v2
  ds_read_b128 v[80:83], v3 offset:0
  ds_read_b128 v[84:87], v3 offset:1024
  ds_read_b128 v[88:91], v3 offset:2048
  ds_read_b128 v[92:95], v3 offset:3072
  s_xor_b32 s53, s40, 2
  s_lshl_b32 s53, s53, 12
  s_add_u32 s53, s53, 16384
  v_add_u32 v3, s53, v2
  ds_read_b128 v[96:99], v3 offset:0
  ds_read_b128 v[100:103], v3 offset:1024
  ds_read_b128 v[104:107], v3 offset:2048
  ds_read_b128 v[108:111], v3 offset:3072
  s_xor_b32 s53, s40, 3
  s_lshl_b32 s53, s53, 12
  s_add_u32 s53, s53, 32768
  v_add_u32 v3, s53, v2
  ds_read_b128 v[112:115], v3 offset:0
  ds_read_b128 v[116:119], v3 offset:1024
  ds_read_b128 v[120:123], v3 offset:2048
  ds_read_b128 v[124:127], v3 offset:3072
  s_waitcnt lgkmcnt(8)
  v_add_f32 v64, v64, v80
  v_add_f32 v65, v65, v81
  v_add_f32 v66, v66, v82
  v_add_f32 v67, v67, v83
  v_add_f32 v68, v68, v84
  v_add_f32 v69, v69, v85
  v_add_f32 v70, v70, v86
  v_add_f32 v71, v71, v87
  v_add_f32 v72, v72, v88
  v_add_f32 v73, v73, v89
  v_add_f32 v74, v74, v90
  v_add_f32 v75, v75, v91
  v_add_f32 v76, v76, v92
  v_add_f32 v77, v77, v93
  v_add_f32 v78, v78, v94
  v_add_f32 v79, v79, v95
  s_waitcnt lgkmcnt(4)
  v_add_f32 v64, v64, v96
  v_add_f32 v65, v65, v97
  v_add_f32 v66, v66, v98
  v_add_f32 v67, v67, v99
  v_add_f32 v68, v68, v100
  v_add_f32 v69, v69, v101
  v_add_f32 v70, v70, v102
  v_add_f32 v71, v71, v103
  v_add_f32 v72, v72, v104
  v_add_f32 v73, v73, v105
  v_add_f32 v74, v74, v106
  v_add_f32 v75, v75, v107
  v_add_f32 v76, v76, v108
  v_add_f32 v77, v77, v109
  v_add_f32 v78, v78, v110
  v_add_f32 v79, v79, v111
  s_waitcnt lgkmcnt(0)
  v_add_f32 v64, v64, v112
  v_add_f32 v65, v65, v113
  v_add_f32 v66, v66, v114
  v_add_f32 v67, v67, v115
  v_add_f32 v68, v68, v116
  v_add_f32 v69, v69, v117
  v_add_f32 v70, v70, v118
  v_add_f32 v71, v71, v119
  v_add_f32 v72, v72, v120
  v_add_f32 v73, v73, v121
  v_add_f32 v74, v74, v122
  v_add_f32 v75, v75, v123
  v_add_f32 v76, v76, v124
  v_add_f32 v77, v77, v125
  v_add_f32 v78, v78, v126
  v_add_f32 v79, v79, v127
  v_cvt_pk_bf16_f32 v88, v64, v65
  v_cvt_pk_bf16_f32 v89, v66, v67
  v_cvt_pk_bf16_f32 v90, v68, v69
  v_cvt_pk_bf16_f32 v91, v70, v71
  v_cvt_pk_bf16_f32 v92, v72, v73
  v_cvt_pk_bf16_f32 v93, v74, v75
  v_cvt_pk_bf16_f32 v94, v76, v77
  v_cvt_pk_bf16_f32 v95, v78, v79
  s_add_u32 s53, s51, 13336576
  buffer_store_dwordx4 v[88:91], v10, s[20:23], s53 offen sc1
  s_add_u32 s53, s53, 32768
  buffer_store_dwordx4 v[92:95], v10, s[20:23], s53 offen sc1
  v_add_f32 v80, v64, v65
  v_mul_f32 v81, v64, v64
  v_fma_f32 v81, v65, v65, v81
  v_add_f32 v82, v66, v67
  v_mul_f32 v83, v66, v66
  v_fma_f32 v83, v67, v67, v83
  v_add_f32 v80, v80, v68
  v_fma_f32 v81, v68, v68, v81
  v_add_f32 v82, v82, v69
  v_fma_f32 v83, v69, v69, v83
  v_add_f32 v80, v80, v70
  v_fma_f32 v81, v70, v70, v81
  v_add_f32 v82, v82, v71
  v_fma_f32 v83, v71, v71, v83
  v_add_f32 v80, v80, v72
  v_fma_f32 v81, v72, v72, v81
  v_add_f32 v82, v82, v73
  v_fma_f32 v83, v73, v73, v83
  v_add_f32 v80, v80, v74
  v_fma_f32 v81, v74, v74, v81
  v_add_f32 v82, v82, v75
  v_fma_f32 v83, v75, v75, v83
  v_add_f32 v80, v80, v76
  v_fma_f32 v81, v76, v76, v81
  v_add_f32 v82, v82, v77
  v_fma_f32 v83, v77, v77, v83
  v_add_f32 v80, v80, v78
  v_fma_f32 v81, v78, v78, v81
  v_add_f32 v82, v82, v79
  v_fma_f32 v83, v79, v79, v83
  v_add_f32 v80, v80, v82
  v_add_f32 v81, v81, v83
  v_mov_b32 v82, v80
  v_mov_b32 v83, v81
  s_nop 0
  v_permlane32_swap_b32 v80, v82
  v_permlane32_swap_b32 v81, v83
  v_add_f32 v80, v80, v82
  v_add_f32 v81, v81, v83
  s_lshl_b32 s53, s42, 1
  s_add_u32 s53, s53, s48
  s_lshl_b32 s53, s53, 14
  s_add_u32 s53, s53, 13107200
  v_lshlrev_b32 v8, 3, v8
  buffer_store_dwordx2 v[80:81], v8, s[20:23], s53 offen sc1
  v_lshlrev_b32 v84, 16, v192
  v_and_b32 v85, 0xffff0000, v192
  v_add_f32 v64, v64, v84
  v_add_f32 v65, v65, v85
  v_lshlrev_b32 v84, 16, v193
  v_and_b32 v85, 0xffff0000, v193
  v_add_f32 v66, v66, v84
  v_add_f32 v67, v67, v85
  v_lshlrev_b32 v84, 16, v194
  v_and_b32 v85, 0xffff0000, v194
  v_add_f32 v68, v68, v84
  v_add_f32 v69, v69, v85
  v_lshlrev_b32 v84, 16, v195
  v_and_b32 v85, 0xffff0000, v195
  v_add_f32 v70, v70, v84
  v_add_f32 v71, v71, v85
  v_lshlrev_b32 v84, 16, v196
  v_and_b32 v85, 0xffff0000, v196
  v_add_f32 v72, v72, v84
  v_add_f32 v73, v73, v85
  v_lshlrev_b32 v84, 16, v197
  v_and_b32 v85, 0xffff0000, v197
  v_add_f32 v74, v74, v84
  v_add_f32 v75, v75, v85
  v_lshlrev_b32 v84, 16, v198
  v_and_b32 v85, 0xffff0000, v198
  v_add_f32 v76, v76, v84
  v_add_f32 v77, v77, v85
  v_lshlrev_b32 v84, 16, v199
  v_and_b32 v85, 0xffff0000, v199
  v_add_f32 v78, v78, v84
  v_add_f32 v79, v79, v85
  s_lshl_b32 s53, s40, 12
  s_add_u32 s53, s53, 139584
  v_add_u32 v3, s53, v2
  ds_write_b128 v3, v[64:67] offset:0
  ds_write_b128 v3, v[68:71] offset:1024
  ds_write_b128 v3, v[72:75] offset:2048
  ds_write_b128 v3, v[76:79] offset:3072
  s_lshl_b32 s43, s41, 5
  s_lshl_b32 s44, s42, 2
  s_add_u32 s44, s44, s40
  s_add_u32 s43, s43, s44
  s_mul_i32 s43, s43, 128
  s_add_u32 s36, s43, 44040192
  v_and_b32 v4, 31, v0
  v_lshrrev_b32 v5, 5, v0
  v_lshlrev_b32 v6, 11, v5
  v_add_u32 v6, v6, v4
  v_lshlrev_b32 v6, 4, v6
  v_lshlrev_b32 v7, 3, v0
  s_mul_i32 s46, s40, 28672
  s_lshl_b32 s44, s41, 6
  s_add_u32 s46, s46, s44
  s_lshl_b32 s46, s46, 4
  s_add_u32 s46, s46, 13336576
  s_lshl_b32 s47, s41, 9
  s_add_u32 s47, s47, 13107200
  s_mul_i32 s48, s40, 14336
  s_add_u32 s48, s48, 0
  s_waitcnt vmcnt(0)
  v_mov_b32 v60, 0
  v_mov_b32 v61, 1
  s_mov_b64 exec, 1
  buffer_store_dword v61, v60, s[20:23], s36 offen sc1
  s_mov_b64 exec, -1
  s_setprio 0
  buffer_load_dwordx4 v[192:195], v2, s[60:63], s64 offen offset:0
  buffer_load_dwordx4 v[196:199], v2, s[60:63], s64 offen offset:1024
  buffer_load_dwordx4 v[200:203], v2, s[60:63], s64 offen offset:2048
  buffer_load_dwordx4 v[204:207], v2, s[60:63], s64 offen offset:3072
  s_add_u32 s64, s64, 4096
  buffer_load_dwordx4 v[208:211], v2, s[60:63], s64 offen offset:0
  buffer_load_dwordx4 v[212:215], v2, s[60:63], s64 offen offset:1024
  buffer_load_dwordx4 v[216:219], v2, s[60:63], s64 offen offset:2048
  buffer_load_dwordx4 v[220:223], v2, s[60:63], s64 offen offset:3072
  s_add_u32 s64, s64, 4096
  buffer_load_dwordx4 v[224:227], v2, s[60:63], s64 offen offset:0
  buffer_load_dwordx4 v[228:231], v2, s[60:63], s64 offen offset:1024
  buffer_load_dwordx4 v[232:235], v2, s[60:63], s64 offen offset:2048
  buffer_load_dwordx4 v[236:239], v2, s[60:63], s64 offen offset:3072
  s_add_u32 s64, s64, 4096
  buffer_load_dwordx4 v[240:243], v2, s[60:63], s64 offen offset:0
  buffer_load_dwordx4 v[244:247], v2, s[60:63], s64 offen offset:1024
  buffer_load_dwordx4 v[248:251], v2, s[60:63], s64 offen offset:2048
  buffer_load_dwordx4 v[252:255], v2, s[60:63], s64 offen offset:3072
  s_add_u32 s64, s64, 4096
  s_cmp_lg_u32 s40, 0
  s_nop 0
  s_cbranch_scc1 x1w_130
  v_min_u32 v60, 27, v0
  v_mul_u32_u24 v60, 128, v60
  s_mul_i32 s43, s41, 4096
  s_add_u32 s43, s43, 44040192
  s_sub_u32 s54, 44593152, s43
  v_lshlrev_b32 v61, 7, v0
  v_add_u32 v61, s54, v61
  v_cmp_gt_u32 vcc, 32, v0
  s_nop 1
  v_cndmask_b32 v60, v61, v60, vcc
gp_132:
  buffer_load_dword v61, v60, s[20:23], s43 offen sc1
  s_waitcnt vmcnt(0)
  v_cmp_eq_u32 vcc, 0, v61
  s_nop 0
  s_cmp_eq_u64 vcc, 0
  s_cbranch_scc1 gpd_133
  s_sub_u32 s39, s39, 1
  s_nop 0
  s_cbranch_scc0 gp_132
  s_mov_b32 s39, 0
gpd_133:
  v_mov_b32 v62, 1
  s_mov_b64 exec, 1
  ds_add_u32 v1, v62 offset:8
  s_mov_b64 exec, -1
  s_branch x1d_131
x1w_130:
lw_134:
  ds_read_b32 v62, v1 offset:8
  s_waitcnt lgkmcnt(0)
  v_readfirstlane_b32 s37, v62
  s_nop 0
  s_cmp_ge_u32 s37, 1
  s_cbranch_scc1 lwd_135
  s_sub_u32 s39, s39, 1
  s_nop 0
  s_cbranch_scc0 lw_134
  s_mov_b32 s39, 0
lwd_135:
x1d_131:
  buffer_load_dwordx2 v[32:33], v7, s[20:23], s47 offen
  s_add_u32 s47, s47, 16384
  buffer_load_dwordx2 v[34:35], v7, s[20:23], s47 offen
  s_add_u32 s47, s47, 16384
  buffer_load_dwordx2 v[36:37], v7, s[20:23], s47 offen
  s_add_u32 s47, s47, 16384
  buffer_load_dwordx2 v[38:39], v7, s[20:23], s47 offen
  s_add_u32 s47, s47, 16384
  buffer_load_dwordx2 v[40:41], v7, s[20:23], s47 offen
  s_add_u32 s47, s47, 16384
  buffer_load_dwordx2 v[42:43], v7, s[20:23], s47 offen
  s_add_u32 s47, s47, 16384
  buffer_load_dwordx2 v[44:45], v7, s[20:23], s47 offen
  s_add_u32 s47, s47, 16384
  buffer_load_dwordx2 v[46:47], v7, s[20:23], s47 offen
  s_add_u32 s47, s47, 16384
  buffer_load_dwordx2 v[48:49], v7, s[20:23], s47 offen
  s_add_u32 s47, s47, 16384
  buffer_load_dwordx2 v[50:51], v7, s[20:23], s47 offen
  s_add_u32 s47, s47, 16384
  buffer_load_dwordx2 v[52:53], v7, s[20:23], s47 offen
  s_add_u32 s47, s47, 16384
  buffer_load_dwordx2 v[54:55], v7, s[20:23], s47 offen
  s_add_u32 s47, s47, 16384
  buffer_load_dwordx2 v[56:57], v7, s[20:23], s47 offen
  s_add_u32 s47, s47, 16384
  buffer_load_dwordx2 v[58:59], v7, s[20:23], s47 offen
  s_mov_b32 m0, s48
  s_nop 0
  buffer_load_dwordx4 v6, s[20:23], s46 offen  lds
  s_add_u32 m0, m0, 1024
  s_add_u32 s45, s46, 512
  buffer_load_dwordx4 v6, s[20:23], s45 offen  lds
  s_add_u32 m0, m0, 1024
  s_add_u32 s46, s46, 65536
  buffer_load_dwordx4 v6, s[20:23], s46 offen  lds
  s_add_u32 m0, m0, 1024
  s_add_u32 s45, s46, 512
  buffer_load_dwordx4 v6, s[20:23], s45 offen  lds
  s_add_u32 m0, m0, 1024
  s_add_u32 s46, s46, 65536
  buffer_load_dwordx4 v6, s[20:23], s46 offen  lds
  s_add_u32 m0, m0, 1024
  s_add_u32 s45, s46, 512
  buffer_load_dwordx4 v6, s[20:23], s45 offen  lds
  s_add_u32 m0, m0, 1024
  s_add_u32 s46, s46, 65536
  buffer_load_dwordx4 v6, s[20:23], s46 offen  lds
  s_add_u32 m0, m0, 1024
  s_add_u32 s45, s46, 512
  buffer_load_dwordx4 v6, s[20:23], s45 offen  lds
  s_add_u32 m0, m0, 1024
  s_add_u32 s46, s46, 65536
  buffer_load_dwordx4 v6, s[20:23], s46 offen  lds
  s_add_u32 m0, m0, 1024
  s_add_u32 s45, s46, 512
  buffer_load_dwordx4 v6, s[20:23], s45 offen  lds
  s_add_u32 m0, m0, 1024
  s_add_u32 s46, s46, 65536
  buffer_load_dwordx4 v6, s[20:23], s46 offen  lds
  s_add_u32 m0, m0, 1024
  s_add_u32 s45, s46, 512
  buffer_load_dwordx4 v6, s[20:23], s45 offen  lds
  s_add_u32 m0, m0, 1024
  s_add_u32 s46, s46, 65536
  buffer_load_dwordx4 v6, s[20:23], s46 offen  lds
  s_add_u32 m0, m0, 1024
  s_add_u32 s45, s46, 512
  buffer_load_dwordx4 v6, s[20:23], s45 offen  lds
  s_setprio 3
  s_waitcnt vmcnt(14)
x1join_129:
  v_add_f32 v32, v32, v34
  v_add_f32 v33, v33, v35
  v_add_f32 v32, v32, v36
  v_add_f32 v33, v33, v37
  v_add_f32 v32, v32, v38
  v_add_f32 v33, v33, v39
  v_add_f32 v32, v32, v40
  v_add_f32 v33, v33, v41
  v_add_f32 v32, v32, v42
  v_add_f32 v33, v33, v43
  v_add_f32 v32, v32, v44
  v_add_f32 v33, v33, v45
  v_add_f32 v32, v32, v46
  v_add_f32 v33, v33, v47
  v_add_f32 v32, v32, v48
  v_add_f32 v33, v33, v49
  v_add_f32 v32, v32, v50
  v_add_f32 v33, v33, v51
  v_add_f32 v32, v32, v52
  v_add_f32 v33, v33, v53
  v_add_f32 v32, v32, v54
  v_add_f32 v33, v33, v55
  v_add_f32 v32, v32, v56
  v_add_f32 v33, v33, v57
  v_add_f32 v32, v32, v58
  v_add_f32 v33, v33, v59
  v_mul_f32 v32, 0x3b124925, v32
  v_mul_f32 v33, 0x3b124925, v33
  v_fma_f32 v33, -v32, v32, v33
  v_max_f32 v33, 0, v33
  v_add_f32 v33, 0x3727c5ac, v33
  v_rsq_f32 v32, v33
  s_nop 0
  v_mul_f32 v33, v33, v32
  v_mov_b32 v34, v32
  v_mov_b32 v35, v33
  s_nop 0
  v_permlane32_swap_b32 v32, v34
  v_permlane32_swap_b32 v33, v35
  v_mul_f32 v48, 0xc0135761, v32
  v_mul_f32 v49, v32, v32
  v_mul_f32 v49, v49, v32
  v_mul_f32 v49, 0xbdd2d3e8, v49
  v_mov_b32 v50, v33
  v_mul_f32 v51, 0xc0135761, v34
  v_mul_f32 v52, v34, v34
  v_mul_f32 v52, v52, v34
  v_mul_f32 v52, 0xbdd2d3e8, v52
  v_mov_b32 v53, v35
  v_lshlrev_b32 v3, 4, v0
  s_waitcnt vmcnt(0) lgkmcnt(0)
  s_add_u32 s38, s38, 4
  v_mov_b32 v62, 1
  s_mov_b64 exec, 1
  ds_add_u32 v1, v62 offset:4
  s_mov_b64 exec, -1
lw_136:
  ds_read_b32 v62, v1 offset:4
  s_waitcnt lgkmcnt(0)
  v_readfirstlane_b32 s37, v62
  s_nop 0
  s_cmp_ge_u32 s37, s38
  s_cbranch_scc1 lwd_137
  s_sub_u32 s39, s39, 1
  s_nop 0
  s_cbranch_scc0 lw_136
  s_mov_b32 s39, 0
lwd_137:
  s_add_u32 s34, s42, s40
  s_add_u32 s34, s34, 1
  s_cmp_ge_u32 s34, 7
  s_cselect_b32 s35, 7, 0
  s_sub_u32 s34, s34, s35
  s_lshr_b32 s57, s40, 1
  s_add_u32 s57, s57, s42
  s_add_u32 s57, s57, 5
  s_cmp_ge_u32 s57, 7
  s_cselect_b32 s35, 7, 0
  s_sub_u32 s57, s57, s35
  s_setprio 0
  ds_read_b128 v[8:11], v3 offset:0
  ds_read_b128 v[12:15], v3 offset:1024
  s_waitcnt vmcnt(30) lgkmcnt(0)
  v_mfma_f32_32x32x16_bf16 v[64:79], v[128:131], v[8:11], 0
  ds_read_b128 v[16:19], v3 offset:2048
  v_mfma_f32_32x32x16_bf16 v[80:95], v[128:131], v[12:15], 0
  ds_read_b128 v[20:23], v3 offset:3072
  v_mfma_f32_32x32x16_bf16 v[96:111], v[132:135], v[8:11], 0
  v_mfma_f32_32x32x16_bf16 v[112:127], v[132:135], v[12:15], 0
  buffer_load_dwordx4 v[128:131], v2, s[60:63], s64 offen offset:0
  buffer_load_dwordx4 v[132:135], v2, s[60:63], s64 offen offset:1024
  s_waitcnt vmcnt(30) lgkmcnt(0)
  v_mfma_f32_32x32x16_bf16 v[64:79], v[136:139], v[16:19], v[64:79]
  ds_read_b128 v[8:11], v3 offset:4096
  v_mfma_f32_32x32x16_bf16 v[80:95], v[136:139], v[20:23], v[80:95]
  ds_read_b128 v[12:15], v3 offset:5120
  v_mfma_f32_32x32x16_bf16 v[96:111], v[140:143], v[16:19], v[96:111]
  v_mfma_f32_32x32x16_bf16 v[112:127], v[140:143], v[20:23], v[112:127]
  buffer_load_dwordx4 v[136:139], v2, s[60:63], s64 offen offset:2048
  buffer_load_dwordx4 v[140:143], v2, s[60:63], s64 offen offset:3072
  s_add_u32 s64, s64, 4096
  s_waitcnt vmcnt(30) lgkmcnt(0)
  v_mfma_f32_32x32x16_bf16 v[64:79], v[144:147], v[8:11], v[64:79]
  ds_read_b128 v[16:19], v3 offset:6144
  v_mfma_f32_32x32x16_bf16 v[80:95], v[144:147], v[12:15], v[80:95]
  ds_read_b128 v[20:23], v3 offset:7168
  v_mfma_f32_32x32x16_bf16 v[96:111], v[148:151], v[8:11], v[96:111]
  v_mfma_f32_32x32x16_bf16 v[112:127], v[148:151], v[12:15], v[112:127]
  buffer_load_dwordx4 v[144:147], v2, s[60:63], s64 offen offset:0
  buffer_load_dwordx4 v[148:151], v2, s[60:63], s64 offen offset:1024
  s_waitcnt vmcnt(30) lgkmcnt(0)
  v_mfma_f32_32x32x16_bf16 v[64:79], v[152:155], v[16:19], v[64:79]
  ds_read_b128 v[8:11], v3 offset:8192
  v_mfma_f32_32x32x16_bf16 v[80:95], v[152:155], v[20:23], v[80:95]
  ds_read_b128 v[12:15], v3 offset:9216
  v_mfma_f32_32x32x16_bf16 v[96:111], v[156:159], v[16:19], v[96:111]
  v_mfma_f32_32x32x16_bf16 v[112:127], v[156:159], v[20:23], v[112:127]
  buffer_load_dwordx4 v[152:155], v2, s[60:63], s64 offen offset:2048
  buffer_load_dwordx4 v[156:159], v2, s[60:63], s64 offen offset:3072
  s_add_u32 s64, s64, 4096
  s_waitcnt vmcnt(30) lgkmcnt(0)
  v_mfma_f32_32x32x16_bf16 v[64:79], v[160:163], v[8:11], v[64:79]
  ds_read_b128 v[16:19], v3 offset:10240
  v_mfma_f32_32x32x16_bf16 v[80:95], v[160:163], v[12:15], v[80:95]
  ds_read_b128 v[20:23], v3 offset:11264
  v_mfma_f32_32x32x16_bf16 v[96:111], v[164:167], v[8:11], v[96:111]
  v_mfma_f32_32x32x16_bf16 v[112:127], v[164:167], v[12:15], v[112:127]
  buffer_load_dwordx4 v[160:163], v2, s[60:63], s64 offen offset:0
  buffer_load_dwordx4 v[164:167], v2, s[60:63], s64 offen offset:1024
  s_waitcnt vmcnt(30) lgkmcnt(0)
  v_mfma_f32_32x32x16_bf16 v[64:79], v[168:171], v[16:19], v[64:79]
  ds_read_b128 v[8:11], v3 offset:12288
  v_mfma_f32_32x32x16_bf16 v[80:95], v[168:171], v[20:23], v[80:95]
  ds_read_b128 v[12:15], v3 offset:13312
  v_mfma_f32_32x32x16_bf16 v[96:111], v[172:175], v[16:19], v[96:111]
  v_mfma_f32_32x32x16_bf16 v[112:127], v[172:175], v[20:23], v[112:127]
  buffer_load_dwordx4 v[168:171], v2, s[60:63], s64 offen offset:2048
  buffer_load_dwordx4 v[172:175], v2, s[60:63], s64 offen offset:3072
  s_add_u32 s64, s64, 4096
  s_waitcnt vmcnt(30) lgkmcnt(0)
  v_mfma_f32_32x32x16_bf16 v[64:79], v[176:179], v[8:11], v[64:79]
  ds_read_b128 v[16:19], v3 offset:14336
  v_mfma_f32_32x32x16_bf16 v[80:95], v[176:179], v[12:15], v[80:95]
  ds_read_b128 v[20:23], v3 offset:15360
  v_mfma_f32_32x32x16_bf16 v[96:111], v[180:183], v[8:11], v[96:111]
  v_mfma_f32_32x32x16_bf16 v[112:127], v[180:183], v[12:15], v[112:127]
  buffer_load_dwordx4 v[176:179], v2, s[60:63], s64 offen offset:0
  buffer_load_dwordx4 v[180:183], v2, s[60:63], s64 offen offset:1024
  s_waitcnt vmcnt(30) lgkmcnt(0)
  v_mfma_f32_32x32x16_bf16 v[64:79], v[184:187], v[16:19], v[64:79]
  ds_read_b128 v[8:11], v3 offset:16384
  v_mfma_f32_32x32x16_bf16 v[80:95], v[184:187], v[20:23], v[80:95]
  ds_read_b128 v[12:15], v3 offset:17408
  v_mfma_f32_32x32x16_bf16 v[96:111], v[188:191], v[16:19], v[96:111]
  v_mfma_f32_32x32x16_bf16 v[112:127], v[188:191], v[20:23], v[112:127]
  buffer_load_dwordx4 v[184:187], v2, s[60:63], s64 offen offset:2048
  buffer_load_dwordx4 v[188:191], v2, s[60:63], s64 offen offset:3072
  s_add_u32 s64, s64, 4096
  s_waitcnt vmcnt(30) lgkmcnt(0)
  v_mfma_f32_32x32x16_bf16 v[64:79], v[192:195], v[8:11], v[64:79]
  ds_read_b128 v[16:19], v3 offset:18432
  v_mfma_f32_32x32x16_bf16 v[80:95], v[192:195], v[12:15], v[80:95]
  ds_read_b128 v[20:23], v3 offset:19456
  v_mfma_f32_32x32x16_bf16 v[96:111], v[196:199], v[8:11], v[96:111]
  v_mfma_f32_32x32x16_bf16 v[112:127], v[196:199], v[12:15], v[112:127]
  buffer_load_dwordx4 v[192:195], v2, s[60:63], s64 offen offset:0
  buffer_load_dwordx4 v[196:199], v2, s[60:63], s64 offen offset:1024
  s_waitcnt vmcnt(30) lgkmcnt(0)
  v_mfma_f32_32x32x16_bf16 v[64:79], v[200:203], v[16:19], v[64:79]
  ds_read_b128 v[8:11], v3 offset:20480
  v_mfma_f32_32x32x16_bf16 v[80:95], v[200:203], v[20:23], v[80:95]
  ds_read_b128 v[12:15], v3 offset:21504
  v_mfma_f32_32x32x16_bf16 v[96:111], v[204:207], v[16:19], v[96:111]
  v_mfma_f32_32x32x16_bf16 v[112:127], v[204:207], v[20:23], v[112:127]
  buffer_load_dwordx4 v[200:203], v2, s[60:63], s64 offen offset:2048
  buffer_load_dwordx4 v[204:207], v2, s[60:63], s64 offen offset:3072
  s_add_u32 s64, s64, 4096
  s_waitcnt vmcnt(30) lgkmcnt(0)
  v_mfma_f32_32x32x16_bf16 v[64:79], v[208:211], v[8:11], v[64:79]
  ds_read_b128 v[16:19], v3 offset:22528
  v_mfma_f32_32x32x16_bf16 v[80:95], v[208:211], v[12:15], v[80:95]
  ds_read_b128 v[20:23], v3 offset:23552
  v_mfma_f32_32x32x16_bf16 v[96:111], v[212:215], v[8:11], v[96:111]
  v_mfma_f32_32x32x16_bf16 v[112:127], v[212:215], v[12:15], v[112:127]
  buffer_load_dwordx4 v[208:211], v2, s[60:63], s64 offen offset:0
  buffer_load_dwordx4 v[212:215], v2, s[60:63], s64 offen offset:1024
  s_waitcnt vmcnt(30) lgkmcnt(0)
  v_mfma_f32_32x32x16_bf16 v[64:79], v[216:219], v[16:19], v[64:79]
  ds_read_b128 v[8:11], v3 offset:24576
  v_mfma_f32_32x32x16_bf16 v[80:95], v[216:219], v[20:23], v[80:95]
  ds_read_b128 v[12:15], v3 offset:25600
  v_mfma_f32_32x32x16_bf16 v[96:111], v[220:223], v[16:19], v[96:111]
  v_mfma_f32_32x32x16_bf16 v[112:127], v[220:223], v[20:23], v[112:127]
  buffer_load_dwordx4 v[216:219], v2, s[60:63], s64 offen offset:2048
  buffer_load_dwordx4 v[220:223], v2, s[60:63], s64 offen offset:3072
  s_add_u32 s64, s64, 4096
  s_waitcnt vmcnt(30) lgkmcnt(0)
  v_mfma_f32_32x32x16_bf16 v[64:79], v[224:227], v[8:11], v[64:79]
  ds_read_b128 v[16:19], v3 offset:26624
  v_mfma_f32_32x32x16_bf16 v[80:95], v[224:227], v[12:15], v[80:95]
  ds_read_b128 v[20:23], v3 offset:27648
  v_mfma_f32_32x32x16_bf16 v[96:111], v[228:231], v[8:11], v[96:111]
  v_mfma_f32_32x32x16_bf16 v[112:127], v[228:231], v[12:15], v[112:127]
  s_cmp_ge_u32 s34, 7
  s_cbranch_scc1 w4null_138
  s_mul_i32 s64, s42, 7
  s_add_u32 s64, s64, s34
  s_lshl_b32 s64, s64, 15
  s_add_u32 s64, s64, 10747904
  s_branch w4set_139
w4null_138:
  s_mov_b32 s62, 0
  s_mov_b32 s64, 0
w4set_139:
  buffer_load_dwordx4 v[224:227], v2, s[60:63], s64 offen offset:0
  buffer_load_dwordx4 v[228:231], v2, s[60:63], s64 offen offset:1024
  s_waitcnt vmcnt(30) lgkmcnt(0)
  v_mfma_f32_32x32x16_bf16 v[64:79], v[232:235], v[16:19], v[64:79]
  ds_read_b128 v[8:11], v3 offset:28672
  v_mfma_f32_32x32x16_bf16 v[80:95], v[232:235], v[20:23], v[80:95]
  ds_read_b128 v[12:15], v3 offset:29696
  v_mfma_f32_32x32x16_bf16 v[96:111], v[236:239], v[16:19], v[96:111]
  v_mfma_f32_32x32x16_bf16 v[112:127], v[236:239], v[20:23], v[112:127]
  buffer_load_dwordx4 v[232:235], v2, s[60:63], s64 offen offset:2048
  buffer_load_dwordx4 v[236:239], v2, s[60:63], s64 offen offset:3072
  s_add_u32 s64, s64, 4096
  s_waitcnt vmcnt(30) lgkmcnt(0)
  v_mfma_f32_32x32x16_bf16 v[64:79], v[240:243], v[8:11], v[64:79]
  ds_read_b128 v[16:19], v3 offset:30720
  v_mfma_f32_32x32x16_bf16 v[80:95], v[240:243], v[12:15], v[80:95]
  ds_read_b128 v[20:23], v3 offset:31744
  v_mfma_f32_32x32x16_bf16 v[96:111], v[244:247], v[8:11], v[96:111]
  v_mfma_f32_32x32x16_bf16 v[112:127], v[244:247], v[12:15], v[112:127]
  buffer_load_dwordx4 v[240:243], v2, s[60:63], s64 offen offset:0
  buffer_load_dwordx4 v[244:247], v2, s[60:63], s64 offen offset:1024
  s_waitcnt vmcnt(30) lgkmcnt(0)
  v_mfma_f32_32x32x16_bf16 v[64:79], v[248:251], v[16:19], v[64:79]
  ds_read_b128 v[8:11], v3 offset:32768
  v_mfma_f32_32x32x16_bf16 v[80:95], v[248:251], v[20:23], v[80:95]
  ds_read_b128 v[12:15], v3 offset:33792
  v_mfma_f32_32x32x16_bf16 v[96:111], v[252:255], v[16:19], v[96:111]
  v_mfma_f32_32x32x16_bf16 v[112:127], v[252:255], v[20:23], v[112:127]
  buffer_load_dwordx4 v[248:251], v2, s[60:63], s64 offen offset:2048
  buffer_load_dwordx4 v[252:255], v2, s[60:63], s64 offen offset:3072
  s_add_u32 s64, s64, 4096
  s_waitcnt vmcnt(30) lgkmcnt(0)
  v_mfma_f32_32x32x16_bf16 v[64:79], v[128:131], v[8:11], v[64:79]
  ds_read_b128 v[16:19], v3 offset:34816
  v_mfma_f32_32x32x16_bf16 v[80:95], v[128:131], v[12:15], v[80:95]
  ds_read_b128 v[20:23], v3 offset:35840
  v_mfma_f32_32x32x16_bf16 v[96:111], v[132:135], v[8:11], v[96:111]
  v_mfma_f32_32x32x16_bf16 v[112:127], v[132:135], v[12:15], v[112:127]
  buffer_load_dwordx4 v[128:131], v2, s[60:63], s64 offen offset:0
  buffer_load_dwordx4 v[132:135], v2, s[60:63], s64 offen offset:1024
  s_waitcnt vmcnt(30) lgkmcnt(0)
  v_mfma_f32_32x32x16_bf16 v[64:79], v[136:139], v[16:19], v[64:79]
  ds_read_b128 v[8:11], v3 offset:36864
  v_mfma_f32_32x32x16_bf16 v[80:95], v[136:139], v[20:23], v[80:95]
  ds_read_b128 v[12:15], v3 offset:37888
  v_mfma_f32_32x32x16_bf16 v[96:111], v[140:143], v[16:19], v[96:111]
  v_mfma_f32_32x32x16_bf16 v[112:127], v[140:143], v[20:23], v[112:127]
  buffer_load_dwordx4 v[136:139], v2, s[60:63], s64 offen offset:2048
  buffer_load_dwordx4 v[140:143], v2, s[60:63], s64 offen offset:3072
  s_add_u32 s64, s64, 4096
  s_waitcnt vmcnt(30) lgkmcnt(0)
  v_mfma_f32_32x32x16_bf16 v[64:79], v[144:147], v[8:11], v[64:79]
  ds_read_b128 v[16:19], v3 offset:38912
  v_mfma_f32_32x32x16_bf16 v[80:95], v[144:147], v[12:15], v[80:95]
  ds_read_b128 v[20:23], v3 offset:39936
  v_mfma_f32_32x32x16_bf16 v[96:111], v[148:151], v[8:11], v[96:111]
  v_mfma_f32_32x32x16_bf16 v[112:127], v[148:151], v[12:15], v[112:127]
  buffer_load_dwordx4 v[144:147], v2, s[60:63], s64 offen offset:0
  buffer_load_dwordx4 v[148:151], v2, s[60:63], s64 offen offset:1024
  s_waitcnt vmcnt(30) lgkmcnt(0)
  v_mfma_f32_32x32x16_bf16 v[64:79], v[152:155], v[16:19], v[64:79]
  ds_read_b128 v[8:11], v3 offset:40960
  v_mfma_f32_32x32x16_bf16 v[80:95], v[152:155], v[20:23], v[80:95]
  ds_read_b128 v[12:15], v3 offset:41984
  v_mfma_f32_32x32x16_bf16 v[96:111], v[156:159], v[16:19], v[96:111]
  v_mfma_f32_32x32x16_bf16 v[112:127], v[156:159], v[20:23], v[112:127]
  buffer_load_dwordx4 v[152:155], v2, s[60:63], s64 offen offset:2048
  buffer_load_dwordx4 v[156:159], v2, s[60:63], s64 offen offset:3072
  s_add_u32 s64, s64, 4096
  s_waitcnt vmcnt(30) lgkmcnt(0)
  v_mfma_f32_32x32x16_bf16 v[64:79], v[160:163], v[8:11], v[64:79]
  ds_read_b128 v[16:19], v3 offset:43008
  v_mfma_f32_32x32x16_bf16 v[80:95], v[160:163], v[12:15], v[80:95]
  ds_read_b128 v[20:23], v3 offset:44032
  v_mfma_f32_32x32x16_bf16 v[96:111], v[164:167], v[8:11], v[96:111]
  v_mfma_f32_32x32x16_bf16 v[112:127], v[164:167], v[12:15], v[112:127]
  buffer_load_dwordx4 v[160:163], v2, s[60:63], s64 offen offset:0
  buffer_load_dwordx4 v[164:167], v2, s[60:63], s64 offen offset:1024
  s_waitcnt vmcnt(30) lgkmcnt(0)
  v_mfma_f32_32x32x16_bf16 v[64:79], v[168:171], v[16:19], v[64:79]
  ds_read_b128 v[8:11], v3 offset:45056
  v_mfma_f32_32x32x16_bf16 v[80:95], v[168:171], v[20:23], v[80:95]
  ds_read_b128 v[12:15], v3 offset:46080
  v_mfma_f32_32x32x16_bf16 v[96:111], v[172:175], v[16:19], v[96:111]
  v_mfma_f32_32x32x16_bf16 v[112:127], v[172:175], v[20:23], v[112:127]
  buffer_load_dwordx4 v[168:171], v2, s[60:63], s64 offen offset:2048
  buffer_load_dwordx4 v[172:175], v2, s[60:63], s64 offen offset:3072
  s_add_u32 s64, s64, 4096
  s_waitcnt vmcnt(30) lgkmcnt(0)
  v_mfma_f32_32x32x16_bf16 v[64:79], v[176:179], v[8:11], v[64:79]
  ds_read_b128 v[16:19], v3 offset:47104
  v_mfma_f32_32x32x16_bf16 v[80:95], v[176:179], v[12:15], v[80:95]
  ds_read_b128 v[20:23], v3 offset:48128
  v_mfma_f32_32x32x16_bf16 v[96:111], v[180:183], v[8:11], v[96:111]
  v_mfma_f32_32x32x16_bf16 v[112:127], v[180:183], v[12:15], v[112:127]
  buffer_load_dwordx4 v[176:179], v2, s[60:63], s64 offen offset:0
  buffer_load_dwordx4 v[180:183], v2, s[60:63], s64 offen offset:1024
  s_waitcnt vmcnt(30) lgkmcnt(0)
  v_mfma_f32_32x32x16_bf16 v[64:79], v[184:187], v[16:19], v[64:79]
  ds_read_b128 v[8:11], v3 offset:49152
  v_mfma_f32_32x32x16_bf16 v[80:95], v[184:187], v[20:23], v[80:95]
  ds_read_b128 v[12:15], v3 offset:50176
  v_mfma_f32_32x32x16_bf16 v[96:111], v[188:191], v[16:19], v[96:111]
  v_mfma_f32_32x32x16_bf16 v[112:127], v[188:191], v[20:23], v[112:127]
  buffer_load_dwordx4 v[184:187], v2, s[60:63], s64 offen offset:2048
  buffer_load_dwordx4 v[188:191], v2, s[60:63], s64 offen offset:3072
  s_add_u32 s64, s64, 4096
  s_waitcnt vmcnt(30) lgkmcnt(0)
  v_mfma_f32_32x32x16_bf16 v[64:79], v[192:195], v[8:11], v[64:79]
  ds_read_b128 v[16:19], v3 offset:51200
  v_mfma_f32_32x32x16_bf16 v[80:95], v[192:195], v[12:15], v[80:95]
  ds_read_b128 v[20:23], v3 offset:52224
  v_mfma_f32_32x32x16_bf16 v[96:111], v[196:199], v[8:11], v[96:111]
  v_mfma_f32_32x32x16_bf16 v[112:127], v[196:199], v[12:15], v[112:127]
  buffer_load_dwordx4 v[192:195], v2, s[60:63], s64 offen offset:0
  buffer_load_dwordx4 v[196:199], v2, s[60:63], s64 offen offset:1024
  s_waitcnt vmcnt(30) lgkmcnt(0)
  v_mfma_f32_32x32x16_bf16 v[64:79], v[200:203], v[16:19], v[64:79]
  ds_read_b128 v[8:11], v3 offset:53248
  v_mfma_f32_32x32x16_bf16 v[80:95], v[200:203], v[20:23], v[80:95]
  ds_read_b128 v[12:15], v3 offset:54272
  v_mfma_f32_32x32x16_bf16 v[96:111], v[204:207], v[16:19], v[96:111]
  v_mfma_f32_32x32x16_bf16 v[112:127], v[204:207], v[20:23], v[112:127]
  buffer_load_dwordx4 v[200:203], v2, s[60:63], s64 offen offset:2048
  buffer_load_dwordx4 v[204:207], v2, s[60:63], s64 offen offset:3072
  s_add_u32 s64, s64, 4096
  s_waitcnt vmcnt(30) lgkmcnt(0)
  v_mfma_f32_32x32x16_bf16 v[64:79], v[208:211], v[8:11], v[64:79]
  ds_read_b128 v[16:19], v3 offset:55296
  v_mfma_f32_32x32x16_bf16 v[80:95], v[208:211], v[12:15], v[80:95]
  ds_read_b128 v[20:23], v3 offset:56320
  v_mfma_f32_32x32x16_bf16 v[96:111], v[212:215], v[8:11], v[96:111]
  v_mfma_f32_32x32x16_bf16 v[112:127], v[212:215], v[12:15], v[112:127]
  buffer_load_dwordx4 v[208:211], v2, s[60:63], s64 offen offset:0
  buffer_load_dwordx4 v[212:215], v2, s[60:63], s64 offen offset:1024
  s_waitcnt vmcnt(30) lgkmcnt(0)
  v_mfma_f32_32x32x16_bf16 v[64:79], v[216:219], v[16:19], v[64:79]
  v_mfma_f32_32x32x16_bf16 v[80:95], v[216:219], v[20:23], v[80:95]
  v_mfma_f32_32x32x16_bf16 v[96:111], v[220:223], v[16:19], v[96:111]
  v_mfma_f32_32x32x16_bf16 v[112:127], v[220:223], v[20:23], v[112:127]
  buffer_load_dwordx4 v[216:219], v2, s[60:63], s64 offen offset:2048
  buffer_load_dwordx4 v[220:223], v2, s[60:63], s64 offen offset:3072
  s_add_u32 s64, s64, 4096
  s_setprio 0
  v_mov_b32 v8, v48
  v_mov_b32 v9, v48
  v_mov_b32 v10, v49
  v_mov_b32 v11, v49
  v_mov_b32 v12, v50
  v_mov_b32 v13, v50
  v_mov_b32 v14, v51
  v_mov_b32 v15, v51
  v_mov_b32 v16, v52
  v_mov_b32 v17, v52
  v_mov_b32 v18, v53
  v_mov_b32 v19, v53
  v_pk_mul_f32 v[32:33], v[64:65], v[64:65]
  v_pk_mul_f32 v[34:35], v[66:67], v[66:67]
  v_pk_mul_f32 v[36:37], v[68:69], v[68:69]
  v_pk_mul_f32 v[38:39], v[70:71], v[70:71]
  v_pk_mul_f32 v[40:41], v[72:73], v[72:73]
  v_pk_mul_f32 v[42:43], v[74:75], v[74:75]
  v_pk_mul_f32 v[44:45], v[76:77], v[76:77]
  v_pk_mul_f32 v[46:47], v[78:79], v[78:79]
  v_pk_fma_f32 v[32:33], v[32:33], v[10:11], v[8:9]
  v_pk_fma_f32 v[34:35], v[34:35], v[10:11], v[8:9]
  v_pk_fma_f32 v[36:37], v[36:37], v[10:11], v[8:9]
  v_pk_fma_f32 v[38:39], v[38:39], v[10:11], v[8:9]
  v_pk_fma_f32 v[40:41], v[40:41], v[10:11], v[8:9]
  v_pk_fma_f32 v[42:43], v[42:43], v[10:11], v[8:9]
  v_pk_fma_f32 v[44:45], v[44:45], v[10:11], v[8:9]
  v_pk_fma_f32 v[46:47], v[46:47], v[10:11], v[8:9]
  v_pk_mul_f32 v[32:33], v[32:33], v[64:65]
  v_pk_mul_f32 v[34:35], v[34:35], v[66:67]
  v_pk_mul_f32 v[36:37], v[36:37], v[68:69]
  v_pk_mul_f32 v[38:39], v[38:39], v[70:71]
  v_pk_mul_f32 v[40:41], v[40:41], v[72:73]
  v_pk_mul_f32 v[42:43], v[42:43], v[74:75]
  v_pk_mul_f32 v[44:45], v[44:45], v[76:77]
  v_pk_mul_f32 v[46:47], v[46:47], v[78:79]
  v_exp_f32 v32, v32
  v_exp_f32 v33, v33
  v_exp_f32 v34, v34
  v_exp_f32 v35, v35
  v_exp_f32 v36, v36
  v_exp_f32 v37, v37
  v_exp_f32 v38, v38
  v_exp_f32 v39, v39
  v_exp_f32 v40, v40
  v_exp_f32 v41, v41
  v_exp_f32 v42, v42
  v_exp_f32 v43, v43
  v_exp_f32 v44, v44
  v_exp_f32 v45, v45
  v_exp_f32 v46, v46
  v_exp_f32 v47, v47
  v_pk_fma_f32 v[32:33], v[32:33], v[12:13], v[12:13]
  v_pk_fma_f32 v[34:35], v[34:35], v[12:13], v[12:13]
  v_pk_fma_f32 v[36:37], v[36:37], v[12:13], v[12:13]
  v_pk_fma_f32 v[38:39], v[38:39], v[12:13], v[12:13]
  v_pk_fma_f32 v[40:41], v[40:41], v[12:13], v[12:13]
  v_pk_fma_f32 v[42:43], v[42:43], v[12:13], v[12:13]
  v_pk_fma_f32 v[44:45], v[44:45], v[12:13], v[12:13]
  v_pk_fma_f32 v[46:47], v[46:47], v[12:13], v[12:13]
  v_rcp_f32 v32, v32
  v_rcp_f32 v33, v33
  v_rcp_f32 v34, v34
  v_rcp_f32 v35, v35
  v_rcp_f32 v36, v36
  v_rcp_f32 v37, v37
  v_rcp_f32 v38, v38
  v_rcp_f32 v39, v39
  v_rcp_f32 v40, v40
  v_rcp_f32 v41, v41
  v_rcp_f32 v42, v42
  v_rcp_f32 v43, v43
  v_rcp_f32 v44, v44
  v_rcp_f32 v45, v45
  v_rcp_f32 v46, v46
  v_rcp_f32 v47, v47
  v_pk_mul_f32 v[64:65], v[64:65], v[32:33]
  v_pk_mul_f32 v[66:67], v[66:67], v[34:35]
  v_pk_mul_f32 v[68:69], v[68:69], v[36:37]
  v_pk_mul_f32 v[70:71], v[70:71], v[38:39]
  v_pk_mul_f32 v[72:73], v[72:73], v[40:41]
  v_pk_mul_f32 v[74:75], v[74:75], v[42:43]
  v_pk_mul_f32 v[76:77], v[76:77], v[44:45]
  v_pk_mul_f32 v[78:79], v[78:79], v[46:47]
  v_cvt_pk_bf16_f32 v64, v64, v65
  v_cvt_pk_bf16_f32 v65, v66, v67
  v_cvt_pk_bf16_f32 v66, v68, v69
  v_cvt_pk_bf16_f32 v67, v70, v71
  v_cvt_pk_bf16_f32 v68, v72, v73
  v_cvt_pk_bf16_f32 v69, v74, v75
  v_cvt_pk_bf16_f32 v70, v76, v77
  v_cvt_pk_bf16_f32 v71, v78, v79
  v_and_b32 v4, 31, v0
  v_lshrrev_b32 v5, 5, v0
  v_lshlrev_b32 v6, 11, v5
  v_lshl_add_u32 v6, v4, 4, v6
  s_lshl_b32 s44, s40, 13
  s_add_u32 s44, s44, 57344
  v_add_u32 v6, s44, v6
  ds_write_b128 v6, v[64:67] offset:0
  ds_write_b128 v6, v[68:71] offset:512
  v_pk_mul_f32 v[32:33], v[80:81], v[80:81]
  v_pk_mul_f32 v[34:35], v[82:83], v[82:83]
  v_pk_mul_f32 v[36:37], v[84:85], v[84:85]
  v_pk_mul_f32 v[38:39], v[86:87], v[86:87]
  v_pk_mul_f32 v[40:41], v[88:89], v[88:89]
  v_pk_mul_f32 v[42:43], v[90:91], v[90:91]
  v_pk_mul_f32 v[44:45], v[92:93], v[92:93]
  v_pk_mul_f32 v[46:47], v[94:95], v[94:95]
  v_pk_fma_f32 v[32:33], v[32:33], v[16:17], v[14:15]
  v_pk_fma_f32 v[34:35], v[34:35], v[16:17], v[14:15]
  v_pk_fma_f32 v[36:37], v[36:37], v[16:17], v[14:15]
  v_pk_fma_f32 v[38:39], v[38:39], v[16:17], v[14:15]
  v_pk_fma_f32 v[40:41], v[40:41], v[16:17], v[14:15]
  v_pk_fma_f32 v[42:43], v[42:43], v[16:17], v[14:15]
  v_pk_fma_f32 v[44:45], v[44:45], v[16:17], v[14:15]
  v_pk_fma_f32 v[46:47], v[46:47], v[16:17], v[14:15]
  v_pk_mul_f32 v[32:33], v[32:33], v[80:81]
  v_pk_mul_f32 v[34:35], v[34:35], v[82:83]
  v_pk_mul_f32 v[36:37], v[36:37], v[84:85]
  v_pk_mul_f32 v[38:39], v[38:39], v[86:87]
  v_pk_mul_f32 v[40:41], v[40:41], v[88:89]
  v_pk_mul_f32 v[42:43], v[42:43], v[90:91]
  v_pk_mul_f32 v[44:45], v[44:45], v[92:93]
  v_pk_mul_f32 v[46:47], v[46:47], v[94:95]
  v_exp_f32 v32, v32
  v_exp_f32 v33, v33
  v_exp_f32 v34, v34
  v_exp_f32 v35, v35
  v_exp_f32 v36, v36
  v_exp_f32 v37, v37
  v_exp_f32 v38, v38
  v_exp_f32 v39, v39
  v_exp_f32 v40, v40
  v_exp_f32 v41, v41
  v_exp_f32 v42, v42
  v_exp_f32 v43, v43
  v_exp_f32 v44, v44
  v_exp_f32 v45, v45
  v_exp_f32 v46, v46
  v_exp_f32 v47, v47
  v_pk_fma_f32 v[32:33], v[32:33], v[18:19], v[18:19]
  v_pk_fma_f32 v[34:35], v[34:35], v[18:19], v[18:19]
  v_pk_fma_f32 v[36:37], v[36:37], v[18:19], v[18:19]
  v_pk_fma_f32 v[38:39], v[38:39], v[18:19], v[18:19]
  v_pk_fma_f32 v[40:41], v[40:41], v[18:19], v[18:19]
  v_pk_fma_f32 v[42:43], v[42:43], v[18:19], v[18:19]
  v_pk_fma_f32 v[44:45], v[44:45], v[18:19], v[18:19]
  v_pk_fma_f32 v[46:47], v[46:47], v[18:19], v[18:19]
  v_rcp_f32 v32, v32
  v_rcp_f32 v33, v33
  v_rcp_f32 v34, v34
  v_rcp_f32 v35, v35
  v_rcp_f32 v36, v36
  v_rcp_f32 v37, v37
  v_rcp_f32 v38, v38
  v_rcp_f32 v39, v39
  v_rcp_f32 v40, v40
  v_rcp_f32 v41, v41
  v_rcp_f32 v42, v42
  v_rcp_f32 v43, v43
  v_rcp_f32 v44, v44
  v_rcp_f32 v45, v45
  v_rcp_f32 v46, v46
  v_rcp_f32 v47, v47
  v_pk_mul_f32 v[80:81], v[80:81], v[32:33]
  v_pk_mul_f32 v[82:83], v[82:83], v[34:35]
  v_pk_mul_f32 v[84:85], v[84:85], v[36:37]
  v_pk_mul_f32 v[86:87], v[86:87], v[38:39]
  v_pk_mul_f32 v[88:89], v[88:89], v[40:41]
  v_pk_mul_f32 v[90:91], v[90:91], v[42:43]
  v_pk_mul_f32 v[92:93], v[92:93], v[44:45]
  v_pk_mul_f32 v[94:95], v[94:95], v[46:47]
  v_cvt_pk_bf16_f32 v80, v80, v81
  v_cvt_pk_bf16_f32 v81, v82, v83
  v_cvt_pk_bf16_f32 v82, v84, v85
  v_cvt_pk_bf16_f32 v83, v86, v87
  v_cvt_pk_bf16_f32 v84, v88, v89
  v_cvt_pk_bf16_f32 v85, v90, v91
  v_cvt_pk_bf16_f32 v86, v92, v93
  v_cvt_pk_bf16_f32 v87, v94, v95
  ds_write_b128 v6, v[80:83] offset:1024
  ds_write_b128 v6, v[84:87] offset:1536
  v_pk_mul_f32 v[32:33], v[96:97], v[96:97]
  v_pk_mul_f32 v[34:35], v[98:99], v[98:99]
  v_pk_mul_f32 v[36:37], v[100:101], v[100:101]
  v_pk_mul_f32 v[38:39], v[102:103], v[102:103]
  v_pk_mul_f32 v[40:41], v[104:105], v[104:105]
  v_pk_mul_f32 v[42:43], v[106:107], v[106:107]
  v_pk_mul_f32 v[44:45], v[108:109], v[108:109]
  v_pk_mul_f32 v[46:47], v[110:111], v[110:111]
  v_pk_fma_f32 v[32:33], v[32:33], v[10:11], v[8:9]
  v_pk_fma_f32 v[34:35], v[34:35], v[10:11], v[8:9]
  v_pk_fma_f32 v[36:37], v[36:37], v[10:11], v[8:9]
  v_pk_fma_f32 v[38:39], v[38:39], v[10:11], v[8:9]
  v_pk_fma_f32 v[40:41], v[40:41], v[10:11], v[8:9]
  v_pk_fma_f32 v[42:43], v[42:43], v[10:11], v[8:9]
  v_pk_fma_f32 v[44:45], v[44:45], v[10:11], v[8:9]
  v_pk_fma_f32 v[46:47], v[46:47], v[10:11], v[8:9]
  v_pk_mul_f32 v[32:33], v[32:33], v[96:97]
  v_pk_mul_f32 v[34:35], v[34:35], v[98:99]
  v_pk_mul_f32 v[36:37], v[36:37], v[100:101]
  v_pk_mul_f32 v[38:39], v[38:39], v[102:103]
  v_pk_mul_f32 v[40:41], v[40:41], v[104:105]
  v_pk_mul_f32 v[42:43], v[42:43], v[106:107]
  v_pk_mul_f32 v[44:45], v[44:45], v[108:109]
  v_pk_mul_f32 v[46:47], v[46:47], v[110:111]
  v_exp_f32 v32, v32
  v_exp_f32 v33, v33
  v_exp_f32 v34, v34
  v_exp_f32 v35, v35
  v_exp_f32 v36, v36
  v_exp_f32 v37, v37
  v_exp_f32 v38, v38
  v_exp_f32 v39, v39
  v_exp_f32 v40, v40
  v_exp_f32 v41, v41
  v_exp_f32 v42, v42
  v_exp_f32 v43, v43
  v_exp_f32 v44, v44
  v_exp_f32 v45, v45
  v_exp_f32 v46, v46
  v_exp_f32 v47, v47
  v_pk_fma_f32 v[32:33], v[32:33], v[12:13], v[12:13]
  v_pk_fma_f32 v[34:35], v[34:35], v[12:13], v[12:13]
  v_pk_fma_f32 v[36:37], v[36:37], v[12:13], v[12:13]
  v_pk_fma_f32 v[38:39], v[38:39], v[12:13], v[12:13]
  v_pk_fma_f32 v[40:41], v[40:41], v[12:13], v[12:13]
  v_pk_fma_f32 v[42:43], v[42:43], v[12:13], v[12:13]
  v_pk_fma_f32 v[44:45], v[44:45], v[12:13], v[12:13]
  v_pk_fma_f32 v[46:47], v[46:47], v[12:13], v[12:13]
  v_rcp_f32 v32, v32
  v_rcp_f32 v33, v33
  v_rcp_f32 v34, v34
  v_rcp_f32 v35, v35
  v_rcp_f32 v36, v36
  v_rcp_f32 v37, v37
  v_rcp_f32 v38, v38
  v_rcp_f32 v39, v39
  v_rcp_f32 v40, v40
  v_rcp_f32 v41, v41
  v_rcp_f32 v42, v42
  v_rcp_f32 v43, v43
  v_rcp_f32 v44, v44
  v_rcp_f32 v45, v45
  v_rcp_f32 v46, v46
  v_rcp_f32 v47, v47
  v_pk_mul_f32 v[96:97], v[96:97], v[32:33]
  v_pk_mul_f32 v[98:99], v[98:99], v[34:35]
  v_pk_mul_f32 v[100:101], v[100:101], v[36:37]
  v_pk_mul_f32 v[102:103], v[102:103], v[38:39]
  v_pk_mul_f32 v[104:105], v[104:105], v[40:41]
  v_pk_mul_f32 v[106:107], v[106:107], v[42:43]
  v_pk_mul_f32 v[108:109], v[108:109], v[44:45]
  v_pk_mul_f32 v[110:111], v[110:111], v[46:47]
  v_cvt_pk_bf16_f32 v96, v96, v97
  v_cvt_pk_bf16_f32 v97, v98, v99
  v_cvt_pk_bf16_f32 v98, v100, v101
  v_cvt_pk_bf16_f32 v99, v102, v103
  v_cvt_pk_bf16_f32 v100, v104, v105
  v_cvt_pk_bf16_f32 v101, v106, v107
  v_cvt_pk_bf16_f32 v102, v108, v109
  v_cvt_pk_bf16_f32 v103, v110, v111
  ds_write_b128 v6, v[96:99] offset:4096
  ds_write_b128 v6, v[100:103] offset:4608
  v_pk_mul_f32 v[32:33], v[112:113], v[112:113]
  v_pk_mul_f32 v[34:35], v[114:115], v[114:115]
  v_pk_mul_f32 v[36:37], v[116:117], v[116:117]
  v_pk_mul_f32 v[38:39], v[118:119], v[118:119]
  v_pk_mul_f32 v[40:41], v[120:121], v[120:121]
  v_pk_mul_f32 v[42:43], v[122:123], v[122:123]
  v_pk_mul_f32 v[44:45], v[124:125], v[124:125]
  v_pk_mul_f32 v[46:47], v[126:127], v[126:127]
  v_pk_fma_f32 v[32:33], v[32:33], v[16:17], v[14:15]
  v_pk_fma_f32 v[34:35], v[34:35], v[16:17], v[14:15]
  v_pk_fma_f32 v[36:37], v[36:37], v[16:17], v[14:15]
  v_pk_fma_f32 v[38:39], v[38:39], v[16:17], v[14:15]
  v_pk_fma_f32 v[40:41], v[40:41], v[16:17], v[14:15]
  v_pk_fma_f32 v[42:43], v[42:43], v[16:17], v[14:15]
  v_pk_fma_f32 v[44:45], v[44:45], v[16:17], v[14:15]
  v_pk_fma_f32 v[46:47], v[46:47], v[16:17], v[14:15]
  v_pk_mul_f32 v[32:33], v[32:33], v[112:113]
  v_pk_mul_f32 v[34:35], v[34:35], v[114:115]
  v_pk_mul_f32 v[36:37], v[36:37], v[116:117]
  v_pk_mul_f32 v[38:39], v[38:39], v[118:119]
  v_pk_mul_f32 v[40:41], v[40:41], v[120:121]
  v_pk_mul_f32 v[42:43], v[42:43], v[122:123]
  v_pk_mul_f32 v[44:45], v[44:45], v[124:125]
  v_pk_mul_f32 v[46:47], v[46:47], v[126:127]
  v_exp_f32 v32, v32
  v_exp_f32 v33, v33
  v_exp_f32 v34, v34
  v_exp_f32 v35, v35
  v_exp_f32 v36, v36
  v_exp_f32 v37, v37
  v_exp_f32 v38, v38
  v_exp_f32 v39, v39
  v_exp_f32 v40, v40
  v_exp_f32 v41, v41
  v_exp_f32 v42, v42
  v_exp_f32 v43, v43
  v_exp_f32 v44, v44
  v_exp_f32 v45, v45
  v_exp_f32 v46, v46
  v_exp_f32 v47, v47
  v_pk_fma_f32 v[32:33], v[32:33], v[18:19], v[18:19]
  v_pk_fma_f32 v[34:35], v[34:35], v[18:19], v[18:19]
  v_pk_fma_f32 v[36:37], v[36:37], v[18:19], v[18:19]
  v_pk_fma_f32 v[38:39], v[38:39], v[18:19], v[18:19]
  v_pk_fma_f32 v[40:41], v[40:41], v[18:19], v[18:19]
  v_pk_fma_f32 v[42:43], v[42:43], v[18:19], v[18:19]
  v_pk_fma_f32 v[44:45], v[44:45], v[18:19], v[18:19]
  v_pk_fma_f32 v[46:47], v[46:47], v[18:19], v[18:19]
  v_rcp_f32 v32, v32
  v_rcp_f32 v33, v33
  v_rcp_f32 v34, v34
  v_rcp_f32 v35, v35
  v_rcp_f32 v36, v36
  v_rcp_f32 v37, v37
  v_rcp_f32 v38, v38
  v_rcp_f32 v39, v39
  v_rcp_f32 v40, v40
  v_rcp_f32 v41, v41
  v_rcp_f32 v42, v42
  v_rcp_f32 v43, v43
  v_rcp_f32 v44, v44
  v_rcp_f32 v45, v45
  v_rcp_f32 v46, v46
  v_rcp_f32 v47, v47
  v_pk_mul_f32 v[112:113], v[112:113], v[32:33]
  v_pk_mul_f32 v[114:115], v[114:115], v[34:35]
  v_pk_mul_f32 v[116:117], v[116:117], v[36:37]
  v_pk_mul_f32 v[118:119], v[118:119], v[38:39]
  v_pk_mul_f32 v[120:121], v[120:121], v[40:41]
  v_pk_mul_f32 v[122:123], v[122:123], v[42:43]
  v_pk_mul_f32 v[124:125], v[124:125], v[44:45]
  v_pk_mul_f32 v[126:127], v[126:127], v[46:47]
  v_cvt_pk_bf16_f32 v112, v112, v113
  v_cvt_pk_bf16_f32 v113, v114, v115
  v_cvt_pk_bf16_f32 v114, v116, v117
  v_cvt_pk_bf16_f32 v115, v118, v119
  v_cvt_pk_bf16_f32 v116, v120, v121
  v_cvt_pk_bf16_f32 v117, v122, v123
  v_cvt_pk_bf16_f32 v118, v124, v125
  v_cvt_pk_bf16_f32 v119, v126, v127
  ds_write_b128 v6, v[112:115] offset:5120
  ds_write_b128 v6, v[116:119] offset:5632
  v_lshlrev_b32 v3, 4, v0
  v_add_u32 v3, 57344, v3
  v_lshlrev_b32 v6, 12, v5
  v_add_u32 v6, v6, v4
  v_lshlrev_b32 v6, 4, v6
  s_waitcnt lgkmcnt(0)
  s_add_u32 s38, s38, 4
  v_mov_b32 v62, 1
  s_mov_b64 exec, 1
  ds_add_u32 v1, v62 offset:4
  s_mov_b64 exec, -1
lw_140:
  ds_read_b32 v62, v1 offset:4
  s_waitcnt lgkmcnt(0)
  v_readfirstlane_b32 s37, v62
  s_nop 0
  s_cmp_ge_u32 s37, s38
  s_cbranch_scc1 lwd_141
  s_sub_u32 s39, s39, 1
  s_nop 0
  s_cbranch_scc0 lw_140
  s_mov_b32 s39, 0
lwd_141:
  s_setprio 0
  ds_read_b128 v[8:11], v3 offset:0
  ds_read_b128 v[12:15], v3 offset:1024
  s_waitcnt vmcnt(30) lgkmcnt(0)
  v_mfma_f32_32x32x16_bf16 v[64:79], v[224:227], v[8:11], 0
  ds_read_b128 v[16:19], v3 offset:2048
  v_mfma_f32_32x32x16_bf16 v[80:95], v[224:227], v[12:15], 0
  ds_read_b128 v[20:23], v3 offset:3072
  v_mfma_f32_32x32x16_bf16 v[96:111], v[228:231], v[8:11], 0
  v_mfma_f32_32x32x16_bf16 v[112:127], v[228:231], v[12:15], 0
  s_mul_i32 s64, s42, 7
  s_add_u32 s64, s64, s57
  s_lshl_b32 s64, s64, 15
  s_and_b32 s35, s40, 1
  s_lshl_b32 s35, s35, 10
  s_add_u32 s64, s64, s35
  s_add_u32 s64, s64, 10747904
  s_lshl_b32 s65, s42, 18
  s_lshr_b32 s35, s40, 1
  s_lshl_b32 s35, s35, 10
  s_add_u32 s65, s65, s35
  s_add_u32 s65, s65, 10747904
  buffer_load_dwordx4 v[224:227], v2, s[60:63], s64 offen offset:0
  buffer_load_dwordx4 v[228:231], v2, s[60:63], s65 offen offset:0
  s_waitcnt vmcnt(30) lgkmcnt(0)
  v_mfma_f32_32x32x16_bf16 v[64:79], v[232:235], v[16:19], v[64:79]
  ds_read_b128 v[8:11], v3 offset:4096
  v_mfma_f32_32x32x16_bf16 v[80:95], v[232:235], v[20:23], v[80:95]
  ds_read_b128 v[12:15], v3 offset:5120
  v_mfma_f32_32x32x16_bf16 v[96:111], v[236:239], v[16:19], v[96:111]
  v_mfma_f32_32x32x16_bf16 v[112:127], v[236:239], v[20:23], v[112:127]
  buffer_load_dwordx4 v[232:235], v2, s[60:63], s64 offen offset:2048
  buffer_load_dwordx4 v[236:239], v2, s[60:63], s65 offen offset:2048
  s_add_u32 s64, s64, 4096
  s_add_u32 s65, s65, 4096
  s_waitcnt vmcnt(30) lgkmcnt(0)
  v_mfma_f32_32x32x16_bf16 v[64:79], v[240:243], v[8:11], v[64:79]
  ds_read_b128 v[16:19], v3 offset:6144
  v_mfma_f32_32x32x16_bf16 v[80:95], v[240:243], v[12:15], v[80:95]
  ds_read_b128 v[20:23], v3 offset:7168
  v_mfma_f32_32x32x16_bf16 v[96:111], v[244:247], v[8:11], v[96:111]
  v_mfma_f32_32x32x16_bf16 v[112:127], v[244:247], v[12:15], v[112:127]
  buffer_load_dwordx4 v[240:243], v2, s[60:63], s64 offen offset:0
  buffer_load_dwordx4 v[244:247], v2, s[60:63], s65 offen offset:0
  s_waitcnt vmcnt(30) lgkmcnt(0)
  v_mfma_f32_32x32x16_bf16 v[64:79], v[248:251], v[16:19], v[64:79]
  ds_read_b128 v[8:11], v3 offset:8192
  v_mfma_f32_32x32x16_bf16 v[80:95], v[248:251], v[20:23], v[80:95]
  ds_read_b128 v[12:15], v3 offset:9216
  v_mfma_f32_32x32x16_bf16 v[96:111], v[252:255], v[16:19], v[96:111]
  v_mfma_f32_32x32x16_bf16 v[112:127], v[252:255], v[20:23], v[112:127]
  buffer_load_dwordx4 v[248:251], v2, s[60:63], s64 offen offset:2048
  buffer_load_dwordx4 v[252:255], v2, s[60:63], s65 offen offset:2048
  s_add_u32 s64, s64, 4096
  s_add_u32 s65, s65, 4096
  s_waitcnt vmcnt(30) lgkmcnt(0)
  v_mfma_f32_32x32x16_bf16 v[64:79], v[128:131], v[8:11], v[64:79]
  ds_read_b128 v[16:19], v3 offset:10240
  v_mfma_f32_32x32x16_bf16 v[80:95], v[128:131], v[12:15], v[80:95]
  ds_read_b128 v[20:23], v3 offset:11264
  v_mfma_f32_32x32x16_bf16 v[96:111], v[132:135], v[8:11], v[96:111]
  v_mfma_f32_32x32x16_bf16 v[112:127], v[132:135], v[12:15], v[112:127]
  buffer_load_dwordx4 v[128:131], v2, s[60:63], s64 offen offset:0
  buffer_load_dwordx4 v[132:135], v2, s[60:63], s65 offen offset:0
  s_waitcnt vmcnt(30) lgkmcnt(0)
  v_mfma_f32_32x32x16_bf16 v[64:79], v[136:139], v[16:19], v[64:79]
  ds_read_b128 v[8:11], v3 offset:12288
  v_mfma_f32_32x32x16_bf16 v[80:95], v[136:139], v[20:23], v[80:95]
  ds_read_b128 v[12:15], v3 offset:13312
  v_mfma_f32_32x32x16_bf16 v[96:111], v[140:143], v[16:19], v[96:111]
  v_mfma_f32_32x32x16_bf16 v[112:127], v[140:143], v[20:23], v[112:127]
  buffer_load_dwordx4 v[136:139], v2, s[60:63], s64 offen offset:2048
  buffer_load_dwordx4 v[140:143], v2, s[60:63], s65 offen offset:2048
  s_add_u32 s64, s64, 4096
  s_add_u32 s65, s65, 4096
  s_waitcnt vmcnt(30) lgkmcnt(0)
  v_mfma_f32_32x32x16_bf16 v[64:79], v[144:147], v[8:11], v[64:79]
  ds_read_b128 v[16:19], v3 offset:14336
  v_mfma_f32_32x32x16_bf16 v[80:95], v[144:147], v[12:15], v[80:95]
  ds_read_b128 v[20:23], v3 offset:15360
  v_mfma_f32_32x32x16_bf16 v[96:111], v[148:151], v[8:11], v[96:111]
  v_mfma_f32_32x32x16_bf16 v[112:127], v[148:151], v[12:15], v[112:127]
  buffer_load_dwordx4 v[144:147], v2, s[60:63], s64 offen offset:0
  buffer_load_dwordx4 v[148:151], v2, s[60:63], s65 offen offset:0
  s_waitcnt vmcnt(30) lgkmcnt(0)
  v_mfma_f32_32x32x16_bf16 v[64:79], v[152:155], v[16:19], v[64:79]
  ds_read_b128 v[8:11], v3 offset:16384
  v_mfma_f32_32x32x16_bf16 v[80:95], v[152:155], v[20:23], v[80:95]
  ds_read_b128 v[12:15], v3 offset:17408
  v_mfma_f32_32x32x16_bf16 v[96:111], v[156:159], v[16:19], v[96:111]
  v_mfma_f32_32x32x16_bf16 v[112:127], v[156:159], v[20:23], v[112:127]
  buffer_load_dwordx4 v[152:155], v2, s[60:63], s64 offen offset:2048
  buffer_load_dwordx4 v[156:159], v2, s[60:63], s65 offen offset:2048
  s_add_u32 s64, s64, 4096
  s_add_u32 s65, s65, 4096
  s_waitcnt vmcnt(30) lgkmcnt(0)
  v_mfma_f32_32x32x16_bf16 v[64:79], v[160:163], v[8:11], v[64:79]
  ds_read_b128 v[16:19], v3 offset:18432
  v_mfma_f32_32x32x16_bf16 v[80:95], v[160:163], v[12:15], v[80:95]
  ds_read_b128 v[20:23], v3 offset:19456
  v_mfma_f32_32x32x16_bf16 v[96:111], v[164:167], v[8:11], v[96:111]
  v_mfma_f32_32x32x16_bf16 v[112:127], v[164:167], v[12:15], v[112:127]
  buffer_load_dwordx4 v[160:163], v2, s[60:63], s64 offen offset:0
  buffer_load_dwordx4 v[164:167], v2, s[60:63], s65 offen offset:0
  s_waitcnt vmcnt(30) lgkmcnt(0)
  v_mfma_f32_32x32x16_bf16 v[64:79], v[168:171], v[16:19], v[64:79]
  ds_read_b128 v[8:11], v3 offset:20480
  v_mfma_f32_32x32x16_bf16 v[80:95], v[168:171], v[20:23], v[80:95]
  ds_read_b128 v[12:15], v3 offset:21504
  v_mfma_f32_32x32x16_bf16 v[96:111], v[172:175], v[16:19], v[96:111]
  v_mfma_f32_32x32x16_bf16 v[112:127], v[172:175], v[20:23], v[112:127]
  buffer_load_dwordx4 v[168:171], v2, s[60:63], s64 offen offset:2048
  buffer_load_dwordx4 v[172:175], v2, s[60:63], s65 offen offset:2048
  s_add_u32 s64, s64, 4096
  s_add_u32 s65, s65, 4096
  s_waitcnt vmcnt(30) lgkmcnt(0)
  v_mfma_f32_32x32x16_bf16 v[64:79], v[176:179], v[8:11], v[64:79]
  ds_read_b128 v[16:19], v3 offset:22528
  v_mfma_f32_32x32x16_bf16 v[80:95], v[176:179], v[12:15], v[80:95]
  ds_read_b128 v[20:23], v3 offset:23552
  v_mfma_f32_32x32x16_bf16 v[96:111], v[180:183], v[8:11], v[96:111]
  v_mfma_f32_32x32x16_bf16 v[112:127], v[180:183], v[12:15], v[112:127]
  buffer_load_dwordx4 v[176:179], v2, s[60:63], s64 offen offset:0
  buffer_load_dwordx4 v[180:183], v2, s[60:63], s65 offen offset:0
  s_waitcnt vmcnt(30) lgkmcnt(0)
  v_mfma_f32_32x32x16_bf16 v[64:79], v[184:187], v[16:19], v[64:79]
  ds_read_b128 v[8:11], v3 offset:24576
  v_mfma_f32_32x32x16_bf16 v[80:95], v[184:187], v[20:23], v[80:95]
  ds_read_b128 v[12:15], v3 offset:25600
  v_mfma_f32_32x32x16_bf16 v[96:111], v[188:191], v[16:19], v[96:111]
  v_mfma_f32_32x32x16_bf16 v[112:127], v[188:191], v[20:23], v[112:127]
  buffer_load_dwordx4 v[184:187], v2, s[60:63], s64 offen offset:2048
  buffer_load_dwordx4 v[188:191], v2, s[60:63], s65 offen offset:2048
  s_add_u32 s64, s64, 4096
  s_add_u32 s65, s65, 4096
  s_waitcnt vmcnt(30) lgkmcnt(0)
  v_mfma_f32_32x32x16_bf16 v[64:79], v[192:195], v[8:11], v[64:79]
  ds_read_b128 v[16:19], v3 offset:26624
  v_mfma_f32_32x32x16_bf16 v[80:95], v[192:195], v[12:15], v[80:95]
  ds_read_b128 v[20:23], v3 offset:27648
  v_mfma_f32_32x32x16_bf16 v[96:111], v[196:199], v[8:11], v[96:111]
  v_mfma_f32_32x32x16_bf16 v[112:127], v[196:199], v[12:15], v[112:127]
  buffer_load_dwordx4 v[192:195], v2, s[60:63], s64 offen offset:0
  buffer_load_dwordx4 v[196:199], v2, s[60:63], s65 offen offset:0
  s_waitcnt vmcnt(30) lgkmcnt(0)
  v_mfma_f32_32x32x16_bf16 v[64:79], v[200:203], v[16:19], v[64:79]
  ds_read_b128 v[8:11], v3 offset:28672
  v_mfma_f32_32x32x16_bf16 v[80:95], v[200:203], v[20:23], v[80:95]
  ds_read_b128 v[12:15], v3 offset:29696
  v_mfma_f32_32x32x16_bf16 v[96:111], v[204:207], v[16:19], v[96:111]
  v_mfma_f32_32x32x16_bf16 v[112:127], v[204:207], v[20:23], v[112:127]
  buffer_load_dwordx4 v[200:203], v2, s[60:63], s64 offen offset:2048
  buffer_load_dwordx4 v[204:207], v2, s[60:63], s65 offen offset:2048
  s_add_u32 s64, s64, 4096
  s_add_u32 s65, s65, 4096
  s_waitcnt vmcnt(30) lgkmcnt(0)
  v_mfma_f32_32x32x16_bf16 v[64:79], v[208:211], v[8:11], v[64:79]
  ds_read_b128 v[16:19], v3 offset:30720
  v_mfma_f32_32x32x16_bf16 v[80:95], v[208:211], v[12:15], v[80:95]
  ds_read_b128 v[20:23], v3 offset:31744
  v_mfma_f32_32x32x16_bf16 v[96:111], v[212:215], v[8:11], v[96:111]
  v_mfma_f32_32x32x16_bf16 v[112:127], v[212:215], v[12:15], v[112:127]
  buffer_load_dwordx4 v[208:211], v2, s[60:63], s64 offen offset:0
  buffer_load_dwordx4 v[212:215], v2, s[60:63], s65 offen offset:0
  s_waitcnt vmcnt(30) lgkmcnt(0)
  v_mfma_f32_32x32x16_bf16 v[64:79], v[216:219], v[16:19], v[64:79]
  v_mfma_f32_32x32x16_bf16 v[80:95], v[216:219], v[20:23], v[80:95]
  v_mfma_f32_32x32x16_bf16 v[96:111], v[220:223], v[16:19], v[96:111]
  v_mfma_f32_32x32x16_bf16 v[112:127], v[220:223], v[20:23], v[112:127]
  buffer_load_dwordx4 v[216:219], v2, s[60:63], s64 offen offset:2048
  buffer_load_dwordx4 v[220:223], v2, s[60:63], s65 offen offset:2048
  s_add_u32 s64, s64, 4096
  s_add_u32 s65, s65, 4096
  s_setprio 3
  v_mov_b32 v62, 1
  s_mov_b64 exec, 1
  ds_add_u32 v1, v62 offset:20
  s_mov_b64 exec, -1
  s_setprio 3
  ds_read_b128 v[8:11], v3 offset:0
  ds_read_b128 v[12:15], v3 offset:1024
  ds_read_b128 v[16:19], v3 offset:2048
  ds_read_b128 v[20:23], v3 offset:3072
  s_mul_i32 s44, s42, 56
  s_lshl_b32 s45, s34, 3
  s_add_u32 s44, s44, s45
  s_lshl_b32 s44, s44, 11
  s_lshl_b32 s45, s41, 6
  s_add_u32 s44, s44, s45
  s_lshl_b32 s44, s44, 4
  s_add_u32 s44, s44, 17268736
  s_waitcnt vmcnt(30) lgkmcnt(2)
  v_mfma_f32_32x32x16_bf16 v[24:39], v[224:227], v[8:11], 0
  ds_read_b128 v[56:59], v3 offset:4096
  ds_read_b128 v[60:63], v3 offset:5120
  v_cvt_pk_bf16_f32 v64, v64, v65
  v_cvt_pk_bf16_f32 v65, v66, v67
  v_cvt_pk_bf16_f32 v66, v68, v69
  v_cvt_pk_bf16_f32 v67, v70, v71
  v_mfma_f32_32x32x16_bf16 v[40:55], v[224:227], v[12:15], 0
  s_add_u32 s45, s44, 0
  buffer_store_dwordx4 v[64:67], v6, s[20:23], s45 offen sc1
  s_waitcnt vmcnt(29) lgkmcnt(2)
  v_mfma_f32_32x32x16_bf16 v[24:39], v[232:235], v[16:19], v[24:39]
  ds_read_b128 v[8:11], v3 offset:6144
  ds_read_b128 v[12:15], v3 offset:7168
  v_cvt_pk_bf16_f32 v68, v72, v73
  v_cvt_pk_bf16_f32 v69, v74, v75
  v_cvt_pk_bf16_f32 v70, v76, v77
  v_cvt_pk_bf16_f32 v71, v78, v79
  v_mfma_f32_32x32x16_bf16 v[40:55], v[232:235], v[20:23], v[40:55]
  s_add_u32 s45, s44, 32768
  buffer_store_dwordx4 v[68:71], v6, s[20:23], s45 offen sc1
  s_waitcnt vmcnt(28) lgkmcnt(2)
  v_mfma_f32_32x32x16_bf16 v[24:39], v[240:243], v[56:59], v[24:39]
  ds_read_b128 v[16:19], v3 offset:8192
  ds_read_b128 v[20:23], v3 offset:9216
  v_cvt_pk_bf16_f32 v80, v80, v81
  v_cvt_pk_bf16_f32 v81, v82, v83
  v_cvt_pk_bf16_f32 v82, v84, v85
  v_cvt_pk_bf16_f32 v83, v86, v87
  v_mfma_f32_32x32x16_bf16 v[40:55], v[240:243], v[60:63], v[40:55]
  s_add_u32 s45, s44, 512
  buffer_store_dwordx4 v[80:83], v6, s[20:23], s45 offen sc1
  s_waitcnt vmcnt(27) lgkmcnt(2)
  v_mfma_f32_32x32x16_bf16 v[24:39], v[248:251], v[8:11], v[24:39]
  ds_read_b128 v[56:59], v3 offset:10240
  ds_read_b128 v[60:63], v3 offset:11264
  v_cvt_pk_bf16_f32 v84, v88, v89
  v_cvt_pk_bf16_f32 v85, v90, v91
  v_cvt_pk_bf16_f32 v86, v92, v93
  v_cvt_pk_bf16_f32 v87, v94, v95
  v_mfma_f32_32x32x16_bf16 v[40:55], v[248:251], v[12:15], v[40:55]
  s_add_u32 s45, s44, 33280
  buffer_store_dwordx4 v[84:87], v6, s[20:23], s45 offen sc1
  s_waitcnt vmcnt(26) lgkmcnt(2)
  v_mfma_f32_32x32x16_bf16 v[24:39], v[128:131], v[16:19], v[24:39]
  ds_read_b128 v[8:11], v3 offset:12288
  ds_read_b128 v[12:15], v3 offset:13312
  v_cvt_pk_bf16_f32 v96, v96, v97
  v_cvt_pk_bf16_f32 v97, v98, v99
  v_cvt_pk_bf16_f32 v98, v100, v101
  v_cvt_pk_bf16_f32 v99, v102, v103
  v_mfma_f32_32x32x16_bf16 v[40:55], v[128:131], v[20:23], v[40:55]
  s_add_u32 s45, s44, 131072
  buffer_store_dwordx4 v[96:99], v6, s[20:23], s45 offen sc1
  s_waitcnt vmcnt(25) lgkmcnt(2)
  v_mfma_f32_32x32x16_bf16 v[24:39], v[136:139], v[56:59], v[24:39]
  ds_read_b128 v[16:19], v3 offset:14336
  ds_read_b128 v[20:23], v3 offset:15360
  v_cvt_pk_bf16_f32 v100, v104, v105
  v_cvt_pk_bf16_f32 v101, v106, v107
  v_cvt_pk_bf16_f32 v102, v108, v109
  v_cvt_pk_bf16_f32 v103, v110, v111
  v_mfma_f32_32x32x16_bf16 v[40:55], v[136:139], v[60:63], v[40:55]
  s_add_u32 s45, s44, 163840
  buffer_store_dwordx4 v[100:103], v6, s[20:23], s45 offen sc1
  s_waitcnt vmcnt(24) lgkmcnt(2)
  v_mfma_f32_32x32x16_bf16 v[24:39], v[144:147], v[8:11], v[24:39]
  ds_read_b128 v[56:59], v3 offset:16384
  ds_read_b128 v[60:63], v3 offset:17408
  v_cvt_pk_bf16_f32 v112, v112, v113
  v_cvt_pk_bf16_f32 v113, v114, v115
  v_cvt_pk_bf16_f32 v114, v116, v117
  v_cvt_pk_bf16_f32 v115, v118, v119
  v_mfma_f32_32x32x16_bf16 v[40:55], v[144:147], v[12:15], v[40:55]
  s_add_u32 s45, s44, 131584
  buffer_store_dwordx4 v[112:115], v6, s[20:23], s45 offen sc1
  s_waitcnt vmcnt(23) lgkmcnt(2)
  v_mfma_f32_32x32x16_bf16 v[24:39], v[152:155], v[16:19], v[24:39]
  ds_read_b128 v[8:11], v3 offset:18432
  ds_read_b128 v[12:15], v3 offset:19456
  v_cvt_pk_bf16_f32 v116, v120, v121
  v_cvt_pk_bf16_f32 v117, v122, v123
  v_cvt_pk_bf16_f32 v118, v124, v125
  v_cvt_pk_bf16_f32 v119, v126, v127
  v_mfma_f32_32x32x16_bf16 v[40:55], v[152:155], v[20:23], v[40:55]
  s_add_u32 s45, s44, 164352
  buffer_store_dwordx4 v[116:119], v6, s[20:23], s45 offen sc1
  s_waitcnt vmcnt(22) lgkmcnt(2)
  v_mfma_f32_32x32x16_bf16 v[24:39], v[160:163], v[56:59], v[24:39]
  ds_read_b128 v[16:19], v3 offset:20480
  ds_read_b128 v[20:23], v3 offset:21504
  v_mfma_f32_32x32x16_bf16 v[40:55], v[160:163], v[60:63], v[40:55]
  s_waitcnt vmcnt(20) lgkmcnt(2)
  v_mfma_f32_32x32x16_bf16 v[24:39], v[168:171], v[8:11], v[24:39]
  ds_read_b128 v[56:59], v3 offset:22528
  ds_read_b128 v[60:63], v3 offset:23552
  v_mfma_f32_32x32x16_bf16 v[40:55], v[168:171], v[12:15], v[40:55]
  s_waitcnt vmcnt(18) lgkmcnt(2)
  v_mfma_f32_32x32x16_bf16 v[24:39], v[176:179], v[16:19], v[24:39]
  ds_read_b128 v[8:11], v3 offset:24576
  ds_read_b128 v[12:15], v3 offset:25600
  v_mfma_f32_32x32x16_bf16 v[40:55], v[176:179], v[20:23], v[40:55]
  s_waitcnt vmcnt(16) lgkmcnt(2)
  v_mfma_f32_32x32x16_bf16 v[24:39], v[184:187], v[56:59], v[24:39]
  ds_read_b128 v[16:19], v3 offset:26624
  ds_read_b128 v[20:23], v3 offset:27648
  v_mfma_f32_32x32x16_bf16 v[40:55], v[184:187], v[60:63], v[40:55]
  s_waitcnt vmcnt(14) lgkmcnt(2)
  v_mfma_f32_32x32x16_bf16 v[24:39], v[192:195], v[8:11], v[24:39]
  ds_read_b128 v[56:59], v3 offset:28672
  ds_read_b128 v[60:63], v3 offset:29696
  v_mfma_f32_32x32x16_bf16 v[40:55], v[192:195], v[12:15], v[40:55]
  s_waitcnt vmcnt(12) lgkmcnt(2)
  v_mfma_f32_32x32x16_bf16 v[24:39], v[200:203], v[16:19], v[24:39]
  ds_read_b128 v[8:11], v3 offset:30720
  ds_read_b128 v[12:15], v3 offset:31744
  v_mfma_f32_32x32x16_bf16 v[40:55], v[200:203], v[20:23], v[40:55]
  s_waitcnt vmcnt(10) lgkmcnt(2)
  v_mfma_f32_32x32x16_bf16 v[24:39], v[208:211], v[56:59], v[24:39]
  v_mfma_f32_32x32x16_bf16 v[40:55], v[208:211], v[60:63], v[40:55]
  s_waitcnt vmcnt(8) lgkmcnt(0)
  v_mfma_f32_32x32x16_bf16 v[24:39], v[216:219], v[8:11], v[24:39]
  v_mfma_f32_32x32x16_bf16 v[40:55], v[216:219], v[12:15], v[40:55]
  s_and_b32 s35, s40, 1
  s_lshl_b32 s35, s35, 10
  v_add_u32 v4, s35, v3
  s_mul_i32 s44, s42, 56
  s_lshl_b32 s45, s57, 3
  s_add_u32 s44, s44, s45
  s_lshl_b32 s44, s44, 11
  s_lshl_b32 s45, s41, 6
  s_add_u32 s44, s44, s45
  s_lshl_b32 s44, s44, 4
  s_add_u32 s44, s44, 17268736
  s_and_b32 s45, s40, 1
  s_lshl_b32 s45, s45, 17
  s_add_u32 s44, s44, s45
  v_cvt_pk_bf16_f32 v24, v24, v25
  v_cvt_pk_bf16_f32 v25, v26, v27
  v_cvt_pk_bf16_f32 v26, v28, v29
  v_cvt_pk_bf16_f32 v27, v30, v31
  s_add_u32 s45, s44, 0
  buffer_store_dwordx4 v[24:27], v6, s[20:23], s45 offen sc1
  v_cvt_pk_bf16_f32 v28, v32, v33
  v_cvt_pk_bf16_f32 v29, v34, v35
  v_cvt_pk_bf16_f32 v30, v36, v37
  v_cvt_pk_bf16_f32 v31, v38, v39
  s_add_u32 s45, s44, 32768
  buffer_store_dwordx4 v[28:31], v6, s[20:23], s45 offen sc1
  v_cvt_pk_bf16_f32 v40, v40, v41
  v_cvt_pk_bf16_f32 v41, v42, v43
  v_cvt_pk_bf16_f32 v42, v44, v45
  v_cvt_pk_bf16_f32 v43, v46, v47
  s_add_u32 s45, s44, 512
  buffer_store_dwordx4 v[40:43], v6, s[20:23], s45 offen sc1
  v_cvt_pk_bf16_f32 v44, v48, v49
  v_cvt_pk_bf16_f32 v45, v50, v51
  v_cvt_pk_bf16_f32 v46, v52, v53
  v_cvt_pk_bf16_f32 v47, v54, v55
  s_add_u32 s45, s44, 33280
  buffer_store_dwordx4 v[44:47], v6, s[20:23], s45 offen sc1
  ds_read_b128 v[8:11], v4 offset:0
  ds_read_b128 v[12:15], v4 offset:2048
  ds_read_b128 v[16:19], v4 offset:4096
  s_waitcnt lgkmcnt(2)
  v_mfma_f32_32x32x16_bf16 v[96:111], v[228:231], v[8:11], 0
  ds_read_b128 v[20:23], v4 offset:6144
  s_waitcnt lgkmcnt(2)
  v_mfma_f32_32x32x16_bf16 v[96:111], v[236:239], v[12:15], v[96:111]
  ds_read_b128 v[8:11], v4 offset:8192
  s_waitcnt lgkmcnt(2)
  v_mfma_f32_32x32x16_bf16 v[96:111], v[244:247], v[16:19], v[96:111]
  ds_read_b128 v[12:15], v4 offset:10240
  s_waitcnt lgkmcnt(2)
  v_mfma_f32_32x32x16_bf16 v[96:111], v[252:255], v[20:23], v[96:111]
  ds_read_b128 v[16:19], v4 offset:12288
  s_waitcnt lgkmcnt(2)
  v_mfma_f32_32x32x16_bf16 v[96:111], v[132:135], v[8:11], v[96:111]
  ds_read_b128 v[20:23], v4 offset:14336
  s_waitcnt lgkmcnt(2)
  v_mfma_f32_32x32x16_bf16 v[96:111], v[140:143], v[12:15], v[96:111]
  ds_read_b128 v[8:11], v4 offset:16384
  s_waitcnt lgkmcnt(2)
  v_mfma_f32_32x32x16_bf16 v[96:111], v[148:151], v[16:19], v[96:111]
  ds_read_b128 v[12:15], v4 offset:18432
  s_waitcnt vmcnt(4)
  s_mul_i32 s44, s41, 7
  s_add_u32 s44, s44, s34
  s_lshl_b32 s44, s44, 3
  s_add_u32 s44, s44, s42
  s_mul_i32 s44, s44, 128
  s_add_u32 s44, s44, 44302336
  v_mov_b32 v60, 0
  v_mov_b32 v61, 1
  s_mov_b64 exec, 1
  buffer_store_dword v61, v60, s[20:23], s44 offen sc1
  s_mov_b64 exec, -1
  s_waitcnt lgkmcnt(2)
  v_mfma_f32_32x32x16_bf16 v[96:111], v[156:159], v[20:23], v[96:111]
  ds_read_b128 v[16:19], v4 offset:20480
  s_waitcnt lgkmcnt(2)
  v_mfma_f32_32x32x16_bf16 v[96:111], v[164:167], v[8:11], v[96:111]
  ds_read_b128 v[20:23], v4 offset:22528
  s_waitcnt lgkmcnt(2)
  v_mfma_f32_32x32x16_bf16 v[96:111], v[172:175], v[12:15], v[96:111]
  ds_read_b128 v[8:11], v4 offset:24576
  s_waitcnt lgkmcnt(2)
  v_mfma_f32_32x32x16_bf16 v[96:111], v[180:183], v[16:19], v[96:111]
  ds_read_b128 v[12:15], v4 offset:26624
  s_waitcnt lgkmcnt(2)
  v_mfma_f32_32x32x16_bf16 v[96:111], v[188:191], v[20:23], v[96:111]
  ds_read_b128 v[16:19], v4 offset:28672
  s_waitcnt lgkmcnt(2)
  v_mfma_f32_32x32x16_bf16 v[96:111], v[196:199], v[8:11], v[96:111]
  ds_read_b128 v[20:23], v4 offset:30720
  s_waitcnt lgkmcnt(2)
  v_mfma_f32_32x32x16_bf16 v[96:111], v[204:207], v[12:15], v[96:111]
  s_waitcnt lgkmcnt(1)
  v_mfma_f32_32x32x16_bf16 v[96:111], v[212:215], v[16:19], v[96:111]
  s_waitcnt lgkmcnt(0)
  v_mfma_f32_32x32x16_bf16 v[96:111], v[220:223], v[20:23], v[96:111]
  v_and_b32 v4, 31, v0
  v_lshrrev_b32 v5, 5, v0
  s_and_b32 s47, s40, 1
  s_lshr_b32 s48, s40, 1
  v_lshlrev_b32 v7, 11, v5
  v_add_u32 v7, v7, v4
  v_lshlrev_b32 v7, 4, v7
  s_lshl_b32 s52, s47, 9
  v_add_u32 v7, s52, v7
  s_lshl_b32 s51, s42, 18
  s_lshl_b32 s52, s41, 10
  s_add_u32 s51, s51, s52
  s_add_u32 s51, s51, 17268736
  s_lshl_b32 s52, s48, 17
  s_add_u32 s51, s51, s52
  s_waitcnt vmcnt(1)
  s_mul_i32 s44, s41, 7
  s_add_u32 s44, s44, s57
  s_lshl_b32 s44, s44, 3
  s_add_u32 s44, s44, s42
  s_mul_i32 s44, s44, 128
  s_add_u32 s44, s44, 44302336
  s_and_b32 s45, s40, 1
  s_lshl_b32 s45, s45, 2
  s_add_u32 s44, s44, s45
  v_mov_b32 v60, 0
  v_mov_b32 v61, 1
  s_mov_b64 exec, 1
  buffer_store_dword v61, v60, s[20:23], s44 offen sc1
  s_mov_b64 exec, -1
  v_and_b32 v4, 31, v0
  v_lshrrev_b32 v5, 5, v0
  s_lshl_b32 s49, s41, 6
  s_lshl_b32 s50, s47, 5
  s_add_u32 s49, s49, s50
  v_add_u32 v2, s49, v4
  v_mul_u32_u24 v2, 896, v2
  v_lshl_add_u32 v2, v5, 5, v2
  s_lshl_b32 s50, s42, 7
  s_lshl_b32 s52, s48, 6
  s_add_u32 s50, s50, s52
  v_and_b32 v6, 3, v4
  v_lshrrev_b32 v3, 3, v4
  v_lshl_add_u32 v6, v3, 2, v6
  v_bfe_u32 v3, v4, 2, 1
  v_lshl_add_u32 v6, v3, 4, v6
  v_lshlrev_b32 v3, 3, v5
  v_sub_u32 v6, v6, v3
  v_mov_b32 v4, 0x3f80
  v_mov_b32 v3, 0x3f800000
  v_cmp_eq_u32 vcc, 0, v6
  s_nop 1
  v_cndmask_b32 v8, 0, v4, vcc
  v_cmp_eq_u32 vcc, 1, v6
  s_nop 1
  v_cndmask_b32 v8, v8, v3, vcc
  v_cmp_eq_u32 vcc, 2, v6
  s_nop 1
  v_cndmask_b32 v9, 0, v4, vcc
  v_cmp_eq_u32 vcc, 3, v6
  s_nop 1
  v_cndmask_b32 v9, v9, v3, vcc
  v_cmp_eq_u32 vcc, 4, v6
  s_nop 1
  v_cndmask_b32 v10, 0, v4, vcc
  v_cmp_eq_u32 vcc, 5, v6
  s_nop 1
  v_cndmask_b32 v10, v10, v3, vcc
  v_cmp_eq_u32 vcc, 6, v6
  s_nop 1
  v_cndmask_b32 v11, 0, v4, vcc
  v_cmp_eq_u32 vcc, 7, v6
  s_nop 1
  v_cndmask_b32 v11, v11, v3, vcc
  v_cmp_eq_u32 vcc, 16, v6
  s_nop 1
  v_cndmask_b32 v12, 0, v4, vcc
  v_cmp_eq_u32 vcc, 17, v6
  s_nop 1
  v_cndmask_b32 v12, v12, v3, vcc
  v_cmp_eq_u32 vcc, 18, v6
  s_nop 1
  v_cndmask_b32 v13, 0, v4, vcc
  v_cmp_eq_u32 vcc, 19, v6
  s_nop 1
  v_cndmask_b32 v13, v13, v3, vcc
  v_cmp_eq_u32 vcc, 20, v6
  s_nop 1
  v_cndmask_b32 v14, 0, v4, vcc
  v_cmp_eq_u32 vcc, 21, v6
  s_nop 1
  v_cndmask_b32 v14, v14, v3, vcc
  v_cmp_eq_u32 vcc, 22, v6
  s_nop 1
  v_cndmask_b32 v15, 0, v4, vcc
  v_cmp_eq_u32 vcc, 23, v6
  s_nop 1
  v_cndmask_b32 v15, v15, v3, vcc
  s_lshl_b32 s53, s40, 12
  v_lshl_add_u32 v5, v0, 4, s53
  v_add_u32 v4, 139584, v5
  ds_read_b128 v[64:67], v4 offset:0
  ds_read_b128 v[68:71], v4 offset:1024
  ds_read_b128 v[72:75], v4 offset:2048
  ds_read_b128 v[76:79], v4 offset:3072
  s_waitcnt lgkmcnt(0)
  v_add_f32 v96, v96, v64
  v_add_f32 v97, v97, v65
  v_add_f32 v98, v98, v66
  v_add_f32 v99, v99, v67
  v_add_f32 v100, v100, v68
  v_add_f32 v101, v101, v69
  v_add_f32 v102, v102, v70
  v_add_f32 v103, v103, v71
  v_add_f32 v104, v104, v72
  v_add_f32 v105, v105, v73
  v_add_f32 v106, v106, v74
  v_add_f32 v107, v107, v75
  v_add_f32 v108, v108, v76
  v_add_f32 v109, v109, v77
  v_add_f32 v110, v110, v78
  v_add_f32 v111, v111, v79
  s_cmp_eq_u32 s40, 3
  s_nop 1
  s_cbranch_scc1 bpoll_142
lw_143:
  ds_read_b32 v62, v1 offset:36
  s_waitcnt lgkmcnt(0)
  v_readfirstlane_b32 s37, v62
  s_nop 0
  s_cmp_ge_u32 s37, 1
  s_cbranch_scc1 lwd_144
  s_sub_u32 s39, s39, 1
  s_nop 0
  s_cbranch_scc0 lw_143
  s_mov_b32 s39, 0
lwd_144:
  s_add_u32 s44, s42, 6
  s_cmp_ge_u32 s44, 7
  s_cselect_b32 s35, 7, 0
  s_sub_u32 s44, s44, s35
  s_mul_i32 s44, s44, 1835008
  s_add_u32 s44, s44, s51
  buffer_load_dwordx4 v[128:131], v7, s[20:23], s44 offen
  s_add_u32 s44, s44, 65536
  buffer_load_dwordx4 v[132:135], v7, s[20:23], s44 offen
  s_add_u32 s44, s42, 5
  s_cmp_ge_u32 s44, 7
  s_cselect_b32 s35, 7, 0
  s_sub_u32 s44, s44, s35
  s_mul_i32 s44, s44, 1835008
  s_add_u32 s44, s44, s51
  buffer_load_dwordx4 v[136:139], v7, s[20:23], s44 offen
  s_add_u32 s44, s44, 65536
  buffer_load_dwordx4 v[140:143], v7, s[20:23], s44 offen
  s_add_u32 s44, s42, 4
  s_cmp_ge_u32 s44, 7
  s_cselect_b32 s35, 7, 0
  s_sub_u32 s44, s44, s35
  s_mul_i32 s44, s44, 1835008
  s_add_u32 s44, s44, s51
  buffer_load_dwordx4 v[144:147], v7, s[20:23], s44 offen
  s_add_u32 s44, s44, 65536
  buffer_load_dwordx4 v[148:151], v7, s[20:23], s44 offen
  s_add_u32 s44, s42, 3
  s_cmp_ge_u32 s44, 7
  s_cselect_b32 s35, 7, 0
  s_sub_u32 s44, s44, s35
  s_mul_i32 s44, s44, 1835008
  s_add_u32 s44, s44, s51
  buffer_load_dwordx4 v[152:155], v7, s[20:23], s44 offen
  s_add_u32 s44, s44, 65536
  buffer_load_dwordx4 v[156:159], v7, s[20:23], s44 offen
lw_145:
  ds_read_b32 v62, v1 offset:28
  s_waitcnt lgkmcnt(0)
  v_readfirstlane_b32 s37, v62
  s_nop 0
  s_cmp_ge_u32 s37, 1
  s_cbranch_scc1 lwd_146
  s_sub_u32 s39, s39, 1
  s_nop 0
  s_cbranch_scc0 lw_145
  s_mov_b32 s39, 0
lwd_146:
  s_branch blate_147
bpoll_142:
  s_setprio 0
  s_mul_i32 s55, s41, 7
  s_add_u32 s55, s55, s42
  s_mul_i32 s55, s55, 1024
  s_add_u32 s55, s55, 44302336
  v_min_u32 v60, 7, v0
  s_add_u32 s44, s42, 6
  v_sub_u32 v58, s44, v60
  v_bfe_u32 v59, v60, 1, 1
  s_add_u32 s44, s42, 1
  v_add_u32 v59, s44, v59
  v_cmp_gt_u32 vcc, 4, v60
  s_nop 1
  v_cndmask_b32 v58, v59, v58, vcc
  v_subrev_u32 v61, 7, v58
  v_cmp_le_u32 vcc, 7, v58
  s_nop 1
  v_cndmask_b32 v58, v58, v61, vcc
  v_mul_u32_u24 v58, 128, v58
  v_and_b32 v59, 1, v60
  v_cmp_le_u32 vcc, 4, v60
  s_nop 1
  v_cndmask_b32 v59, 0, v59, vcc
  v_lshl_add_u32 v60, v59, 2, v58
  s_mov_b32 s54, 0
pb_148:
  buffer_load_dword v61, v60, s[20:23], s55 offen sc1
  s_waitcnt vmcnt(0)
  v_cmp_eq_u32 vcc, 0, v61
  s_nop 0
  s_and_b32 s53, vcc_lo, 0xf
  s_or_b32 s53, s53, s54
  s_cmp_lg_u32 s53, 0
  s_cbranch_scc1 pbn_150
  v_mov_b32 v62, 1
  s_mov_b64 exec, 1
  ds_add_u32 v1, v62 offset:36
  s_mov_b64 exec, -1
  s_mov_b32 s54, 0x100
pbn_150:
  s_cmp_eq_u64 vcc, 0
  s_cbranch_scc1 pbd_149
  s_sub_u32 s39, s39, 1
  s_nop 0
  s_cbranch_scc0 pb_148
  s_mov_b32 s39, 0
pbd_149:
  s_cmp_lg_u32 s54, 0
  s_cbranch_scc1 pbx_151
  v_mov_b32 v62, 1
  s_mov_b64 exec, 1
  ds_add_u32 v1, v62 offset:36
  s_mov_b64 exec, -1
pbx_151:
  v_mov_b32 v62, 1
  s_mov_b64 exec, 1
  ds_add_u32 v1, v62 offset:28
  s_mov_b64 exec, -1
  s_add_u32 s44, s42, 6
  s_cmp_ge_u32 s44, 7
  s_cselect_b32 s35, 7, 0
  s_sub_u32 s44, s44, s35
  s_mul_i32 s44, s44, 1835008
  s_add_u32 s44, s44, s51
  buffer_load_dwordx4 v[128:131], v7, s[20:23], s44 offen
  s_add_u32 s44, s44, 65536
  buffer_load_dwordx4 v[132:135], v7, s[20:23], s44 offen
  s_add_u32 s44, s42, 5
  s_cmp_ge_u32 s44, 7
  s_cselect_b32 s35, 7, 0
  s_sub_u32 s44, s44, s35
  s_mul_i32 s44, s44, 1835008
  s_add_u32 s44, s44, s51
  buffer_load_dwordx4 v[136:139], v7, s[20:23], s44 offen
  s_add_u32 s44, s44, 65536
  buffer_load_dwordx4 v[140:143], v7, s[20:23], s44 offen
  s_add_u32 s44, s42, 4
  s_cmp_ge_u32 s44, 7
  s_cselect_b32 s35, 7, 0
  s_sub_u32 s44, s44, s35
  s_mul_i32 s44, s44, 1835008
  s_add_u32 s44, s44, s51
  buffer_load_dwordx4 v[144:147], v7, s[20:23], s44 offen
  s_add_u32 s44, s44, 65536
  buffer_load_dwordx4 v[148:151], v7, s[20:23], s44 offen
  s_add_u32 s44, s42, 3
  s_cmp_ge_u32 s44, 7
  s_cselect_b32 s35, 7, 0
  s_sub_u32 s44, s44, s35
  s_mul_i32 s44, s44, 1835008
  s_add_u32 s44, s44, s51
  buffer_load_dwordx4 v[152:155], v7, s[20:23], s44 offen
  s_add_u32 s44, s44, 65536
  buffer_load_dwordx4 v[156:159], v7, s[20:23], s44 offen
  s_setprio 3
blate_147:
  s_add_u32 s44, s42, 1
  s_cmp_ge_u32 s44, 7
  s_cselect_b32 s35, 7, 0
  s_sub_u32 s44, s44, s35
  s_mul_i32 s44, s44, 1835008
  s_add_u32 s44, s44, s51
  buffer_load_dwordx4 v[160:163], v7, s[20:23], s44 offen
  s_add_u32 s44, s44, 65536
  buffer_load_dwordx4 v[164:167], v7, s[20:23], s44 offen
  s_add_u32 s44, s42, 2
  s_cmp_ge_u32 s44, 7
  s_cselect_b32 s35, 7, 0
  s_sub_u32 s44, s44, s35
  s_mul_i32 s44, s44, 1835008
  s_add_u32 s44, s44, s51
  buffer_load_dwordx4 v[168:171], v7, s[20:23], s44 offen
  s_add_u32 s44, s44, 65536
  buffer_load_dwordx4 v[172:175], v7, s[20:23], s44 offen
lw_152:
  ds_read_b32 v62, v1 offset:12
  s_waitcnt lgkmcnt(0)
  v_readfirstlane_b32 s37, v62
  s_nop 0
  s_cmp_ge_u32 s37, 4
  s_cbranch_scc1 lwd_153
  s_sub_u32 s39, s39, 1
  s_nop 0
  s_cbranch_scc0 lw_152
  s_mov_b32 s39, 0
lwd_153:
  v_add_u32 v4, 90112, v5
  ds_read_b128 v[64:67], v4 offset:0
  ds_read_b128 v[68:71], v4 offset:1024
  ds_read_b128 v[72:75], v4 offset:2048
  ds_read_b128 v[76:79], v4 offset:3072
  v_add_u32 v4, 106496, v5
  ds_read_b128 v[80:83], v4 offset:0
  ds_read_b128 v[84:87], v4 offset:1024
  ds_read_b128 v[88:91], v4 offset:2048
  ds_read_b128 v[92:95], v4 offset:3072
  s_waitcnt lgkmcnt(4)
  v_add_f32 v96, v96, v64
  v_add_f32 v97, v97, v65
  v_add_f32 v98, v98, v66
  v_add_f32 v99, v99, v67
  v_add_f32 v100, v100, v68
  v_add_f32 v101, v101, v69
  v_add_f32 v102, v102, v70
  v_add_f32 v103, v103, v71
  v_add_f32 v104, v104, v72
  v_add_f32 v105, v105, v73
  v_add_f32 v106, v106, v74
  v_add_f32 v107, v107, v75
  v_add_f32 v108, v108, v76
  v_add_f32 v109, v109, v77
  v_add_f32 v110, v110, v78
  v_add_f32 v111, v111, v79
  s_waitcnt lgkmcnt(0)
  v_add_f32 v96, v96, v80
  v_add_f32 v97, v97, v81
  v_add_f32 v98, v98, v82
  v_add_f32 v99, v99, v83
  v_add_f32 v100, v100, v84
  v_add_f32 v101, v101, v85
  v_add_f32 v102, v102, v86
  v_add_f32 v103, v103, v87
  v_add_f32 v104, v104, v88
  v_add_f32 v105, v105, v89
  v_add_f32 v106, v106, v90
  v_add_f32 v107, v107, v91
  v_add_f32 v108, v108, v92
  v_add_f32 v109, v109, v93
  v_add_f32 v110, v110, v94
  v_add_f32 v111, v111, v95
  v_add_u32 v4, 122880, v5
  ds_read_b128 v[64:67], v4 offset:0
  ds_read_b128 v[68:71], v4 offset:1024
  ds_read_b128 v[72:75], v4 offset:2048
  ds_read_b128 v[76:79], v4 offset:3072
  v_add_u32 v4, 32768, v5
  ds_read_b128 v[80:83], v4 offset:0
  ds_read_b128 v[84:87], v4 offset:1024
  ds_read_b128 v[88:91], v4 offset:2048
  ds_read_b128 v[92:95], v4 offset:3072
  s_waitcnt lgkmcnt(4)
  v_add_f32 v96, v96, v64
  v_add_f32 v97, v97, v65
  v_add_f32 v98, v98, v66
  v_add_f32 v99, v99, v67
  v_add_f32 v100, v100, v68
  v_add_f32 v101, v101, v69
  v_add_f32 v102, v102, v70
  v_add_f32 v103, v103, v71
  v_add_f32 v104, v104, v72
  v_add_f32 v105, v105, v73
  v_add_f32 v106, v106, v74
  v_add_f32 v107, v107, v75
  v_add_f32 v108, v108, v76
  v_add_f32 v109, v109, v77
  v_add_f32 v110, v110, v78
  v_add_f32 v111, v111, v79
  s_waitcnt lgkmcnt(0)
  v_add_f32 v96, v96, v80
  v_add_f32 v97, v97, v81
  v_add_f32 v98, v98, v82
  v_add_f32 v99, v99, v83
  v_add_f32 v100, v100, v84
  v_add_f32 v101, v101, v85
  v_add_f32 v102, v102, v86
  v_add_f32 v103, v103, v87
  v_add_f32 v104, v104, v88
  v_add_f32 v105, v105, v89
  v_add_f32 v106, v106, v90
  v_add_f32 v107, v107, v91
  v_add_f32 v108, v108, v92
  v_add_f32 v109, v109, v93
  v_add_f32 v110, v110, v94
  v_add_f32 v111, v111, v95
  s_waitcnt vmcnt(11)
  s_nop 0
  v_mfma_f32_32x32x16_bf16 v[96:111], v[8:11], v[128:131], v[96:111]
  s_waitcnt vmcnt(10)
  v_mfma_f32_32x32x16_bf16 v[96:111], v[12:15], v[132:135], v[96:111]
  s_waitcnt vmcnt(9)
  v_mfma_f32_32x32x16_bf16 v[96:111], v[8:11], v[136:139], v[96:111]
  s_waitcnt vmcnt(8)
  v_mfma_f32_32x32x16_bf16 v[96:111], v[12:15], v[140:143], v[96:111]
  s_waitcnt vmcnt(7)
  v_mfma_f32_32x32x16_bf16 v[96:111], v[8:11], v[144:147], v[96:111]
  s_waitcnt vmcnt(6)
  v_mfma_f32_32x32x16_bf16 v[96:111], v[12:15], v[148:151], v[96:111]
  s_waitcnt vmcnt(5)
  v_mfma_f32_32x32x16_bf16 v[96:111], v[8:11], v[152:155], v[96:111]
  s_waitcnt vmcnt(4)
  v_mfma_f32_32x32x16_bf16 v[96:111], v[12:15], v[156:159], v[96:111]
  s_waitcnt vmcnt(3)
  v_mfma_f32_32x32x16_bf16 v[96:111], v[8:11], v[160:163], v[96:111]
  s_waitcnt vmcnt(2)
  v_mfma_f32_32x32x16_bf16 v[96:111], v[12:15], v[164:167], v[96:111]
  s_waitcnt vmcnt(1)
  v_mfma_f32_32x32x16_bf16 v[96:111], v[8:11], v[168:171], v[96:111]
  s_waitcnt vmcnt(0)
  v_mfma_f32_32x32x16_bf16 v[96:111], v[12:15], v[172:175], v[96:111]
  s_nop 11
  v_cvt_pk_bf16_f32 v64, v96, v97
  v_cvt_pk_bf16_f32 v65, v98, v99
  v_cvt_pk_bf16_f32 v66, v100, v101
  v_cvt_pk_bf16_f32 v67, v102, v103
  v_cvt_pk_bf16_f32 v68, v104, v105
  v_cvt_pk_bf16_f32 v69, v106, v107
  v_cvt_pk_bf16_f32 v70, v108, v109
  v_cvt_pk_bf16_f32 v71, v110, v111
  buffer_store_dwordx4 v[64:67], v2, s[16:19], s50 offen
  buffer_store_dwordx4 v[68:71], v2, s[16:19], s50 offen offset:16
  s_endpgm
KMBsp_101:
  s_cmp_lg_u32 s2, 255
  s_cbranch_scc1 nz_154
  s_cmp_lg_u32 s3, 4
  s_cbranch_scc1 nz_154
  s_waitcnt lgkmcnt(0)
  s_load_dwordx2 s[24:25], s[0:1], 72
  s_mov_b32 s26, 256
  s_mov_b32 s27, 0x00020000
  v_lshlrev_b32 v2, 7, v0
  v_mov_b32 v3, 0
  s_mov_b32 s30, 44564480
  buffer_store_dword v3, v2, s[20:23], s30 offen sc1
  s_mov_b32 s30, 44572672
  buffer_store_dword v3, v2, s[20:23], s30 offen sc1
  s_mov_b32 s30, 44580864
  buffer_store_dword v3, v2, s[20:23], s30 offen sc1
  s_mov_b32 s30, 44589056
  buffer_store_dword v3, v2, s[20:23], s30 offen sc1
  s_mov_b32 s30, 44597248
  buffer_store_dword v3, v2, s[20:23], s30 offen sc1
  s_mov_b32 s30, 44605440
  buffer_store_dword v3, v2, s[20:23], s30 offen sc1
  s_mov_b32 s30, 44613632
  buffer_store_dword v3, v2, s[20:23], s30 offen sc1
  s_mov_b32 s30, 44621824
  buffer_store_dword v3, v2, s[20:23], s30 offen sc1
  s_mov_b32 s30, 44630016
  buffer_store_dword v3, v2, s[20:23], s30 offen sc1
  s_mov_b32 s30, 44638208
  buffer_store_dword v3, v2, s[20:23], s30 offen sc1
  s_mov_b32 s30, 44646400
  buffer_store_dword v3, v2, s[20:23], s30 offen sc1
  s_mov_b32 s30, 44654592
  buffer_store_dword v3, v2, s[20:23], s30 offen sc1
  s_mov_b32 s30, 44662784
  buffer_store_dword v3, v2, s[20:23], s30 offen sc1
  s_waitcnt vmcnt(0) lgkmcnt(0)
  v_mov_b32 v2, 0
  v_mov_b32 v3, 1
  s_mov_b64 exec, 1
  buffer_store_dword v3, v2, s[24:27], 0 offen sc1
  s_mov_b64 exec, -1
nz_154:
  s_sub_u32 s40, s3, 4
  s_sub_u32 s4, s2, 224
  s_mov_b32 s39, 131072
  s_waitcnt lgkmcnt(0)
  s_load_dwordx2 s[12:13], s[0:1], 48
  s_load_dwordx2 s[24:25], s[0:1], 40
  s_mov_b32 s14, 0x188000
  s_mov_b32 s15, 0x00020000
  s_mov_b32 s26, 0x62000
  s_mov_b32 s27, 0x00020000
  s_mul_i32 s28, s40, 16384
  s_add_u32 s28, s28, 65536
  v_lshlrev_b32 v14, 4, v0
  v_lshrrev_b32 v4, 5, v0
  v_lshlrev_b32 v13, 10, v4
  v_bfe_u32 v4, v0, 2, 2
  v_lshl_add_u32 v13, v4, 6, v13
  v_and_b32 v4, 1, v0
  v_lshl_add_u32 v13, v4, 5, v13
  v_bfe_u32 v4, v0, 4, 1
  v_lshl_add_u32 v13, v4, 4, v13
  v_bfe_u32 v4, v0, 1, 1
  v_lshl_add_u32 v13, v4, 3, v13
  v_add_u32 v13, s28, v13
  s_cmp_ge_u32 s4, 28
  s_cbranch_scc1 pb1n_155
  s_mul_i32 s5, s40, 3
  s_add_u32 s5, s5, 16
  s_movk_i32 s43, 3584
  v_lshrrev_b32 v11, 5, v0
  v_bfe_u32 v12, v0, 2, 2
  v_lshl_add_u32 v11, v11, 2, v12
  v_mul_lo_u32 v10, v11, s43
  v_bfe_u32 v11, v0, 4, 1
  v_lshl_add_u32 v10, v11, 6, v10
  v_and_b32 v11, 3, v0
  v_lshl_add_u32 v10, v11, 4, v10
  v_add_u32 v11, 28672, v10
  s_mul_i32 s33, s5, 57344
  s_lshl_b32 s34, s4, 7
  s_add_u32 s33, s33, s34
  s_movk_i32 s43, 896
  v_lshrrev_b32 v9, 5, v0
  v_bfe_u32 v12, v0, 2, 2
  v_lshl_add_u32 v9, v9, 2, v12
  v_mul_lo_u32 v8, v9, s43
  v_bfe_u32 v9, v0, 4, 1
  v_lshl_add_u32 v8, v9, 6, v8
  v_and_b32 v9, 3, v0
  v_lshl_add_u32 v8, v9, 4, v8
  s_and_b32 s30, s4, 3
  s_mul_i32 s30, s30, 100352
  s_mul_i32 s31, s3, 14336
  s_add_u32 s30, s30, s31
  s_lshr_b32 s31, s4, 2
  s_lshl_b32 s31, s31, 7
  s_add_u32 s30, s30, s31
  v_add_u32 v8, s30, v8
  v_add_u32 v9, 7168, v8
  s_waitcnt lgkmcnt(0)
  s_add_u32 m0, s28, 8192
  s_nop 0
  buffer_load_dwordx4 v8, s[24:27], 0 offen lds
  s_add_u32 m0, m0, 1024
  s_nop 0
  buffer_load_dwordx4 v9, s[24:27], 0 offen lds
  s_mov_b32 m0, s28
  s_nop 0
  buffer_load_dwordx4 v10, s[12:15], s33 offen lds
  s_add_u32 m0, m0, 1024
  s_nop 0
  buffer_load_dwordx4 v11, s[12:15], s33 offen lds
  s_add_u32 m0, m0, 1024
  s_add_u32 s33, s33, 57344
  buffer_load_dwordx4 v10, s[12:15], s33 offen lds
  s_add_u32 m0, m0, 1024
  s_nop 0
  buffer_load_dwordx4 v11, s[12:15], s33 offen lds
  s_add_u32 m0, m0, 1024
  s_add_u32 s33, s33, 57344
  buffer_load_dwordx4 v10, s[12:15], s33 offen lds
  s_add_u32 m0, m0, 1024
  s_nop 0
  buffer_load_dwordx4 v11, s[12:15], s33 offen lds
  v_mov_b32 v28, 0x3f803f80
  v_mov_b32 v29, 0x3f803f80
  v_mov_b32 v30, 0x3f803f80
  v_mov_b32 v31, 0x3f803f80
  s_waitcnt vmcnt(0)
  ds_read_b64_tr_b16 v[80:81], v13 offset:8192
  ds_read_b64_tr_b16 v[82:83], v13 offset:8704
  ds_read_b64_tr_b16 v[84:85], v13 offset:8448
  ds_read_b64_tr_b16 v[86:87], v13 offset:8960
  s_mul_i32 s35, s4, 14336
  s_lshl_b32 s36, s3, 11
  s_add_u32 s35, s35, s36
  s_add_u32 s35, s35, 8388608
  s_waitcnt lgkmcnt(0)
  s_cmp_ge_u32 s3, 7
  s_cbranch_scc1 now2_157
  buffer_store_dwordx4 v[80:83], v14, s[20:23], s35 offen sc1
  buffer_store_dwordx4 v[84:87], v14, s[20:23], s35 offen offset:1024 sc1
now2_157:
  ds_read_b64_tr_b16 v[32:33], v13 offset:0
  ds_read_b64_tr_b16 v[34:35], v13 offset:512
  ds_read_b64_tr_b16 v[36:37], v13 offset:256
  ds_read_b64_tr_b16 v[38:39], v13 offset:768
  ds_read_b64_tr_b16 v[40:41], v13 offset:2048
  ds_read_b64_tr_b16 v[42:43], v13 offset:2560
  ds_read_b64_tr_b16 v[44:45], v13 offset:2304
  ds_read_b64_tr_b16 v[46:47], v13 offset:2816
  ds_read_b64_tr_b16 v[48:49], v13 offset:4096
  ds_read_b64_tr_b16 v[50:51], v13 offset:4608
  ds_read_b64_tr_b16 v[52:53], v13 offset:4352
  ds_read_b64_tr_b16 v[54:55], v13 offset:4864
  s_waitcnt lgkmcnt(0)
  v_mfma_f32_32x32x16_bf16 v[144:159], v[28:31], v[32:35], 0
  v_mfma_f32_32x32x16_bf16 v[160:175], v[28:31], v[36:39], 0
  v_mfma_f32_32x32x16_bf16 v[144:159], v[28:31], v[40:43], v[144:159]
  v_mfma_f32_32x32x16_bf16 v[160:175], v[28:31], v[44:47], v[160:175]
  v_mfma_f32_32x32x16_bf16 v[144:159], v[28:31], v[48:51], v[144:159]
  v_mfma_f32_32x32x16_bf16 v[160:175], v[28:31], v[52:55], v[160:175]
  v_lshlrev_b32 v2, 2, v0
  s_add_u32 s30, s28, 14336
  v_add_u32 v3, s30, v2
  v_add_u32 v4, 14336, v2
  v_add_u32 v7, 79872, v2
  s_nop 5
  ds_write_b32 v3, v144
  ds_write_b32 v3, v160 offset:256
  s_waitcnt lgkmcnt(0)
  s_barrier
  ds_read_b32 v96, v4 offset:0
  ds_read_b32 v97, v4 offset:256
  ds_read_b32 v98, v4 offset:16384
  ds_read_b32 v99, v4 offset:16640
  ds_read_b32 v100, v4 offset:32768
  ds_read_b32 v101, v4 offset:33024
  ds_read_b32 v102, v4 offset:49152
  ds_read_b32 v103, v4 offset:49408
  ds_read_b32 v104, v7 offset:0
  ds_read_b32 v105, v7 offset:256
  ds_read_b32 v106, v7 offset:16384
  ds_read_b32 v107, v7 offset:16640
  ds_read_b32 v108, v7 offset:32768
  ds_read_b32 v109, v7 offset:33024
  ds_read_b32 v110, v7 offset:49152
  ds_read_b32 v111, v7 offset:49408
  s_waitcnt lgkmcnt(0)
  v_add_f32 v96, v96, v104
  v_add_f32 v97, v97, v105
  v_add_f32 v98, v98, v106
  v_add_f32 v99, v99, v107
  v_add_f32 v100, v100, v108
  v_add_f32 v101, v101, v109
  v_add_f32 v102, v102, v110
  v_add_f32 v103, v103, v111
  v_add_f32 v96, v96, v100
  v_add_f32 v97, v97, v101
  v_add_f32 v98, v98, v102
  v_add_f32 v99, v99, v103
  v_add_f32 v96, v96, v98
  v_add_f32 v97, v97, v99
  v_mul_f32 v5, 0x3b124925, v96
  v_mul_f32 v6, 0x3b124925, v97
  s_mul_i32 s32, s4, 57344
  s_lshl_b32 s33, s5, 11
  s_add_u32 s32, s32, s33
  s_add_u32 s32, s32, 8912896
  v_lshlrev_b32 v16, 16, v32
  v_and_b32 v17, 0xffff0000, v32
  v_lshlrev_b32 v18, 16, v33
  v_and_b32 v19, 0xffff0000, v33
  v_lshlrev_b32 v20, 16, v34
  v_and_b32 v21, 0xffff0000, v34
  v_lshlrev_b32 v22, 16, v35
  v_and_b32 v23, 0xffff0000, v35
  v_sub_f32 v16, v16, v5
  v_sub_f32 v17, v17, v5
  v_sub_f32 v18, v18, v5
  v_sub_f32 v19, v19, v5
  v_sub_f32 v20, v20, v5
  v_sub_f32 v21, v21, v5
  v_sub_f32 v22, v22, v5
  v_sub_f32 v23, v23, v5
  v_cvt_pk_bf16_f32 v32, v16, v17
  v_cvt_pk_bf16_f32 v33, v18, v19
  v_cvt_pk_bf16_f32 v34, v20, v21
  v_cvt_pk_bf16_f32 v35, v22, v23
  v_lshlrev_b32 v16, 16, v36
  v_and_b32 v17, 0xffff0000, v36
  v_lshlrev_b32 v18, 16, v37
  v_and_b32 v19, 0xffff0000, v37
  v_lshlrev_b32 v20, 16, v38
  v_and_b32 v21, 0xffff0000, v38
  v_lshlrev_b32 v22, 16, v39
  v_and_b32 v23, 0xffff0000, v39
  v_sub_f32 v16, v16, v6
  v_sub_f32 v17, v17, v6
  v_sub_f32 v18, v18, v6
  v_sub_f32 v19, v19, v6
  v_sub_f32 v20, v20, v6
  v_sub_f32 v21, v21, v6
  v_sub_f32 v22, v22, v6
  v_sub_f32 v23, v23, v6
  v_cvt_pk_bf16_f32 v36, v16, v17
  v_cvt_pk_bf16_f32 v37, v18, v19
  v_cvt_pk_bf16_f32 v38, v20, v21
  v_cvt_pk_bf16_f32 v39, v22, v23
  buffer_store_dwordx4 v[32:35], v14, s[20:23], s32 offen offset:0 sc1
  buffer_store_dwordx4 v[36:39], v14, s[20:23], s32 offen offset:1024 sc1
  v_lshlrev_b32 v16, 16, v40
  v_and_b32 v17, 0xffff0000, v40
  v_lshlrev_b32 v18, 16, v41
  v_and_b32 v19, 0xffff0000, v41
  v_lshlrev_b32 v20, 16, v42
  v_and_b32 v21, 0xffff0000, v42
  v_lshlrev_b32 v22, 16, v43
  v_and_b32 v23, 0xffff0000, v43
  v_sub_f32 v16, v16, v5
  v_sub_f32 v17, v17, v5
  v_sub_f32 v18, v18, v5
  v_sub_f32 v19, v19, v5
  v_sub_f32 v20, v20, v5
  v_sub_f32 v21, v21, v5
  v_sub_f32 v22, v22, v5
  v_sub_f32 v23, v23, v5
  v_cvt_pk_bf16_f32 v40, v16, v17
  v_cvt_pk_bf16_f32 v41, v18, v19
  v_cvt_pk_bf16_f32 v42, v20, v21
  v_cvt_pk_bf16_f32 v43, v22, v23
  v_lshlrev_b32 v16, 16, v44
  v_and_b32 v17, 0xffff0000, v44
  v_lshlrev_b32 v18, 16, v45
  v_and_b32 v19, 0xffff0000, v45
  v_lshlrev_b32 v20, 16, v46
  v_and_b32 v21, 0xffff0000, v46
  v_lshlrev_b32 v22, 16, v47
  v_and_b32 v23, 0xffff0000, v47
  v_sub_f32 v16, v16, v6
  v_sub_f32 v17, v17, v6
  v_sub_f32 v18, v18, v6
  v_sub_f32 v19, v19, v6
  v_sub_f32 v20, v20, v6
  v_sub_f32 v21, v21, v6
  v_sub_f32 v22, v22, v6
  v_sub_f32 v23, v23, v6
  v_cvt_pk_bf16_f32 v44, v16, v17
  v_cvt_pk_bf16_f32 v45, v18, v19
  v_cvt_pk_bf16_f32 v46, v20, v21
  v_cvt_pk_bf16_f32 v47, v22, v23
  buffer_store_dwordx4 v[40:43], v14, s[20:23], s32 offen offset:2048 sc1
  buffer_store_dwordx4 v[44:47], v14, s[20:23], s32 offen offset:3072 sc1
  s_add_u32 s32, s32, 4096
  v_lshlrev_b32 v16, 16, v48
  v_and_b32 v17, 0xffff0000, v48
  v_lshlrev_b32 v18, 16, v49
  v_and_b32 v19, 0xffff0000, v49
  v_lshlrev_b32 v20, 16, v50
  v_and_b32 v21, 0xffff0000, v50
  v_lshlrev_b32 v22, 16, v51
  v_and_b32 v23, 0xffff0000, v51
  v_sub_f32 v16, v16, v5
  v_sub_f32 v17, v17, v5
  v_sub_f32 v18, v18, v5
  v_sub_f32 v19, v19, v5
  v_sub_f32 v20, v20, v5
  v_sub_f32 v21, v21, v5
  v_sub_f32 v22, v22, v5
  v_sub_f32 v23, v23, v5
  v_cvt_pk_bf16_f32 v48, v16, v17
  v_cvt_pk_bf16_f32 v49, v18, v19
  v_cvt_pk_bf16_f32 v50, v20, v21
  v_cvt_pk_bf16_f32 v51, v22, v23
  v_lshlrev_b32 v16, 16, v52
  v_and_b32 v17, 0xffff0000, v52
  v_lshlrev_b32 v18, 16, v53
  v_and_b32 v19, 0xffff0000, v53
  v_lshlrev_b32 v20, 16, v54
  v_and_b32 v21, 0xffff0000, v54
  v_lshlrev_b32 v22, 16, v55
  v_and_b32 v23, 0xffff0000, v55
  v_sub_f32 v16, v16, v6
  v_sub_f32 v17, v17, v6
  v_sub_f32 v18, v18, v6
  v_sub_f32 v19, v19, v6
  v_sub_f32 v20, v20, v6
  v_sub_f32 v21, v21, v6
  v_sub_f32 v22, v22, v6
  v_sub_f32 v23, v23, v6
  v_cvt_pk_bf16_f32 v52, v16, v17
  v_cvt_pk_bf16_f32 v53, v18, v19
  v_cvt_pk_bf16_f32 v54, v20, v21
  v_cvt_pk_bf16_f32 v55, v22, v23
  buffer_store_dwordx4 v[48:51], v14, s[20:23], s32 offen offset:0 sc1
  buffer_store_dwordx4 v[52:55], v14, s[20:23], s32 offen offset:1024 sc1
  s_branch pb1d_156
pb1n_155:
  s_waitcnt lgkmcnt(0)
  s_barrier
pb1d_156:
  s_waitcnt vmcnt(0)
  s_barrier
  s_barrier
  v_mov_b32 v1, 139328
  s_load_dwordx2 s[8:9], s[0:1], 56
  s_load_dwordx2 s[16:17], s[0:1], 16
  s_mov_b32 s10, 0x188000
  s_mov_b32 s11, 0x00020000
  s_mov_b32 s18, 0x62000
  s_mov_b32 s19, 0x00020000
  s_mul_i32 s28, s40, 16384
  v_lshlrev_b32 v14, 4, v0
  v_lshrrev_b32 v4, 5, v0
  v_lshlrev_b32 v13, 10, v4
  v_bfe_u32 v4, v0, 2, 2
  v_lshl_add_u32 v13, v4, 6, v13
  v_and_b32 v4, 1, v0
  v_lshl_add_u32 v13, v4, 5, v13
  v_bfe_u32 v4, v0, 4, 1
  v_lshl_add_u32 v13, v4, 4, v13
  v_bfe_u32 v4, v0, 1, 1
  v_lshl_add_u32 v13, v4, 3, v13
  v_add_u32 v13, s28, v13
  s_lshl_b32 s5, s4, 2
  s_add_u32 s5, s5, s40
  s_movk_i32 s43, 896
  v_lshrrev_b32 v11, 5, v0
  v_bfe_u32 v12, v0, 2, 2
  v_lshl_add_u32 v11, v11, 2, v12
  v_mul_lo_u32 v10, v11, s43
  v_bfe_u32 v11, v0, 4, 1
  v_lshl_add_u32 v10, v11, 6, v10
  v_and_b32 v11, 3, v0
  v_lshl_add_u32 v10, v11, 4, v10
  s_waitcnt lgkmcnt(0)
  s_cmp_ge_u32 s5, 100
  s_nop 0
  s_cbranch_scc1 pkwo_158
  s_cmp_ge_u32 s5, 98
  s_nop 0
  s_cbranch_scc1 pkd2_159
  v_add_u32 v11, 7168, v10
  s_lshl_b32 s5, s5, 3
  s_mov_b32 m0, s28
  s_lshr_b32 s31, s5, 4
  s_and_b32 s32, s5, 15
  s_mul_i32 s33, s31, 9363
  s_lshr_b32 s33, s33, 16
  s_mul_i32 s34, s33, 7
  s_sub_u32 s34, s31, s34
  s_lshl_b32 s33, s33, 4
  s_add_u32 s33, s33, s32
  s_mul_i32 s33, s33, 14336
  s_lshl_b32 s34, s34, 7
  s_add_u32 s33, s33, s34
  buffer_load_dwordx4 v10, s[8:11], s33 offen lds
  s_add_u32 m0, m0, 1024
  s_nop 0
  buffer_load_dwordx4 v11, s[8:11], s33 offen lds
  s_add_u32 m0, m0, 1024
  s_add_u32 s33, s33, 14336
  buffer_load_dwordx4 v10, s[8:11], s33 offen lds
  s_add_u32 m0, m0, 1024
  s_nop 0
  buffer_load_dwordx4 v11, s[8:11], s33 offen lds
  s_add_u32 m0, m0, 1024
  s_add_u32 s33, s33, 14336
  buffer_load_dwordx4 v10, s[8:11], s33 offen lds
  s_add_u32 m0, m0, 1024
  s_nop 0
  buffer_load_dwordx4 v11, s[8:11], s33 offen lds
  s_add_u32 m0, m0, 1024
  s_add_u32 s33, s33, 14336
  buffer_load_dwordx4 v10, s[8:11], s33 offen lds
  s_add_u32 m0, m0, 1024
  s_nop 0
  buffer_load_dwordx4 v11, s[8:11], s33 offen lds
  s_add_u32 m0, m0, 1024
  s_add_u32 s33, s33, 14336
  buffer_load_dwordx4 v10, s[8:11], s33 offen lds
  s_add_u32 m0, m0, 1024
  s_nop 0
  buffer_load_dwordx4 v11, s[8:11], s33 offen lds
  s_add_u32 m0, m0, 1024
  s_add_u32 s33, s33, 14336
  buffer_load_dwordx4 v10, s[8:11], s33 offen lds
  s_add_u32 m0, m0, 1024
  s_nop 0
  buffer_load_dwordx4 v11, s[8:11], s33 offen lds
  s_add_u32 m0, m0, 1024
  s_add_u32 s33, s33, 14336
  buffer_load_dwordx4 v10, s[8:11], s33 offen lds
  s_add_u32 m0, m0, 1024
  s_nop 0
  buffer_load_dwordx4 v11, s[8:11], s33 offen lds
  s_add_u32 m0, m0, 1024
  s_add_u32 s33, s33, 14336
  buffer_load_dwordx4 v10, s[8:11], s33 offen lds
  s_add_u32 m0, m0, 1024
  s_nop 0
  buffer_load_dwordx4 v11, s[8:11], s33 offen lds
  s_waitcnt vmcnt(0)
  ds_read_b64_tr_b16 v[32:33], v13 offset:0
  ds_read_b64_tr_b16 v[34:35], v13 offset:512
  ds_read_b64_tr_b16 v[36:37], v13 offset:256
  ds_read_b64_tr_b16 v[38:39], v13 offset:768
  ds_read_b64_tr_b16 v[40:41], v13 offset:2048
  ds_read_b64_tr_b16 v[42:43], v13 offset:2560
  ds_read_b64_tr_b16 v[44:45], v13 offset:2304
  ds_read_b64_tr_b16 v[46:47], v13 offset:2816
  ds_read_b64_tr_b16 v[48:49], v13 offset:4096
  ds_read_b64_tr_b16 v[50:51], v13 offset:4608
  ds_read_b64_tr_b16 v[52:53], v13 offset:4352
  ds_read_b64_tr_b16 v[54:55], v13 offset:4864
  ds_read_b64_tr_b16 v[56:57], v13 offset:6144
  ds_read_b64_tr_b16 v[58:59], v13 offset:6656
  ds_read_b64_tr_b16 v[60:61], v13 offset:6400
  ds_read_b64_tr_b16 v[62:63], v13 offset:6912
  ds_read_b64_tr_b16 v[64:65], v13 offset:8192
  ds_read_b64_tr_b16 v[66:67], v13 offset:8704
  ds_read_b64_tr_b16 v[68:69], v13 offset:8448
  ds_read_b64_tr_b16 v[70:71], v13 offset:8960
  ds_read_b64_tr_b16 v[72:73], v13 offset:10240
  ds_read_b64_tr_b16 v[74:75], v13 offset:10752
  ds_read_b64_tr_b16 v[76:77], v13 offset:10496
  ds_read_b64_tr_b16 v[78:79], v13 offset:11008
  ds_read_b64_tr_b16 v[80:81], v13 offset:12288
  ds_read_b64_tr_b16 v[82:83], v13 offset:12800
  ds_read_b64_tr_b16 v[84:85], v13 offset:12544
  ds_read_b64_tr_b16 v[86:87], v13 offset:13056
  ds_read_b64_tr_b16 v[88:89], v13 offset:14336
  ds_read_b64_tr_b16 v[90:91], v13 offset:14848
  ds_read_b64_tr_b16 v[92:93], v13 offset:14592
  ds_read_b64_tr_b16 v[94:95], v13 offset:15104
  s_lshl_b32 s32, s5, 11
  s_add_u32 s32, s32, 10747904
  s_nop 0
  s_branch pkst_160
pkwo_158:
  s_sub_u32 s5, s5, 100
  s_and_b32 s30, s5, 3
  s_mul_i32 s30, s30, 100352
  s_lshr_b32 s31, s5, 2
  s_lshl_b32 s31, s31, 7
  s_add_u32 s30, s30, s31
  v_add_u32 v10, s30, v10
  s_mov_b32 m0, s28
  s_nop 0
  buffer_load_dwordx4 v10, s[16:19], 0 offen lds
  s_add_u32 m0, m0, 1024
  v_add_u32 v10, 7168, v10
  buffer_load_dwordx4 v10, s[16:19], 0 offen lds
  s_add_u32 m0, m0, 1024
  v_add_u32 v10, 7168, v10
  buffer_load_dwordx4 v10, s[16:19], 0 offen lds
  s_add_u32 m0, m0, 1024
  v_add_u32 v10, 7168, v10
  buffer_load_dwordx4 v10, s[16:19], 0 offen lds
  s_add_u32 m0, m0, 1024
  v_add_u32 v10, 7168, v10
  buffer_load_dwordx4 v10, s[16:19], 0 offen lds
  s_add_u32 m0, m0, 1024
  v_add_u32 v10, 7168, v10
  buffer_load_dwordx4 v10, s[16:19], 0 offen lds
  s_add_u32 m0, m0, 1024
  v_add_u32 v10, 7168, v10
  buffer_load_dwordx4 v10, s[16:19], 0 offen lds
  s_add_u32 m0, m0, 1024
  v_add_u32 v10, 7168, v10
  buffer_load_dwordx4 v10, s[16:19], 0 offen lds
  s_add_u32 m0, m0, 1024
  v_add_u32 v10, 7168, v10
  buffer_load_dwordx4 v10, s[16:19], 0 offen lds
  s_add_u32 m0, m0, 1024
  v_add_u32 v10, 7168, v10
  buffer_load_dwordx4 v10, s[16:19], 0 offen lds
  s_add_u32 m0, m0, 1024
  v_add_u32 v10, 7168, v10
  buffer_load_dwordx4 v10, s[16:19], 0 offen lds
  s_add_u32 m0, m0, 1024
  v_add_u32 v10, 7168, v10
  buffer_load_dwordx4 v10, s[16:19], 0 offen lds
  s_add_u32 m0, m0, 1024
  v_add_u32 v10, 7168, v10
  buffer_load_dwordx4 v10, s[16:19], 0 offen lds
  s_add_u32 m0, m0, 1024
  v_add_u32 v10, 7168, v10
  buffer_load_dwordx4 v10, s[16:19], 0 offen lds
  s_add_u32 m0, m0, 1024
  v_add_u32 v10, 7168, v10
  buffer_load_dwordx4 v10, s[16:19], 0 offen lds
  s_waitcnt vmcnt(0)
  ds_read_b64_tr_b16 v[32:33], v13 offset:0
  ds_read_b64_tr_b16 v[34:35], v13 offset:512
  ds_read_b64_tr_b16 v[36:37], v13 offset:256
  ds_read_b64_tr_b16 v[38:39], v13 offset:768
  ds_read_b64_tr_b16 v[40:41], v13 offset:2048
  ds_read_b64_tr_b16 v[42:43], v13 offset:2560
  ds_read_b64_tr_b16 v[44:45], v13 offset:2304
  ds_read_b64_tr_b16 v[46:47], v13 offset:2816
  ds_read_b64_tr_b16 v[48:49], v13 offset:3584
  ds_read_b64_tr_b16 v[50:51], v13 offset:4096
  ds_read_b64_tr_b16 v[52:53], v13 offset:3840
  ds_read_b64_tr_b16 v[54:55], v13 offset:4352
  ds_read_b64_tr_b16 v[56:57], v13 offset:5632
  ds_read_b64_tr_b16 v[58:59], v13 offset:6144
  ds_read_b64_tr_b16 v[60:61], v13 offset:5888
  ds_read_b64_tr_b16 v[62:63], v13 offset:6400
  ds_read_b64_tr_b16 v[64:65], v13 offset:7168
  ds_read_b64_tr_b16 v[66:67], v13 offset:7680
  ds_read_b64_tr_b16 v[68:69], v13 offset:7424
  ds_read_b64_tr_b16 v[70:71], v13 offset:7936
  ds_read_b64_tr_b16 v[72:73], v13 offset:9216
  ds_read_b64_tr_b16 v[74:75], v13 offset:9728
  ds_read_b64_tr_b16 v[76:77], v13 offset:9472
  ds_read_b64_tr_b16 v[78:79], v13 offset:9984
  ds_read_b64_tr_b16 v[80:81], v13 offset:10752
  ds_read_b64_tr_b16 v[82:83], v13 offset:11264
  ds_read_b64_tr_b16 v[84:85], v13 offset:11008
  ds_read_b64_tr_b16 v[86:87], v13 offset:11520
  ds_read_b64_tr_b16 v[88:89], v13 offset:12800
  ds_read_b64_tr_b16 v[90:91], v13 offset:13312
  ds_read_b64_tr_b16 v[92:93], v13 offset:13056
  ds_read_b64_tr_b16 v[94:95], v13 offset:13568
  s_lshl_b32 s32, s5, 14
  s_add_u32 s32, s32, 12582912
pkst_160:
  s_waitcnt lgkmcnt(0)
lw_161:
  ds_read_b32 v2, v1 offset:52
  s_waitcnt lgkmcnt(0)
  v_readfirstlane_b32 s37, v2
  s_nop 0
  s_cmp_ge_u32 s37, 1
  s_cbranch_scc1 lwd_162
  s_sub_u32 s39, s39, 1
  s_nop 0
  s_cbranch_scc0 lw_161
  s_mov_b32 s39, 0
lwd_162:
  buffer_store_dwordx4 v[32:35], v14, s[20:23], s32 offen offset:0 sc1
  buffer_store_dwordx4 v[36:39], v14, s[20:23], s32 offen offset:1024 sc1
  buffer_store_dwordx4 v[40:43], v14, s[20:23], s32 offen offset:2048 sc1
  buffer_store_dwordx4 v[44:47], v14, s[20:23], s32 offen offset:3072 sc1
  s_add_u32 s32, s32, 4096
  buffer_store_dwordx4 v[48:51], v14, s[20:23], s32 offen offset:0 sc1
  buffer_store_dwordx4 v[52:55], v14, s[20:23], s32 offen offset:1024 sc1
  buffer_store_dwordx4 v[56:59], v14, s[20:23], s32 offen offset:2048 sc1
  buffer_store_dwordx4 v[60:63], v14, s[20:23], s32 offen offset:3072 sc1
  s_add_u32 s32, s32, 4096
  buffer_store_dwordx4 v[64:67], v14, s[20:23], s32 offen offset:0 sc1
  buffer_store_dwordx4 v[68:71], v14, s[20:23], s32 offen offset:1024 sc1
  buffer_store_dwordx4 v[72:75], v14, s[20:23], s32 offen offset:2048 sc1
  buffer_store_dwordx4 v[76:79], v14, s[20:23], s32 offen offset:3072 sc1
  s_add_u32 s32, s32, 4096
  buffer_store_dwordx4 v[80:83], v14, s[20:23], s32 offen offset:0 sc1
  buffer_store_dwordx4 v[84:87], v14, s[20:23], s32 offen offset:1024 sc1
  buffer_store_dwordx4 v[88:91], v14, s[20:23], s32 offen offset:2048 sc1
  buffer_store_dwordx4 v[92:95], v14, s[20:23], s32 offen offset:3072 sc1
  s_add_u32 s32, s32, 4096
pkd2_159:
  s_waitcnt vmcnt(0)
  v_mov_b32 v3, 1
  s_mov_b64 exec, 1
  ds_add_rtn_u32 v2, v1, v3 offset:60
  s_mov_b64 exec, -1
  s_waitcnt lgkmcnt(0)
  v_readfirstlane_b32 s5, v2
  s_nop 0
  s_cmp_lg_u32 s5, 3
  s_cbranch_scc1 notlast2_163
  s_lshl_b32 s5, s4, 7
  s_add_u32 s5, s5, 44597248
  v_mov_b32 v2, 0
  v_mov_b32 v3, 1
  s_mov_b64 exec, 1
  buffer_store_dword v3, v2, s[20:23], s5 offen sc1
  s_mov_b64 exec, -1
notlast2_163:
K1end_5:
  s_endpgm
.section .rodata,"a"
.p2align 6
.amdhsa_kernel parallel_sum__softmax_full_mha__mixer_s_mlp__prompt_kernel
  .amdhsa_next_free_vgpr 256
  .amdhsa_next_free_sgpr 102
  .amdhsa_accum_offset 256
  .amdhsa_group_segment_fixed_size 0
  .amdhsa_kernarg_size 88
  .amdhsa_user_sgpr_count 2
  .amdhsa_user_sgpr_kernarg_segment_ptr 1
  .amdhsa_system_sgpr_workgroup_id_x 1
  .amdhsa_float_denorm_mode_32 3
  .amdhsa_float_denorm_mode_16_64 3
.end_amdhsa_kernel
```
